```python
import torch

def _softmax(x, axis=-1):
    return torch.softmax(x, dim=axis)

def _gelu(x):
    return torch.nn.functional.gelu(x, approximate='tanh')

def _silu(x):
    return torch.nn.functional.silu(x)

def _sigmoid(x):
    return torch.sigmoid(x)

def _layernorm(x, axis=-1, eps=1e-05):
    m = x.mean(dim=axis, keepdim=True)
    v = x.var(dim=axis, keepdim=True, unbiased=False)
    return (x - m) / torch.sqrt(v + eps)

def _scatter_add(tgt, idx, src, axis=0):
    return tgt.clone().index_add_(axis, idx, src)

def _segment_sum(src, seg, n):
    out = torch.zeros((n,) + src.shape[1:], dtype=src.dtype)
    return out.index_add_(0, seg, src)

def _pad(x, pw):
    flat = tuple((v for pair in reversed(pw) for v in pair))
    return torch.nn.functional.pad(x, flat)
kernel_name = 'standalone__conformer_family_branchformer__speech'

def setup_inputs():

    _w = lambda a: (lambda t: t.to(torch.bfloat16) if t.is_floating_point() else t)(torch.as_tensor(a))
    B, T, D, K = (2, 4000, 512, 31)
    s = float(D) ** (-0.5)
    return {'x': _w((lambda *s: torch.randn(*s, dtype=torch.bfloat16) * 0.05)(B, T, D)), 'w_q': _w((lambda *s: torch.randn(*s, dtype=torch.bfloat16) * 1.6)(D, D) * s), 'w_k': _w((lambda *s: torch.randn(*s, dtype=torch.bfloat16) * 1.6)(D, D) * s), 'w_v': _w((lambda *s: torch.randn(*s, dtype=torch.bfloat16) * 0.8)(D, D) * s), 'w_ao': _w((lambda *s: torch.randn(*s, dtype=torch.bfloat16) * 0.8)(D, D) * s), 'w_up': _w((lambda *s: torch.randn(*s, dtype=torch.bfloat16) * 1.6)(D, 2 * D) * s), 'dw': _w((lambda *s: torch.randn(*s, dtype=torch.bfloat16) * 1.6)(K, D) * (1.0 / K)), 'w_dn': _w((lambda *s: torch.randn(*s, dtype=torch.bfloat16) * 0.8)(D, D) * s), 'w_merge': _w((lambda *s: torch.randn(*s, dtype=torch.bfloat16) * 0.8)(2 * D, D) * s)}

def reference(x, w_q, w_k, w_v, w_ao, w_up, dw, w_dn, w_merge):
    B, T, D = x.shape
    K = dw.shape[0]
    xa = _layernorm(x, axis=-1)
    q = torch.einsum('btd,de->bte', xa, w_q)
    k = torch.einsum('btd,de->bte', xa, w_k)
    v = torch.einsum('btd,de->bte', xa, w_v)
    logits = torch.einsum('btd,bsd->bts', q, k) * float(D) ** (-0.5)
    attn = _softmax(logits, axis=-1)
    ya = torch.einsum('bts,bsd->btd', attn, v)
    ya = torch.einsum('btd,de->bte', ya, w_ao)
    xc = _layernorm(x, axis=-1)
    h = _gelu(torch.einsum('btd,de->bte', xc, w_up))
    u = h[..., :D].clone()
    g = _layernorm(h[..., D:], axis=-1)
    pad = K // 2
    gp = _pad(g, ((0, 0), (pad, pad), (0, 0)))
    conv = torch.zeros_like(g)
    for i in range(K):
        conv = conv + gp[:, i:i + T, :] * dw[i][None, None, :]
    yc = torch.einsum('btd,de->bte', u * conv, w_dn)
    merged = torch.concatenate([ya, yc], axis=-1)
    out = torch.einsum('btf,fd->btd', merged, w_merge)
    return x + out
```

```asm
; @launch grid=(256,1,1) block=(256,1,1) lds=163840
.amdgcn_target "amdgcn-amd-amdhsa--gfx950"
.text
.globl standalone__conformer_family_branchformer__speech_kernel
.p2align 8
.type standalone__conformer_family_branchformer__speech_kernel,@function
standalone__conformer_family_branchformer__speech_kernel:
    s_cmp_ge_u32 s2, 256
    s_cbranch_scc1 L_end
    s_load_dwordx16 s[56:71], s[0:1], 0
    s_load_dwordx8 s[72:79], s[0:1], 64
    v_mov_b32 v251, v0
    s_getpc_b64 s[42:43]
L_pc:
    s_sub_u32 s42, s42, L_pc-standalone__conformer_family_branchformer__speech_kernel
    s_subb_u32 s43, s43, 0
    s_lshr_b32 s44, s2, 3
    s_mul_i32 s44, s44, 3072
    v_subrev_u32 v13, 192, v251
    v_cmp_gt_u32 vcc, 24, v13
    v_lshlrev_b32 v13, 7, v13
    v_add_u32 v13, s44, v13
    v_min_u32 v13, L_end-standalone__conformer_family_branchformer__speech_kernel-4, v13
    s_and_saveexec_b64 s[44:45], vcc
    s_cbranch_execz L_nopf
    global_load_dword v250, v13, s[42:43]
L_nopf:
    s_mov_b64 exec, s[44:45]
    v_lshrrev_b32 v13, 6, v0
    v_cmp_gt_u32 vcc, 32, v0
    v_bfrev_b32 v14, 1
    v_lshlrev_b32 v15, 2, v0
    v_and_b32 v0, 63, v0
    v_readfirstlane_b32 s26, v13
    v_lshlrev_b32 v7, 4, v0
    v_cndmask_b32 v10, v14, v15, vcc
    s_and_b32 s29, s2, 7
    s_lshr_b32 s30, s2, 3
    s_and_b32 s28, s30, 3
    s_lshr_b32 s30, s30, 2
    s_lshl_b32 s34, s30, 2
    s_and_b32 s36, s29, 3
    s_lshl_b32 s36, s36, 3
    s_add_u32 s36, s36, s30
    s_lshr_b32 s29, s29, 2
    s_lshl_b32 s32, s29, 5
    s_add_u32 s32, s32, s36
    s_mov_b32 s6, s36
    s_mov_b32 s7, s32
    s_mul_i32 s37, s29, 125
    s_lshl_b32 s33, s26, 13
    v_add_u32 v1, s33, v7
    v_add_u32 v2, 4096, v1
    s_lshr_b32 s39, s6, 1
    s_lshl_b32 s39, s39, 3
    s_bfe_u32 s29, s2, 0x30003
    s_add_u32 s39, s39, s29
    s_cmp_lt_u32 s39, 125
    s_cselect_b32 s35, 0, 0x80000000
    s_min_u32 s39, s39, 124
    s_add_u32 s39, s39, s37
    s_lshl_b32 s39, s39, 15
    s_waitcnt lgkmcnt(0)
    s_mov_b32 s12, s56
    s_mov_b32 s13, s57
    s_mov_b32 s14, 8192000
    s_mov_b32 s15, 0x00020000
    s_add_u32 m0, s33, 0
    s_nop 0
    buffer_load_dwordx4 v1, s[12:15], s39 offen offset:0 lds
    buffer_load_dwordx4 v1, s[12:15], s39 offen offset:1024 lds
    buffer_load_dwordx4 v1, s[12:15], s39 offen offset:2048 lds
    buffer_load_dwordx4 v1, s[12:15], s39 offen offset:3072 lds
    s_add_u32 m0, s33, 4096
    s_nop 0
    buffer_load_dwordx4 v2, s[12:15], s39 offen offset:0 lds
    buffer_load_dwordx4 v2, s[12:15], s39 offen offset:1024 lds
    buffer_load_dwordx4 v2, s[12:15], s39 offen offset:2048 lds
    buffer_load_dwordx4 v2, s[12:15], s39 offen offset:3072 lds
    s_lshl_b32 s27, s36, 2
    s_add_u32 s27, s27, s26
    s_cmp_lt_u32 s27, 125
    s_cselect_b32 s31, 0, 0x80000000
    s_min_u32 s27, s27, 124
    s_add_u32 s27, s27, s37
    s_lshl_b32 s20, s28, 3
    s_lshr_b32 s30, 0x60412100, s20
    s_and_b32 s30, s30, 255
    s_add_u32 s30, s30, s37
    s_lshr_b32 s25, 0x1b1d1e1f, s20
    s_and_b32 s25, s25, 255
    s_lshl_b32 s20, s30, 15
    s_add_u32 s21, s20, 8388608
    v_and_b32 v13, 7, v0
    v_lshrrev_b32 v14, 3, v0
    v_lshlrev_b32 v8, 4, v14
    v_lshl_add_u32 v8, v13, 10, v8
    v_add_u32 v8, s33, v8
    v_lshrrev_b32 v15, 5, v0
    v_lshlrev_b32 v9, 11, v15
    v_and_b32 v15, 3, v14
    v_lshl_add_u32 v9, v15, 8, v9
    v_lshl_add_u32 v9, v13, 4, v9
    v_or_b32 v9, s35, v9
    s_and_b32 s42, s26, 1
    s_lshr_b32 s43, s26, 1
    s_lshl_b32 s30, s42, 7
    v_xor_b32 v16, s30, v7
    v_xor_b32 v17, 16, v16
    v_xor_b32 v18, 32, v16
    v_xor_b32 v19, 48, v16
    v_xor_b32 v20, 64, v16
    v_xor_b32 v21, 80, v16
    v_xor_b32 v22, 96, v16
    v_xor_b32 v23, 112, v16
    v_bfe_u32 v15, v0, 4, 1
    v_lshlrev_b32 v15, 2, v15
    v_xor_b32 v15, v15, v13
    v_lshlrev_b32 v6, 4, v15
    v_lshl_add_u32 v29, v14, 11, v6
    s_and_b32 s3, s2, 7
    s_lshl_b32 s3, s3, 5
    s_lshr_b32 s30, s2, 3
    s_add_u32 s3, s3, s30
    s_and_b32 s35, s2, 1
    s_lshl1_add_u32 s30, s30, s35
    s_add_u32 s30, s30, 192
    s_cmp_ge_u32 s3, 192
    s_cselect_b32 s3, s30, s3
    s_lshr_b32 s55, s3, 6
    s_and_b32 s52, s3, 7
    s_bfe_u32 s53, s3, 0x30003
    s_mov_b32 s96, s76
    s_mov_b32 s97, s77
    s_mov_b32 s98, 256
    s_mov_b32 s99, 0x00020000
    s_cmp_lt_u32 s2, 248
    s_cbranch_scc1 L_notag
    s_memrealtime s[100:101]
    v_mov_b32 v25, 0
    s_waitcnt lgkmcnt(0)
    s_or_b32 s100, s100, 1
    v_mov_b32 v24, s100
    s_mov_b64 exec, 1
    buffer_atomic_cmpswap v[24:25], v10, s[96:99], 0 offen sc1
    s_mov_b64 exec, -1
L_notag:
    s_mov_b32 s8, s78
    s_mov_b32 s9, s79
    s_mov_b32 s10, 117440512
    s_mov_b32 s11, 0x00020000
    s_mov_b32 s4, s56
    s_mov_b32 s5, s57
    s_mov_b32 s40, s78
    s_mov_b32 s41, s79
    s_mov_b32 s16, s74
    s_mov_b32 s17, s75
    s_mov_b32 s18, 8192000
    s_mov_b32 s19, 0x00020000
    s_mov_b32 s76, s66
    s_mov_b32 s77, s67
    s_mov_b32 s78, 1048576
    s_mov_b32 s79, 0x00020000
    s_lshr_b32 s30, s2, 6
    s_lshl2_add_u32 s30, s30, s26
    s_lshl_b32 s30, s30, 16
    s_lshl_b32 s29, s29, 7
    s_add_u32 s30, s30, s29
    s_add_u32 s30, s30, 1024
    v_and_b32 v27, 31, v0
    v_lshlrev_b32 v27, 11, v27
    v_add_u32 v27, s30, v27
    s_cmp_lg_u32 s26, 0
    s_cbranch_scc1 L_pw
    s_bfe_u32 s29, s2, 0x30003
    s_and_b32 s30, s2, 3
    s_lshl_b32 s30, s30, 2
    s_lshr_b32 s35, s2, 6
    s_add_u32 s30, s30, s35
    s_lshl_b32 s30, s30, 4
    s_and_b32 s35, s2, 4
    s_lshl1_add_u32 s30, s35, s30
    s_add_u32 s30, s30, s29
    s_lshl_b32 s35, s7, 2
    s_and_b32 s35, s35, 0xf8
    s_add_u32 s35, s35, s29
    v_min_u32 v30, 6, v14
    v_mov_b32 v31, s35
    v_cmp_eq_u32 vcc, 0, v30
    v_mov_b32 v252, s30
    v_mov_b32 v253, s3
    v_cndmask_b32 v31, v31, v252, vcc
    v_cmp_eq_u32 vcc, 6, v30
    v_lshlrev_b32 v30, 15, v30
    v_lshl_add_u32 v30, v13, 4, v30
    v_cndmask_b32 v31, v31, v253, vcc
    v_lshl_add_u32 v30, v31, 7, v30
    v_mov_b32 v252, 0
    v_mov_b32 v253, 0
    v_mov_b32 v254, 0
    v_mov_b32 v255, 0
    s_mov_b32 s30, 80740352
    buffer_store_dwordx4 v[252:255], v30, s[8:11], s30 offen sc1
L_pw:
    s_cmp_eq_u32 s55, 3
    s_cbranch_scc1 L_i3
    s_cmp_eq_u32 s55, 1
    s_cbranch_scc1 L_i1
    s_cmp_eq_u32 s55, 0
    s_cselect_b32 s44, s64, s70
    s_cselect_b32 s45, s65, s71
    s_cselect_b32 s29, 0, 524288
    s_mov_b32 s46, 524288
    s_mov_b32 s47, 0x20000
    s_mov_b32 s48, s72
    s_mov_b32 s49, s73
    s_mov_b32 s50, 1048576
    s_mov_b32 s51, 0x00020000
    s_lshl_b32 s30, s53, 7
    s_add_u32 s29, s29, s30
    v_lshl_add_u32 v12, v14, 10, v6
    s_mul_i32 s30, s26, 131072
    s_add_u32 s30, s30, s29
    s_mul_i32 s35, s26, 16384
    s_add_u32 m0, s35, 98304
    s_nop 0
    buffer_load_dwordx4 v12, s[48:51], s30 offen lds
    s_add_u32 m0, s35, 99328
    s_add_u32 s30, s30, 8192
    buffer_load_dwordx4 v12, s[48:51], s30 offen lds
    s_add_u32 m0, s35, 100352
    s_add_u32 s30, s30, 8192
    buffer_load_dwordx4 v12, s[48:51], s30 offen lds
    s_add_u32 m0, s35, 101376
    s_add_u32 s30, s30, 8192
    buffer_load_dwordx4 v12, s[48:51], s30 offen lds
    s_add_u32 m0, s35, 102400
    s_add_u32 s30, s30, 8192
    buffer_load_dwordx4 v12, s[48:51], s30 offen lds
    s_add_u32 m0, s35, 103424
    s_add_u32 s30, s30, 8192
    buffer_load_dwordx4 v12, s[48:51], s30 offen lds
    s_add_u32 m0, s35, 104448
    s_add_u32 s30, s30, 8192
    buffer_load_dwordx4 v12, s[48:51], s30 offen lds
    s_add_u32 m0, s35, 105472
    s_add_u32 s30, s30, 8192
    buffer_load_dwordx4 v12, s[48:51], s30 offen lds
    s_add_u32 m0, s35, 106496
    s_add_u32 s30, s30, 8192
    buffer_load_dwordx4 v12, s[48:51], s30 offen lds
    s_add_u32 m0, s35, 107520
    s_add_u32 s30, s30, 8192
    buffer_load_dwordx4 v12, s[48:51], s30 offen lds
    s_add_u32 m0, s35, 108544
    s_add_u32 s30, s30, 8192
    buffer_load_dwordx4 v12, s[48:51], s30 offen lds
    s_add_u32 m0, s35, 109568
    s_add_u32 s30, s30, 8192
    buffer_load_dwordx4 v12, s[48:51], s30 offen lds
    s_add_u32 m0, s35, 110592
    s_add_u32 s30, s30, 8192
    buffer_load_dwordx4 v12, s[48:51], s30 offen lds
    s_add_u32 m0, s35, 111616
    s_add_u32 s30, s30, 8192
    buffer_load_dwordx4 v12, s[48:51], s30 offen lds
    s_add_u32 m0, s35, 112640
    s_add_u32 s30, s30, 8192
    buffer_load_dwordx4 v12, s[48:51], s30 offen lds
    s_add_u32 m0, s35, 113664
    s_add_u32 s30, s30, 8192
    buffer_load_dwordx4 v12, s[48:51], s30 offen lds
    buffer_load_dword v26, v27, s[76:79], 0 offen
    s_waitcnt vmcnt(17)
    s_branch L_ln
L_i1:
    s_mov_b32 s44, s58
    s_mov_b32 s45, s59
    s_mov_b32 s46, 524288
    s_mov_b32 s47, 0x00020000
    s_mov_b32 s48, s60
    s_mov_b32 s49, s61
    s_mov_b32 s50, 524288
    s_mov_b32 s51, 0x00020000
    s_lshl_b32 s29, s53, 16
    s_lshl_b32 s35, s26, 14
    s_add_u32 s30, s29, s35
    s_add_u32 m0, s35, 98304
    s_nop 0
    buffer_load_dwordx4 v16, s[48:51], s30 offen offset:0 lds
    buffer_load_dwordx4 v17, s[48:51], s30 offen offset:1024 lds
    buffer_load_dwordx4 v18, s[48:51], s30 offen offset:2048 lds
    buffer_load_dwordx4 v19, s[48:51], s30 offen offset:3072 lds
    s_add_u32 m0, s35, 102400
    s_add_u32 s30, s30, 4096
    buffer_load_dwordx4 v16, s[48:51], s30 offen offset:0 lds
    buffer_load_dwordx4 v17, s[48:51], s30 offen offset:1024 lds
    buffer_load_dwordx4 v18, s[48:51], s30 offen offset:2048 lds
    buffer_load_dwordx4 v19, s[48:51], s30 offen offset:3072 lds
    s_add_u32 m0, s35, 106496
    s_add_u32 s30, s30, 4096
    buffer_load_dwordx4 v20, s[48:51], s30 offen offset:0 lds
    buffer_load_dwordx4 v21, s[48:51], s30 offen offset:1024 lds
    buffer_load_dwordx4 v22, s[48:51], s30 offen offset:2048 lds
    buffer_load_dwordx4 v23, s[48:51], s30 offen offset:3072 lds
    s_add_u32 m0, s35, 110592
    s_add_u32 s30, s30, 4096
    buffer_load_dwordx4 v20, s[48:51], s30 offen offset:0 lds
    buffer_load_dwordx4 v21, s[48:51], s30 offen offset:1024 lds
    buffer_load_dwordx4 v22, s[48:51], s30 offen offset:2048 lds
    buffer_load_dwordx4 v23, s[48:51], s30 offen offset:3072 lds
    buffer_load_dword v26, v27, s[76:79], 0 offen
    s_waitcnt vmcnt(17)
    s_branch L_ln
L_i3:
    s_mov_b32 s44, s62
    s_mov_b32 s45, s63
    s_mov_b32 s46, 524288
    s_mov_b32 s47, 0x00020000
    s_cmp_ge_u32 s3, 208
    s_cbranch_scc1 L_i5
    buffer_load_dword v26, v27, s[76:79], 0 offen
    s_waitcnt vmcnt(1)
    s_branch L_ln
L_i5:
    s_mov_b32 s48, s68
    s_mov_b32 s49, s69
    s_mov_b32 s50, 31744
    s_mov_b32 s51, 0x00020000
    s_mov_b32 s46, 0
    s_sub_u32 s54, s3, 208
    s_lshl2_add_u32 s54, s54, s26
    s_min_u32 s54, s54, 159
    v_bfe_u32 v15, v0, 4, 2
    v_bfe_u32 v12, v0, 2, 2
    v_lshl_add_u32 v15, v15, 3, v12
    v_lshlrev_b32 v15, 1, v15
    v_and_b32 v12, 3, v0
    v_add_u32 v12, 1, v12
    v_lshlrev_b32 v12, 10, v12
    v_sub_u32 v15, v15, v12
    s_mul_i32 s30, s54, 52429
    s_lshr_b32 s30, s30, 18
    s_mul_i32 s35, s30, 5
    s_sub_u32 s29, s54, s35
    s_lshl_b32 s29, s29, 13
    s_lshr_b32 s35, s30, 1
    s_lshl_b32 s35, s35, 6
    s_add_u32 s29, s29, s35
    s_and_b32 s30, s30, 1
    s_lshl_b32 s30, s30, 3
    s_add_u32 s29, s29, s30
    v_add_u32 v12, s29, v15
    buffer_load_ushort v32, v12, s[48:51], 0 offen
    v_add_u32 v12, 1024, v12
    buffer_load_ushort v33, v12, s[48:51], 0 offen
    v_add_u32 v12, 1024, v12
    buffer_load_ushort v34, v12, s[48:51], 0 offen
    v_add_u32 v12, 1024, v12
    buffer_load_ushort v35, v12, s[48:51], 0 offen
    v_add_u32 v12, 1024, v12
    buffer_load_ushort v36, v12, s[48:51], 0 offen
    v_add_u32 v12, 1024, v12
    buffer_load_ushort v37, v12, s[48:51], 0 offen
    v_add_u32 v12, 1024, v12
    buffer_load_ushort v38, v12, s[48:51], 0 offen
    v_add_u32 v12, 1024, v12
    buffer_load_ushort v39, v12, s[48:51], 0 offen
    buffer_load_dword v26, v27, s[76:79], 0 offen
    s_waitcnt vmcnt(9)
L_ln:
    s_lshl_b32 s35, s26, 14
    s_lshl_b32 s30, s52, 16
    s_add_u32 s30, s30, s35
    ds_read_b128 v[64:67], v8 offset:0
    ds_read_b128 v[68:71], v8 offset:128
    ds_read_b128 v[72:75], v8 offset:256
    ds_read_b128 v[76:79], v8 offset:384
    ds_read_b128 v[80:83], v8 offset:512
    ds_read_b128 v[84:87], v8 offset:640
    ds_read_b128 v[88:91], v8 offset:768
    ds_read_b128 v[92:95], v8 offset:896
    v_mov_b32 v168, 0
    v_mov_b32 v169, 0
    v_mov_b32 v170, 0
    v_mov_b32 v171, 0
    s_waitcnt lgkmcnt(7)
    v_lshlrev_b32 v96, 16, v64
    v_and_b32 v97, 0xffff0000, v64
    v_lshlrev_b32 v98, 16, v65
    v_and_b32 v99, 0xffff0000, v65
    v_lshlrev_b32 v100, 16, v66
    v_and_b32 v101, 0xffff0000, v66
    v_lshlrev_b32 v102, 16, v67
    v_and_b32 v103, 0xffff0000, v67
    s_add_u32 m0, s35, 32768
    s_nop 0
    buffer_load_dwordx4 v16, s[44:47], s30 offen offset:0 lds
    v_pk_add_f32 v[168:169], v[168:169], v[96:97]
    v_pk_add_f32 v[170:171], v[170:171], v[98:99]
    v_pk_add_f32 v[168:169], v[168:169], v[100:101]
    v_pk_add_f32 v[170:171], v[170:171], v[102:103]
    s_waitcnt lgkmcnt(6)
    v_lshlrev_b32 v104, 16, v68
    v_and_b32 v105, 0xffff0000, v68
    v_lshlrev_b32 v106, 16, v69
    v_and_b32 v107, 0xffff0000, v69
    buffer_load_dwordx4 v17, s[44:47], s30 offen offset:1024 lds
    v_lshlrev_b32 v108, 16, v70
    v_and_b32 v109, 0xffff0000, v70
    v_lshlrev_b32 v110, 16, v71
    v_and_b32 v111, 0xffff0000, v71
    v_pk_add_f32 v[168:169], v[168:169], v[104:105]
    v_pk_add_f32 v[170:171], v[170:171], v[106:107]
    v_pk_add_f32 v[168:169], v[168:169], v[108:109]
    v_pk_add_f32 v[170:171], v[170:171], v[110:111]
    buffer_load_dwordx4 v18, s[44:47], s30 offen offset:2048 lds
    s_waitcnt lgkmcnt(5)
    v_lshlrev_b32 v112, 16, v72
    v_and_b32 v113, 0xffff0000, v72
    v_lshlrev_b32 v114, 16, v73
    v_and_b32 v115, 0xffff0000, v73
    v_lshlrev_b32 v116, 16, v74
    v_and_b32 v117, 0xffff0000, v74
    v_lshlrev_b32 v118, 16, v75
    v_and_b32 v119, 0xffff0000, v75
    buffer_load_dwordx4 v19, s[44:47], s30 offen offset:3072 lds
    v_pk_add_f32 v[168:169], v[168:169], v[112:113]
    v_pk_add_f32 v[170:171], v[170:171], v[114:115]
    v_pk_add_f32 v[168:169], v[168:169], v[116:117]
    v_pk_add_f32 v[170:171], v[170:171], v[118:119]
    s_waitcnt lgkmcnt(4)
    v_lshlrev_b32 v120, 16, v76
    v_and_b32 v121, 0xffff0000, v76
    v_lshlrev_b32 v122, 16, v77
    v_and_b32 v123, 0xffff0000, v77
    s_add_u32 m0, s35, 36864
    s_add_u32 s30, s30, 4096
    buffer_load_dwordx4 v16, s[44:47], s30 offen offset:0 lds
    v_lshlrev_b32 v124, 16, v78
    v_and_b32 v125, 0xffff0000, v78
    v_lshlrev_b32 v126, 16, v79
    v_and_b32 v127, 0xffff0000, v79
    v_pk_add_f32 v[168:169], v[168:169], v[120:121]
    v_pk_add_f32 v[170:171], v[170:171], v[122:123]
    v_pk_add_f32 v[168:169], v[168:169], v[124:125]
    v_pk_add_f32 v[170:171], v[170:171], v[126:127]
    buffer_load_dwordx4 v17, s[44:47], s30 offen offset:1024 lds
    s_waitcnt lgkmcnt(3)
    v_lshlrev_b32 v128, 16, v80
    v_and_b32 v129, 0xffff0000, v80
    v_lshlrev_b32 v130, 16, v81
    v_and_b32 v131, 0xffff0000, v81
    v_lshlrev_b32 v132, 16, v82
    v_and_b32 v133, 0xffff0000, v82
    v_lshlrev_b32 v134, 16, v83
    v_and_b32 v135, 0xffff0000, v83
    buffer_load_dwordx4 v18, s[44:47], s30 offen offset:2048 lds
    v_pk_add_f32 v[168:169], v[168:169], v[128:129]
    v_pk_add_f32 v[170:171], v[170:171], v[130:131]
    v_pk_add_f32 v[168:169], v[168:169], v[132:133]
    v_pk_add_f32 v[170:171], v[170:171], v[134:135]
    s_waitcnt lgkmcnt(2)
    v_lshlrev_b32 v136, 16, v84
    v_and_b32 v137, 0xffff0000, v84
    v_lshlrev_b32 v138, 16, v85
    v_and_b32 v139, 0xffff0000, v85
    buffer_load_dwordx4 v19, s[44:47], s30 offen offset:3072 lds
    v_lshlrev_b32 v140, 16, v86
    v_and_b32 v141, 0xffff0000, v86
    v_lshlrev_b32 v142, 16, v87
    v_and_b32 v143, 0xffff0000, v87
    v_pk_add_f32 v[168:169], v[168:169], v[136:137]
    v_pk_add_f32 v[170:171], v[170:171], v[138:139]
    v_pk_add_f32 v[168:169], v[168:169], v[140:141]
    v_pk_add_f32 v[170:171], v[170:171], v[142:143]
    s_add_u32 m0, s35, 40960
    s_add_u32 s30, s30, 4096
    buffer_load_dwordx4 v20, s[44:47], s30 offen offset:0 lds
    s_waitcnt lgkmcnt(1)
    v_lshlrev_b32 v144, 16, v88
    v_and_b32 v145, 0xffff0000, v88
    v_lshlrev_b32 v146, 16, v89
    v_and_b32 v147, 0xffff0000, v89
    v_lshlrev_b32 v148, 16, v90
    v_and_b32 v149, 0xffff0000, v90
    v_lshlrev_b32 v150, 16, v91
    v_and_b32 v151, 0xffff0000, v91
    buffer_load_dwordx4 v21, s[44:47], s30 offen offset:1024 lds
    v_pk_add_f32 v[168:169], v[168:169], v[144:145]
    v_pk_add_f32 v[170:171], v[170:171], v[146:147]
    v_pk_add_f32 v[168:169], v[168:169], v[148:149]
    v_pk_add_f32 v[170:171], v[170:171], v[150:151]
    s_waitcnt lgkmcnt(0)
    v_lshlrev_b32 v152, 16, v92
    v_and_b32 v153, 0xffff0000, v92
    v_lshlrev_b32 v154, 16, v93
    v_and_b32 v155, 0xffff0000, v93
    buffer_load_dwordx4 v22, s[44:47], s30 offen offset:2048 lds
    v_lshlrev_b32 v156, 16, v94
    v_and_b32 v157, 0xffff0000, v94
    v_lshlrev_b32 v158, 16, v95
    v_and_b32 v159, 0xffff0000, v95
    v_pk_add_f32 v[168:169], v[168:169], v[152:153]
    v_pk_add_f32 v[170:171], v[170:171], v[154:155]
    v_pk_add_f32 v[168:169], v[168:169], v[156:157]
    v_pk_add_f32 v[170:171], v[170:171], v[158:159]
    buffer_load_dwordx4 v23, s[44:47], s30 offen offset:3072 lds
    v_pk_add_f32 v[168:169], v[168:169], v[170:171]
    v_add_f32 v172, v168, v169
    s_nop 1
    v_add_f32_dpp v172, v172, v172 row_ror:8 row_mask:0xf bank_mask:0xf
    v_mov_b32 v15, v172
    s_nop 1
    v_permlane16_swap_b32 v15, v172
    s_nop 1
    v_add_f32 v172, v172, v15
    v_mov_b32 v15, v172
    s_nop 1
    v_permlane32_swap_b32 v15, v172
    s_nop 1
    v_add_f32 v172, v172, v15
    v_mul_f32 v172, 0xbb000000, v172
    v_mov_b32 v168, 0
    v_mov_b32 v169, 0
    v_mov_b32 v170, 0
    v_mov_b32 v171, 0
    v_pk_add_f32 v[96:97], v[96:97], v[172:173] op_sel_hi:[1,0]
    v_pk_add_f32 v[98:99], v[98:99], v[172:173] op_sel_hi:[1,0]
    v_pk_fma_f32 v[170:171], v[96:97], v[96:97], v[170:171]
    v_pk_add_f32 v[100:101], v[100:101], v[172:173] op_sel_hi:[1,0]
    v_pk_fma_f32 v[168:169], v[98:99], v[98:99], v[168:169]
    v_pk_add_f32 v[102:103], v[102:103], v[172:173] op_sel_hi:[1,0]
    v_pk_fma_f32 v[170:171], v[100:101], v[100:101], v[170:171]
    v_pk_add_f32 v[104:105], v[104:105], v[172:173] op_sel_hi:[1,0]
    s_add_u32 m0, s35, 45056
    s_add_u32 s30, s30, 4096
    buffer_load_dwordx4 v20, s[44:47], s30 offen offset:0 lds
    v_pk_fma_f32 v[168:169], v[102:103], v[102:103], v[168:169]
    v_pk_add_f32 v[106:107], v[106:107], v[172:173] op_sel_hi:[1,0]
    v_pk_fma_f32 v[170:171], v[104:105], v[104:105], v[170:171]
    v_pk_add_f32 v[108:109], v[108:109], v[172:173] op_sel_hi:[1,0]
    v_pk_fma_f32 v[168:169], v[106:107], v[106:107], v[168:169]
    v_pk_add_f32 v[110:111], v[110:111], v[172:173] op_sel_hi:[1,0]
    v_pk_fma_f32 v[170:171], v[108:109], v[108:109], v[170:171]
    v_pk_add_f32 v[112:113], v[112:113], v[172:173] op_sel_hi:[1,0]
    buffer_load_dwordx4 v21, s[44:47], s30 offen offset:1024 lds
    v_pk_fma_f32 v[168:169], v[110:111], v[110:111], v[168:169]
    v_pk_add_f32 v[114:115], v[114:115], v[172:173] op_sel_hi:[1,0]
    v_pk_fma_f32 v[170:171], v[112:113], v[112:113], v[170:171]
    v_pk_add_f32 v[116:117], v[116:117], v[172:173] op_sel_hi:[1,0]
    v_pk_fma_f32 v[168:169], v[114:115], v[114:115], v[168:169]
    v_pk_add_f32 v[118:119], v[118:119], v[172:173] op_sel_hi:[1,0]
    v_pk_fma_f32 v[170:171], v[116:117], v[116:117], v[170:171]
    v_pk_add_f32 v[120:121], v[120:121], v[172:173] op_sel_hi:[1,0]
    buffer_load_dwordx4 v22, s[44:47], s30 offen offset:2048 lds
    v_pk_fma_f32 v[168:169], v[118:119], v[118:119], v[168:169]
    v_pk_add_f32 v[122:123], v[122:123], v[172:173] op_sel_hi:[1,0]
    v_pk_fma_f32 v[170:171], v[120:121], v[120:121], v[170:171]
    v_pk_add_f32 v[124:125], v[124:125], v[172:173] op_sel_hi:[1,0]
    v_pk_fma_f32 v[168:169], v[122:123], v[122:123], v[168:169]
    v_pk_add_f32 v[126:127], v[126:127], v[172:173] op_sel_hi:[1,0]
    v_pk_fma_f32 v[170:171], v[124:125], v[124:125], v[170:171]
    v_pk_add_f32 v[128:129], v[128:129], v[172:173] op_sel_hi:[1,0]
    buffer_load_dwordx4 v23, s[44:47], s30 offen offset:3072 lds
    v_pk_fma_f32 v[168:169], v[126:127], v[126:127], v[168:169]
    v_pk_add_f32 v[130:131], v[130:131], v[172:173] op_sel_hi:[1,0]
    v_pk_fma_f32 v[170:171], v[128:129], v[128:129], v[170:171]
    v_pk_add_f32 v[132:133], v[132:133], v[172:173] op_sel_hi:[1,0]
    v_pk_fma_f32 v[168:169], v[130:131], v[130:131], v[168:169]
    v_pk_add_f32 v[134:135], v[134:135], v[172:173] op_sel_hi:[1,0]
    v_pk_fma_f32 v[170:171], v[132:133], v[132:133], v[170:171]
    v_pk_add_f32 v[136:137], v[136:137], v[172:173] op_sel_hi:[1,0]
    v_pk_fma_f32 v[168:169], v[134:135], v[134:135], v[168:169]
    v_pk_add_f32 v[138:139], v[138:139], v[172:173] op_sel_hi:[1,0]
    v_pk_fma_f32 v[170:171], v[136:137], v[136:137], v[170:171]
    v_pk_add_f32 v[140:141], v[140:141], v[172:173] op_sel_hi:[1,0]
    v_pk_fma_f32 v[168:169], v[138:139], v[138:139], v[168:169]
    v_pk_add_f32 v[142:143], v[142:143], v[172:173] op_sel_hi:[1,0]
    v_pk_fma_f32 v[170:171], v[140:141], v[140:141], v[170:171]
    v_pk_add_f32 v[144:145], v[144:145], v[172:173] op_sel_hi:[1,0]
    v_pk_fma_f32 v[168:169], v[142:143], v[142:143], v[168:169]
    v_pk_add_f32 v[146:147], v[146:147], v[172:173] op_sel_hi:[1,0]
    v_pk_fma_f32 v[170:171], v[144:145], v[144:145], v[170:171]
    v_pk_add_f32 v[148:149], v[148:149], v[172:173] op_sel_hi:[1,0]
    v_pk_fma_f32 v[168:169], v[146:147], v[146:147], v[168:169]
    v_pk_add_f32 v[150:151], v[150:151], v[172:173] op_sel_hi:[1,0]
    v_pk_fma_f32 v[170:171], v[148:149], v[148:149], v[170:171]
    v_pk_add_f32 v[152:153], v[152:153], v[172:173] op_sel_hi:[1,0]
    v_pk_fma_f32 v[168:169], v[150:151], v[150:151], v[168:169]
    v_pk_add_f32 v[154:155], v[154:155], v[172:173] op_sel_hi:[1,0]
    v_pk_fma_f32 v[170:171], v[152:153], v[152:153], v[170:171]
    v_pk_add_f32 v[156:157], v[156:157], v[172:173] op_sel_hi:[1,0]
    v_pk_fma_f32 v[168:169], v[154:155], v[154:155], v[168:169]
    v_pk_add_f32 v[158:159], v[158:159], v[172:173] op_sel_hi:[1,0]
    v_pk_fma_f32 v[170:171], v[156:157], v[156:157], v[170:171]
    v_pk_fma_f32 v[168:169], v[158:159], v[158:159], v[168:169]
    v_pk_add_f32 v[168:169], v[168:169], v[170:171]
    v_add_f32 v174, v168, v169
    s_nop 1
    v_add_f32_dpp v174, v174, v174 row_ror:8 row_mask:0xf bank_mask:0xf
    v_mov_b32 v15, v174
    s_nop 1
    v_permlane16_swap_b32 v15, v174
    s_nop 1
    v_add_f32 v174, v174, v15
    v_mov_b32 v15, v174
    s_nop 1
    v_permlane32_swap_b32 v15, v174
    s_nop 1
    v_add_f32 v174, v174, v15
    v_mov_b32 v15, 0x3727c5ac
    v_fmac_f32 v15, 0x3b000000, v174
    v_rsq_f32 v174, v15
    s_lshl_b32 s29, s43, 10
    s_lshl_b32 s30, s42, 7
    s_add_u32 s29, s29, s30
    s_add_u32 s29, s29, s39
    v_pk_mul_f32 v[96:97], v[96:97], v[174:175] op_sel_hi:[1,0]
    v_pk_mul_f32 v[98:99], v[98:99], v[174:175] op_sel_hi:[1,0]
    v_pk_mul_f32 v[100:101], v[100:101], v[174:175] op_sel_hi:[1,0]
    v_pk_mul_f32 v[102:103], v[102:103], v[174:175] op_sel_hi:[1,0]
    v_cvt_pk_bf16_f32 v64, v96, v97
    v_cvt_pk_bf16_f32 v65, v98, v99
    v_cvt_pk_bf16_f32 v66, v100, v101
    v_cvt_pk_bf16_f32 v67, v102, v103
    buffer_store_dwordx4 v[64:67], v9, s[8:11], s29 offen sc1
    v_pk_mul_f32 v[104:105], v[104:105], v[174:175] op_sel_hi:[1,0]
    v_pk_mul_f32 v[106:107], v[106:107], v[174:175] op_sel_hi:[1,0]
    v_pk_mul_f32 v[108:109], v[108:109], v[174:175] op_sel_hi:[1,0]
    v_pk_mul_f32 v[110:111], v[110:111], v[174:175] op_sel_hi:[1,0]
    v_cvt_pk_bf16_f32 v68, v104, v105
    v_cvt_pk_bf16_f32 v69, v106, v107
    v_cvt_pk_bf16_f32 v70, v108, v109
    v_cvt_pk_bf16_f32 v71, v110, v111
    s_add_u32 s29, s29, 4096
    buffer_store_dwordx4 v[68:71], v9, s[8:11], s29 offen sc1
    v_pk_mul_f32 v[112:113], v[112:113], v[174:175] op_sel_hi:[1,0]
    v_pk_mul_f32 v[114:115], v[114:115], v[174:175] op_sel_hi:[1,0]
    v_pk_mul_f32 v[116:117], v[116:117], v[174:175] op_sel_hi:[1,0]
    v_pk_mul_f32 v[118:119], v[118:119], v[174:175] op_sel_hi:[1,0]
    v_cvt_pk_bf16_f32 v72, v112, v113
    v_cvt_pk_bf16_f32 v73, v114, v115
    v_cvt_pk_bf16_f32 v74, v116, v117
    v_cvt_pk_bf16_f32 v75, v118, v119
    s_add_u32 s29, s29, 4096
    buffer_store_dwordx4 v[72:75], v9, s[8:11], s29 offen sc1
    v_pk_mul_f32 v[120:121], v[120:121], v[174:175] op_sel_hi:[1,0]
    v_pk_mul_f32 v[122:123], v[122:123], v[174:175] op_sel_hi:[1,0]
    v_pk_mul_f32 v[124:125], v[124:125], v[174:175] op_sel_hi:[1,0]
    v_pk_mul_f32 v[126:127], v[126:127], v[174:175] op_sel_hi:[1,0]
    v_cvt_pk_bf16_f32 v76, v120, v121
    v_cvt_pk_bf16_f32 v77, v122, v123
    v_cvt_pk_bf16_f32 v78, v124, v125
    v_cvt_pk_bf16_f32 v79, v126, v127
    s_add_u32 s29, s29, 4096
    buffer_store_dwordx4 v[76:79], v9, s[8:11], s29 offen sc1
    v_pk_mul_f32 v[128:129], v[128:129], v[174:175] op_sel_hi:[1,0]
    v_pk_mul_f32 v[130:131], v[130:131], v[174:175] op_sel_hi:[1,0]
    v_pk_mul_f32 v[132:133], v[132:133], v[174:175] op_sel_hi:[1,0]
    v_pk_mul_f32 v[134:135], v[134:135], v[174:175] op_sel_hi:[1,0]
    v_cvt_pk_bf16_f32 v80, v128, v129
    v_cvt_pk_bf16_f32 v81, v130, v131
    v_cvt_pk_bf16_f32 v82, v132, v133
    v_cvt_pk_bf16_f32 v83, v134, v135
    s_add_u32 s29, s29, 4096
    buffer_store_dwordx4 v[80:83], v9, s[8:11], s29 offen sc1
    v_pk_mul_f32 v[136:137], v[136:137], v[174:175] op_sel_hi:[1,0]
    v_pk_mul_f32 v[138:139], v[138:139], v[174:175] op_sel_hi:[1,0]
    v_pk_mul_f32 v[140:141], v[140:141], v[174:175] op_sel_hi:[1,0]
    v_pk_mul_f32 v[142:143], v[142:143], v[174:175] op_sel_hi:[1,0]
    v_cvt_pk_bf16_f32 v84, v136, v137
    v_cvt_pk_bf16_f32 v85, v138, v139
    v_cvt_pk_bf16_f32 v86, v140, v141
    v_cvt_pk_bf16_f32 v87, v142, v143
    s_add_u32 s29, s29, 4096
    buffer_store_dwordx4 v[84:87], v9, s[8:11], s29 offen sc1
    v_pk_mul_f32 v[144:145], v[144:145], v[174:175] op_sel_hi:[1,0]
    v_pk_mul_f32 v[146:147], v[146:147], v[174:175] op_sel_hi:[1,0]
    v_pk_mul_f32 v[148:149], v[148:149], v[174:175] op_sel_hi:[1,0]
    v_pk_mul_f32 v[150:151], v[150:151], v[174:175] op_sel_hi:[1,0]
    v_cvt_pk_bf16_f32 v88, v144, v145
    v_cvt_pk_bf16_f32 v89, v146, v147
    v_cvt_pk_bf16_f32 v90, v148, v149
    v_cvt_pk_bf16_f32 v91, v150, v151
    s_add_u32 s29, s29, 4096
    buffer_store_dwordx4 v[88:91], v9, s[8:11], s29 offen sc1
    v_pk_mul_f32 v[152:153], v[152:153], v[174:175] op_sel_hi:[1,0]
    v_pk_mul_f32 v[154:155], v[154:155], v[174:175] op_sel_hi:[1,0]
    v_pk_mul_f32 v[156:157], v[156:157], v[174:175] op_sel_hi:[1,0]
    v_pk_mul_f32 v[158:159], v[158:159], v[174:175] op_sel_hi:[1,0]
    v_cvt_pk_bf16_f32 v92, v152, v153
    v_cvt_pk_bf16_f32 v93, v154, v155
    v_cvt_pk_bf16_f32 v94, v156, v157
    v_cvt_pk_bf16_f32 v95, v158, v159
    s_add_u32 s29, s29, 4096
    buffer_store_dwordx4 v[92:95], v9, s[8:11], s29 offen sc1
    v_mov_b32 v25, 0
    buffer_load_dword v24, v25, s[96:99], 0 offen sc1
    v_and_b32 v13, 15, v0
    v_lshrrev_b32 v14, 4, v0
    v_bfe_u32 v15, v0, 2, 2
    v_and_b32 v12, 3, v0
    v_lshl_add_u32 v5, v15, 3, v12
    v_lshlrev_b32 v5, 10, v5
    v_xor_b32 v13, v13, v14
    v_lshl_add_u32 v5, v13, 4, v5
    s_lshl_b32 s29, s42, 15
    s_add_u32 s29, s29, 32768
    s_lshl_b32 s30, s43, 15
    s_add_u32 s30, s30, 98304
    v_xor_b32 v13, 0, v5
    v_add_u32 v160, s29, v13
    v_add_u32 v164, s30, v13
    v_xor_b32 v13, 64, v5
    v_add_u32 v161, s29, v13
    v_add_u32 v165, s30, v13
    v_xor_b32 v13, 128, v5
    v_add_u32 v162, s29, v13
    v_add_u32 v166, s30, v13
    v_xor_b32 v13, 192, v5
    v_add_u32 v163, s29, v13
    v_add_u32 v167, s30, v13
    v_bfe_u32 v13, v0, 3, 1
    v_lshl_add_u32 v13, v13, 2, v12
    v_lshlrev_b32 v6, 4, v13
    v_lshl_add_u32 v6, v15, 7, v6
    v_lshl_add_u32 v6, v14, 10, v6
    v_xor_b32 v28, 64, v6
    s_lshl_b32 s29, s43, 6
    v_xor_b32 v5, s29, v6
    v_add_u32 v5, 98304, v5
    s_waitcnt vmcnt(9)
    s_barrier
    s_bfe_u32 s64, s2, 0x30003
    s_lshl_b32 s72, s7, 2
    s_and_b32 s72, s72, 0xf8
    s_lshl_b32 s68, s72, 7
    s_add_u32 s72, s72, s64
    s_lshl_b32 s62, s26, 17
    s_lshl_b32 s30, s64, 7
    s_add_u32 s62, s62, s30
    s_add_u32 m0, s33, 0
    s_add_u32 s30, s62, 1024
    buffer_load_dwordx4 v29, s[76:79], s30 offen lds
    s_add_u32 m0, s33, 1024
    s_add_u32 s30, s62, 17408
    buffer_load_dwordx4 v29, s[76:79], s30 offen lds
    s_add_u32 m0, s33, 2048
    s_add_u32 s30, s62, 33792
    buffer_load_dwordx4 v29, s[76:79], s30 offen lds
    s_add_u32 m0, s33, 3072
    s_add_u32 s30, s62, 50176
    buffer_load_dwordx4 v29, s[76:79], s30 offen lds
    s_add_u32 m0, s33, 4096
    s_add_u32 s30, s62, 66560
    buffer_load_dwordx4 v29, s[76:79], s30 offen lds
    s_add_u32 m0, s33, 5120
    s_add_u32 s30, s62, 82944
    buffer_load_dwordx4 v29, s[76:79], s30 offen lds
    s_add_u32 m0, s33, 6144
    s_add_u32 s30, s62, 99328
    buffer_load_dwordx4 v29, s[76:79], s30 offen lds
    s_add_u32 m0, s33, 7168
    s_add_u32 s30, s62, 115712
    buffer_load_dwordx4 v29, s[76:79], s30 offen lds
    s_add_u32 s68, s68, 80904192
    v_and_b32 v11, 7, v0
    v_lshlrev_b32 v11, 7, v11
    s_cmp_eq_u32 s55, 3
    s_cbranch_scc1 L_c3
    s_lshl1_add_u32 s54, s53, s43
    s_lshl_b32 s54, s54, 15
    s_lshl1_add_u32 s29, s52, s42
    s_lshl_b32 s29, s29, 11
    s_add_u32 s54, s54, s29
    s_cmp_eq_u32 s55, 1
    s_cbranch_scc1 L_c1
    s_cmp_eq_u32 s55, 0
    s_cselect_b32 s29, 524288, 0
    s_add_u32 s54, s54, s29
    s_add_u32 s54, s54, 45088768
    ds_read_b128 v[64:67], v160 offset:0
    ds_read_b128 v[68:71], v160 offset:4096
    ds_read_b64_tr_b16 v[96:97], v5 offset:0
    ds_read_b64_tr_b16 v[98:99], v5 offset:512
    ds_read_b64_tr_b16 v[100:101], v5 offset:8
    ds_read_b64_tr_b16 v[102:103], v5 offset:520
    ds_read_b128 v[72:75], v161 offset:0
    ds_read_b128 v[76:79], v161 offset:4096
    ds_read_b64_tr_b16 v[104:105], v5 offset:4096
    ds_read_b64_tr_b16 v[106:107], v5 offset:4608
    ds_read_b64_tr_b16 v[108:109], v5 offset:4104
    ds_read_b64_tr_b16 v[110:111], v5 offset:4616
    ds_read_b128 v[80:83], v162 offset:0
    ds_read_b128 v[84:87], v162 offset:4096
    ds_read_b64_tr_b16 v[112:113], v5 offset:8192
    s_waitcnt lgkmcnt(13)
    ds_read_b64_tr_b16 v[114:115], v5 offset:8704
    ds_read_b64_tr_b16 v[116:117], v5 offset:8200
    s_waitcnt lgkmcnt(13)
    ds_read_b64_tr_b16 v[118:119], v5 offset:8712
    s_waitcnt lgkmcnt(12)
    v_mfma_f32_16x16x32_bf16 v[32:35], v[64:67], v[96:99], 0
    v_mfma_f32_16x16x32_bf16 v[36:39], v[68:71], v[96:99], 0
    ds_read_b128 v[88:91], v163 offset:0
    ds_read_b128 v[92:95], v163 offset:4096
    ds_read_b64_tr_b16 v[120:121], v5 offset:12288
    s_waitcnt lgkmcnt(13)
    ds_read_b64_tr_b16 v[122:123], v5 offset:12800
    ds_read_b64_tr_b16 v[124:125], v5 offset:12296
    s_waitcnt lgkmcnt(13)
    ds_read_b64_tr_b16 v[126:127], v5 offset:12808
    v_mfma_f32_16x16x32_bf16 v[40:43], v[64:67], v[100:103], 0
    v_mfma_f32_16x16x32_bf16 v[44:47], v[68:71], v[100:103], 0
    s_waitcnt lgkmcnt(12)
    v_mfma_f32_16x16x32_bf16 v[32:35], v[72:75], v[104:107], v[32:35]
    v_mfma_f32_16x16x32_bf16 v[36:39], v[76:79], v[104:107], v[36:39]
    ds_read_b128 v[64:67], v160 offset:256
    ds_read_b128 v[68:71], v160 offset:4352
    ds_read_b64_tr_b16 v[96:97], v5 offset:16384
    s_waitcnt lgkmcnt(13)
    ds_read_b64_tr_b16 v[98:99], v5 offset:16896
    ds_read_b64_tr_b16 v[100:101], v5 offset:16392
    s_waitcnt lgkmcnt(13)
    ds_read_b64_tr_b16 v[102:103], v5 offset:16904
    v_mfma_f32_16x16x32_bf16 v[40:43], v[72:75], v[108:111], v[40:43]
    v_mfma_f32_16x16x32_bf16 v[44:47], v[76:79], v[108:111], v[44:47]
    s_waitcnt lgkmcnt(12)
    v_mfma_f32_16x16x32_bf16 v[32:35], v[80:83], v[112:115], v[32:35]
    v_mfma_f32_16x16x32_bf16 v[36:39], v[84:87], v[112:115], v[36:39]
    ds_read_b128 v[72:75], v161 offset:256
    ds_read_b128 v[76:79], v161 offset:4352
    ds_read_b64_tr_b16 v[104:105], v5 offset:20480
    s_waitcnt lgkmcnt(13)
    ds_read_b64_tr_b16 v[106:107], v5 offset:20992
    ds_read_b64_tr_b16 v[108:109], v5 offset:20488
    s_waitcnt lgkmcnt(13)
    ds_read_b64_tr_b16 v[110:111], v5 offset:21000
    v_mfma_f32_16x16x32_bf16 v[40:43], v[80:83], v[116:119], v[40:43]
    v_mfma_f32_16x16x32_bf16 v[44:47], v[84:87], v[116:119], v[44:47]
    s_waitcnt lgkmcnt(12)
    v_mfma_f32_16x16x32_bf16 v[32:35], v[88:91], v[120:123], v[32:35]
    v_mfma_f32_16x16x32_bf16 v[36:39], v[92:95], v[120:123], v[36:39]
    ds_read_b128 v[80:83], v162 offset:256
    ds_read_b128 v[84:87], v162 offset:4352
    ds_read_b64_tr_b16 v[112:113], v5 offset:24576
    s_waitcnt lgkmcnt(13)
    ds_read_b64_tr_b16 v[114:115], v5 offset:25088
    ds_read_b64_tr_b16 v[116:117], v5 offset:24584
    s_waitcnt lgkmcnt(13)
    ds_read_b64_tr_b16 v[118:119], v5 offset:25096
    v_mfma_f32_16x16x32_bf16 v[40:43], v[88:91], v[124:127], v[40:43]
    v_mfma_f32_16x16x32_bf16 v[44:47], v[92:95], v[124:127], v[44:47]
    s_waitcnt lgkmcnt(12)
    v_mfma_f32_16x16x32_bf16 v[32:35], v[64:67], v[96:99], v[32:35]
    v_mfma_f32_16x16x32_bf16 v[36:39], v[68:71], v[96:99], v[36:39]
    ds_read_b128 v[88:91], v163 offset:256
    ds_read_b128 v[92:95], v163 offset:4352
    ds_read_b64_tr_b16 v[120:121], v5 offset:28672
    s_waitcnt lgkmcnt(13)
    ds_read_b64_tr_b16 v[122:123], v5 offset:29184
    ds_read_b64_tr_b16 v[124:125], v5 offset:28680
    s_waitcnt lgkmcnt(13)
    ds_read_b64_tr_b16 v[126:127], v5 offset:29192
    v_mfma_f32_16x16x32_bf16 v[40:43], v[64:67], v[100:103], v[40:43]
    v_mfma_f32_16x16x32_bf16 v[44:47], v[68:71], v[100:103], v[44:47]
    s_waitcnt lgkmcnt(12)
    v_mfma_f32_16x16x32_bf16 v[32:35], v[72:75], v[104:107], v[32:35]
    v_mfma_f32_16x16x32_bf16 v[36:39], v[76:79], v[104:107], v[36:39]
    ds_read_b128 v[64:67], v160 offset:512
    ds_read_b128 v[68:71], v160 offset:4608
    ds_read_b64_tr_b16 v[96:97], v5 offset:32768
    s_waitcnt lgkmcnt(13)
    ds_read_b64_tr_b16 v[98:99], v5 offset:33280
    ds_read_b64_tr_b16 v[100:101], v5 offset:32776
    s_waitcnt lgkmcnt(13)
    ds_read_b64_tr_b16 v[102:103], v5 offset:33288
    v_mfma_f32_16x16x32_bf16 v[40:43], v[72:75], v[108:111], v[40:43]
    v_mfma_f32_16x16x32_bf16 v[44:47], v[76:79], v[108:111], v[44:47]
    s_waitcnt lgkmcnt(12)
    v_mfma_f32_16x16x32_bf16 v[32:35], v[80:83], v[112:115], v[32:35]
    v_mfma_f32_16x16x32_bf16 v[36:39], v[84:87], v[112:115], v[36:39]
    ds_read_b128 v[72:75], v161 offset:512
    ds_read_b128 v[76:79], v161 offset:4608
    ds_read_b64_tr_b16 v[104:105], v5 offset:36864
    s_waitcnt lgkmcnt(13)
    ds_read_b64_tr_b16 v[106:107], v5 offset:37376
    ds_read_b64_tr_b16 v[108:109], v5 offset:36872
    s_waitcnt lgkmcnt(13)
    ds_read_b64_tr_b16 v[110:111], v5 offset:37384
    v_mfma_f32_16x16x32_bf16 v[40:43], v[80:83], v[116:119], v[40:43]
    v_mfma_f32_16x16x32_bf16 v[44:47], v[84:87], v[116:119], v[44:47]
    s_waitcnt vmcnt(8)
L_tag_1w:
    v_readfirstlane_b32 s75, v24
    s_nop 3
    s_cmp_eq_u32 s75, 0
    s_cbranch_scc1 L_tag_1s
    s_barrier
    s_lshl_b32 s35, s72, 7
    s_add_u32 s35, s35, 80904192
    v_mov_b32 v14, s75
    buffer_store_dword v14, v10, s[8:11], s35 offen sc1
    s_waitcnt lgkmcnt(12)
    v_mfma_f32_16x16x32_bf16 v[32:35], v[88:91], v[120:123], v[32:35]
    v_mfma_f32_16x16x32_bf16 v[36:39], v[92:95], v[120:123], v[36:39]
    ds_read_b128 v[80:83], v162 offset:512
    ds_read_b128 v[84:87], v162 offset:4608
    ds_read_b64_tr_b16 v[112:113], v5 offset:40960
    s_waitcnt lgkmcnt(13)
    ds_read_b64_tr_b16 v[114:115], v5 offset:41472
    ds_read_b64_tr_b16 v[116:117], v5 offset:40968
    s_waitcnt lgkmcnt(13)
    ds_read_b64_tr_b16 v[118:119], v5 offset:41480
    v_mfma_f32_16x16x32_bf16 v[40:43], v[88:91], v[124:127], v[40:43]
    v_mfma_f32_16x16x32_bf16 v[44:47], v[92:95], v[124:127], v[44:47]
    s_waitcnt lgkmcnt(12)
    v_mfma_f32_16x16x32_bf16 v[32:35], v[64:67], v[96:99], v[32:35]
    v_mfma_f32_16x16x32_bf16 v[36:39], v[68:71], v[96:99], v[36:39]
    ds_read_b128 v[88:91], v163 offset:512
    ds_read_b128 v[92:95], v163 offset:4608
    ds_read_b64_tr_b16 v[120:121], v5 offset:45056
    s_waitcnt lgkmcnt(13)
    ds_read_b64_tr_b16 v[122:123], v5 offset:45568
    ds_read_b64_tr_b16 v[124:125], v5 offset:45064
    s_waitcnt lgkmcnt(13)
    ds_read_b64_tr_b16 v[126:127], v5 offset:45576
    v_mfma_f32_16x16x32_bf16 v[40:43], v[64:67], v[100:103], v[40:43]
    v_mfma_f32_16x16x32_bf16 v[44:47], v[68:71], v[100:103], v[44:47]
    s_waitcnt lgkmcnt(12)
    v_mfma_f32_16x16x32_bf16 v[32:35], v[72:75], v[104:107], v[32:35]
    v_mfma_f32_16x16x32_bf16 v[36:39], v[76:79], v[104:107], v[36:39]
    ds_read_b128 v[64:67], v160 offset:768
    ds_read_b128 v[68:71], v160 offset:4864
    ds_read_b64_tr_b16 v[96:97], v5 offset:49152
    s_waitcnt lgkmcnt(13)
    ds_read_b64_tr_b16 v[98:99], v5 offset:49664
    ds_read_b64_tr_b16 v[100:101], v5 offset:49160
    s_waitcnt lgkmcnt(13)
    ds_read_b64_tr_b16 v[102:103], v5 offset:49672
    v_mfma_f32_16x16x32_bf16 v[40:43], v[72:75], v[108:111], v[40:43]
    v_mfma_f32_16x16x32_bf16 v[44:47], v[76:79], v[108:111], v[44:47]
    s_waitcnt lgkmcnt(12)
    v_mfma_f32_16x16x32_bf16 v[32:35], v[80:83], v[112:115], v[32:35]
    v_mfma_f32_16x16x32_bf16 v[36:39], v[84:87], v[112:115], v[36:39]
    ds_read_b128 v[72:75], v161 offset:768
    ds_read_b128 v[76:79], v161 offset:4864
    ds_read_b64_tr_b16 v[104:105], v5 offset:53248
    s_waitcnt lgkmcnt(13)
    ds_read_b64_tr_b16 v[106:107], v5 offset:53760
    ds_read_b64_tr_b16 v[108:109], v5 offset:53256
    s_waitcnt lgkmcnt(13)
    ds_read_b64_tr_b16 v[110:111], v5 offset:53768
    v_mfma_f32_16x16x32_bf16 v[40:43], v[80:83], v[116:119], v[40:43]
    v_mfma_f32_16x16x32_bf16 v[44:47], v[84:87], v[116:119], v[44:47]
    s_waitcnt lgkmcnt(12)
    v_mfma_f32_16x16x32_bf16 v[32:35], v[88:91], v[120:123], v[32:35]
    v_mfma_f32_16x16x32_bf16 v[36:39], v[92:95], v[120:123], v[36:39]
    ds_read_b128 v[80:83], v162 offset:768
    ds_read_b128 v[84:87], v162 offset:4864
    ds_read_b64_tr_b16 v[112:113], v5 offset:57344
    s_waitcnt lgkmcnt(13)
    ds_read_b64_tr_b16 v[114:115], v5 offset:57856
    ds_read_b64_tr_b16 v[116:117], v5 offset:57352
    s_waitcnt lgkmcnt(13)
    ds_read_b64_tr_b16 v[118:119], v5 offset:57864
    v_mfma_f32_16x16x32_bf16 v[40:43], v[88:91], v[124:127], v[40:43]
    v_mfma_f32_16x16x32_bf16 v[44:47], v[92:95], v[124:127], v[44:47]
    s_waitcnt lgkmcnt(12)
    v_mfma_f32_16x16x32_bf16 v[32:35], v[64:67], v[96:99], v[32:35]
    v_mfma_f32_16x16x32_bf16 v[36:39], v[68:71], v[96:99], v[36:39]
    ds_read_b128 v[88:91], v163 offset:768
    ds_read_b128 v[92:95], v163 offset:4864
    ds_read_b64_tr_b16 v[120:121], v5 offset:61440
    s_waitcnt lgkmcnt(13)
    ds_read_b64_tr_b16 v[122:123], v5 offset:61952
    ds_read_b64_tr_b16 v[124:125], v5 offset:61448
    s_waitcnt lgkmcnt(13)
    ds_read_b64_tr_b16 v[126:127], v5 offset:61960
    v_mfma_f32_16x16x32_bf16 v[40:43], v[64:67], v[100:103], v[40:43]
    v_mfma_f32_16x16x32_bf16 v[44:47], v[68:71], v[100:103], v[44:47]
    s_waitcnt lgkmcnt(12)
    v_mfma_f32_16x16x32_bf16 v[32:35], v[72:75], v[104:107], v[32:35]
    v_mfma_f32_16x16x32_bf16 v[36:39], v[76:79], v[104:107], v[36:39]
    v_mfma_f32_16x16x32_bf16 v[40:43], v[72:75], v[108:111], v[40:43]
    v_mfma_f32_16x16x32_bf16 v[44:47], v[76:79], v[108:111], v[44:47]
    s_waitcnt lgkmcnt(6)
    v_mfma_f32_16x16x32_bf16 v[32:35], v[80:83], v[112:115], v[32:35]
    v_mfma_f32_16x16x32_bf16 v[36:39], v[84:87], v[112:115], v[36:39]
    v_mfma_f32_16x16x32_bf16 v[40:43], v[80:83], v[116:119], v[40:43]
    v_mfma_f32_16x16x32_bf16 v[44:47], v[84:87], v[116:119], v[44:47]
    s_waitcnt lgkmcnt(0)
    v_mfma_f32_16x16x32_bf16 v[32:35], v[88:91], v[120:123], v[32:35]
    v_mfma_f32_16x16x32_bf16 v[36:39], v[92:95], v[120:123], v[36:39]
    v_mfma_f32_16x16x32_bf16 v[40:43], v[88:91], v[124:127], v[40:43]
    v_mfma_f32_16x16x32_bf16 v[44:47], v[92:95], v[124:127], v[44:47]
    buffer_load_dword v27, v11, s[8:11], s68 offen sc1
    s_nop 6
    s_branch L_out
L_c1:
    s_add_u32 s54, s54, 42991616
    ds_read_b128 v[64:67], v160 offset:0
    ds_read_b128 v[68:71], v160 offset:4096
    ds_read_b128 v[96:99], v164 offset:0
    ds_read_b128 v[100:103], v164 offset:4096
    ds_read_b128 v[72:75], v161 offset:0
    ds_read_b128 v[76:79], v161 offset:4096
    ds_read_b128 v[104:107], v165 offset:0
    ds_read_b128 v[108:111], v165 offset:4096
    ds_read_b128 v[80:83], v162 offset:0
    ds_read_b128 v[84:87], v162 offset:4096
    ds_read_b128 v[112:115], v166 offset:0
    ds_read_b128 v[116:119], v166 offset:4096
    s_waitcnt lgkmcnt(8)
    v_mfma_f32_16x16x32_bf16 v[32:35], v[64:67], v[96:99], 0
    v_mfma_f32_16x16x32_bf16 v[36:39], v[68:71], v[96:99], 0
    ds_read_b128 v[88:91], v163 offset:0
    ds_read_b128 v[92:95], v163 offset:4096
    ds_read_b128 v[120:123], v167 offset:0
    ds_read_b128 v[124:127], v167 offset:4096
    v_mfma_f32_16x16x32_bf16 v[40:43], v[64:67], v[100:103], 0
    v_mfma_f32_16x16x32_bf16 v[44:47], v[68:71], v[100:103], 0
    s_waitcnt lgkmcnt(8)
    v_mfma_f32_16x16x32_bf16 v[32:35], v[72:75], v[104:107], v[32:35]
    v_mfma_f32_16x16x32_bf16 v[36:39], v[76:79], v[104:107], v[36:39]
    ds_read_b128 v[64:67], v160 offset:256
    ds_read_b128 v[68:71], v160 offset:4352
    ds_read_b128 v[96:99], v164 offset:256
    ds_read_b128 v[100:103], v164 offset:4352
    v_mfma_f32_16x16x32_bf16 v[40:43], v[72:75], v[108:111], v[40:43]
    v_mfma_f32_16x16x32_bf16 v[44:47], v[76:79], v[108:111], v[44:47]
    s_waitcnt lgkmcnt(8)
    v_mfma_f32_16x16x32_bf16 v[32:35], v[80:83], v[112:115], v[32:35]
    v_mfma_f32_16x16x32_bf16 v[36:39], v[84:87], v[112:115], v[36:39]
    ds_read_b128 v[72:75], v161 offset:256
    ds_read_b128 v[76:79], v161 offset:4352
    ds_read_b128 v[104:107], v165 offset:256
    ds_read_b128 v[108:111], v165 offset:4352
    v_mfma_f32_16x16x32_bf16 v[40:43], v[80:83], v[116:119], v[40:43]
    v_mfma_f32_16x16x32_bf16 v[44:47], v[84:87], v[116:119], v[44:47]
    s_waitcnt lgkmcnt(8)
    v_mfma_f32_16x16x32_bf16 v[32:35], v[88:91], v[120:123], v[32:35]
    v_mfma_f32_16x16x32_bf16 v[36:39], v[92:95], v[120:123], v[36:39]
    ds_read_b128 v[80:83], v162 offset:256
    ds_read_b128 v[84:87], v162 offset:4352
    ds_read_b128 v[112:115], v166 offset:256
    ds_read_b128 v[116:119], v166 offset:4352
    v_mfma_f32_16x16x32_bf16 v[40:43], v[88:91], v[124:127], v[40:43]
    v_mfma_f32_16x16x32_bf16 v[44:47], v[92:95], v[124:127], v[44:47]
    s_waitcnt lgkmcnt(8)
    v_mfma_f32_16x16x32_bf16 v[32:35], v[64:67], v[96:99], v[32:35]
    v_mfma_f32_16x16x32_bf16 v[36:39], v[68:71], v[96:99], v[36:39]
    ds_read_b128 v[88:91], v163 offset:256
    ds_read_b128 v[92:95], v163 offset:4352
    ds_read_b128 v[120:123], v167 offset:256
    ds_read_b128 v[124:127], v167 offset:4352
    v_mfma_f32_16x16x32_bf16 v[40:43], v[64:67], v[100:103], v[40:43]
    v_mfma_f32_16x16x32_bf16 v[44:47], v[68:71], v[100:103], v[44:47]
    s_waitcnt lgkmcnt(8)
    v_mfma_f32_16x16x32_bf16 v[32:35], v[72:75], v[104:107], v[32:35]
    v_mfma_f32_16x16x32_bf16 v[36:39], v[76:79], v[104:107], v[36:39]
    ds_read_b128 v[64:67], v160 offset:512
    ds_read_b128 v[68:71], v160 offset:4608
    ds_read_b128 v[96:99], v164 offset:512
    ds_read_b128 v[100:103], v164 offset:4608
    v_mfma_f32_16x16x32_bf16 v[40:43], v[72:75], v[108:111], v[40:43]
    v_mfma_f32_16x16x32_bf16 v[44:47], v[76:79], v[108:111], v[44:47]
    s_waitcnt lgkmcnt(8)
    v_mfma_f32_16x16x32_bf16 v[32:35], v[80:83], v[112:115], v[32:35]
    v_mfma_f32_16x16x32_bf16 v[36:39], v[84:87], v[112:115], v[36:39]
    ds_read_b128 v[72:75], v161 offset:512
    ds_read_b128 v[76:79], v161 offset:4608
    ds_read_b128 v[104:107], v165 offset:512
    ds_read_b128 v[108:111], v165 offset:4608
    v_mfma_f32_16x16x32_bf16 v[40:43], v[80:83], v[116:119], v[40:43]
    v_mfma_f32_16x16x32_bf16 v[44:47], v[84:87], v[116:119], v[44:47]
    s_waitcnt vmcnt(8)
L_tag_2w:
    v_readfirstlane_b32 s75, v24
    s_nop 3
    s_cmp_eq_u32 s75, 0
    s_cbranch_scc1 L_tag_2s
    s_barrier
    s_lshl_b32 s35, s72, 7
    s_add_u32 s35, s35, 80904192
    v_mov_b32 v14, s75
    buffer_store_dword v14, v10, s[8:11], s35 offen sc1
    s_waitcnt lgkmcnt(8)
    v_mfma_f32_16x16x32_bf16 v[32:35], v[88:91], v[120:123], v[32:35]
    v_mfma_f32_16x16x32_bf16 v[36:39], v[92:95], v[120:123], v[36:39]
    ds_read_b128 v[80:83], v162 offset:512
    ds_read_b128 v[84:87], v162 offset:4608
    ds_read_b128 v[112:115], v166 offset:512
    ds_read_b128 v[116:119], v166 offset:4608
    v_mfma_f32_16x16x32_bf16 v[40:43], v[88:91], v[124:127], v[40:43]
    v_mfma_f32_16x16x32_bf16 v[44:47], v[92:95], v[124:127], v[44:47]
    s_waitcnt lgkmcnt(8)
    v_mfma_f32_16x16x32_bf16 v[32:35], v[64:67], v[96:99], v[32:35]
    v_mfma_f32_16x16x32_bf16 v[36:39], v[68:71], v[96:99], v[36:39]
    ds_read_b128 v[88:91], v163 offset:512
    ds_read_b128 v[92:95], v163 offset:4608
    ds_read_b128 v[120:123], v167 offset:512
    ds_read_b128 v[124:127], v167 offset:4608
    v_mfma_f32_16x16x32_bf16 v[40:43], v[64:67], v[100:103], v[40:43]
    v_mfma_f32_16x16x32_bf16 v[44:47], v[68:71], v[100:103], v[44:47]
    s_waitcnt lgkmcnt(8)
    v_mfma_f32_16x16x32_bf16 v[32:35], v[72:75], v[104:107], v[32:35]
    v_mfma_f32_16x16x32_bf16 v[36:39], v[76:79], v[104:107], v[36:39]
    ds_read_b128 v[64:67], v160 offset:768
    ds_read_b128 v[68:71], v160 offset:4864
    ds_read_b128 v[96:99], v164 offset:768
    ds_read_b128 v[100:103], v164 offset:4864
    v_mfma_f32_16x16x32_bf16 v[40:43], v[72:75], v[108:111], v[40:43]
    v_mfma_f32_16x16x32_bf16 v[44:47], v[76:79], v[108:111], v[44:47]
    s_waitcnt lgkmcnt(8)
    v_mfma_f32_16x16x32_bf16 v[32:35], v[80:83], v[112:115], v[32:35]
    v_mfma_f32_16x16x32_bf16 v[36:39], v[84:87], v[112:115], v[36:39]
    ds_read_b128 v[72:75], v161 offset:768
    ds_read_b128 v[76:79], v161 offset:4864
    ds_read_b128 v[104:107], v165 offset:768
    ds_read_b128 v[108:111], v165 offset:4864
    v_mfma_f32_16x16x32_bf16 v[40:43], v[80:83], v[116:119], v[40:43]
    v_mfma_f32_16x16x32_bf16 v[44:47], v[84:87], v[116:119], v[44:47]
    s_waitcnt lgkmcnt(8)
    v_mfma_f32_16x16x32_bf16 v[32:35], v[88:91], v[120:123], v[32:35]
    v_mfma_f32_16x16x32_bf16 v[36:39], v[92:95], v[120:123], v[36:39]
    ds_read_b128 v[80:83], v162 offset:768
    ds_read_b128 v[84:87], v162 offset:4864
    ds_read_b128 v[112:115], v166 offset:768
    ds_read_b128 v[116:119], v166 offset:4864
    v_mfma_f32_16x16x32_bf16 v[40:43], v[88:91], v[124:127], v[40:43]
    v_mfma_f32_16x16x32_bf16 v[44:47], v[92:95], v[124:127], v[44:47]
    s_waitcnt lgkmcnt(8)
    v_mfma_f32_16x16x32_bf16 v[32:35], v[64:67], v[96:99], v[32:35]
    v_mfma_f32_16x16x32_bf16 v[36:39], v[68:71], v[96:99], v[36:39]
    ds_read_b128 v[88:91], v163 offset:768
    ds_read_b128 v[92:95], v163 offset:4864
    ds_read_b128 v[120:123], v167 offset:768
    ds_read_b128 v[124:127], v167 offset:4864
    v_mfma_f32_16x16x32_bf16 v[40:43], v[64:67], v[100:103], v[40:43]
    v_mfma_f32_16x16x32_bf16 v[44:47], v[68:71], v[100:103], v[44:47]
    s_waitcnt lgkmcnt(8)
    v_mfma_f32_16x16x32_bf16 v[32:35], v[72:75], v[104:107], v[32:35]
    v_mfma_f32_16x16x32_bf16 v[36:39], v[76:79], v[104:107], v[36:39]
    v_mfma_f32_16x16x32_bf16 v[40:43], v[72:75], v[108:111], v[40:43]
    v_mfma_f32_16x16x32_bf16 v[44:47], v[76:79], v[108:111], v[44:47]
    s_waitcnt lgkmcnt(4)
    v_mfma_f32_16x16x32_bf16 v[32:35], v[80:83], v[112:115], v[32:35]
    v_mfma_f32_16x16x32_bf16 v[36:39], v[84:87], v[112:115], v[36:39]
    v_mfma_f32_16x16x32_bf16 v[40:43], v[80:83], v[116:119], v[40:43]
    v_mfma_f32_16x16x32_bf16 v[44:47], v[84:87], v[116:119], v[44:47]
    s_waitcnt lgkmcnt(0)
    v_mfma_f32_16x16x32_bf16 v[32:35], v[88:91], v[120:123], v[32:35]
    v_mfma_f32_16x16x32_bf16 v[36:39], v[92:95], v[120:123], v[36:39]
    v_mfma_f32_16x16x32_bf16 v[40:43], v[88:91], v[124:127], v[40:43]
    v_mfma_f32_16x16x32_bf16 v[44:47], v[92:95], v[124:127], v[44:47]
    buffer_load_dword v27, v11, s[8:11], s68 offen sc1
    s_nop 6
    s_mov_b32 s30, 0x3d8293ee
    v_mul_f32 v32, s30, v32
    v_mul_f32 v33, s30, v33
    v_mul_f32 v34, s30, v34
    v_mul_f32 v35, s30, v35
    v_mul_f32 v36, s30, v36
    v_mul_f32 v37, s30, v37
    v_mul_f32 v38, s30, v38
    v_mul_f32 v39, s30, v39
    v_mul_f32 v40, s30, v40
    v_mul_f32 v41, s30, v41
    v_mul_f32 v42, s30, v42
    v_mul_f32 v43, s30, v43
    v_mul_f32 v44, s30, v44
    v_mul_f32 v45, s30, v45
    v_mul_f32 v46, s30, v46
    v_mul_f32 v47, s30, v47
L_out:
    v_cvt_pk_bf16_f32 v48, v32, v33
    v_cvt_pk_bf16_f32 v49, v34, v35
    v_cvt_pk_bf16_f32 v50, v36, v37
    v_cvt_pk_bf16_f32 v51, v38, v39
    v_cvt_pk_bf16_f32 v52, v40, v41
    v_cvt_pk_bf16_f32 v53, v42, v43
    v_cvt_pk_bf16_f32 v54, v44, v45
    v_cvt_pk_bf16_f32 v55, v46, v47
    buffer_store_dwordx4 v[48:51], v7, s[8:11], s54 offen offset:0 sc1
    buffer_store_dwordx4 v[52:55], v7, s[8:11], s54 offen offset:1024 sc1
    s_branch L_pfin
L_c3:
    s_waitcnt vmcnt(8)
L_tag_3w:
    v_readfirstlane_b32 s75, v24
    s_nop 3
    s_cmp_eq_u32 s75, 0
    s_cbranch_scc1 L_tag_3s
    s_barrier
    s_lshl_b32 s35, s72, 7
    s_add_u32 s35, s35, 80904192
    v_mov_b32 v14, s75
    buffer_store_dword v14, v10, s[8:11], s35 offen sc1
    s_cmp_ge_u32 s3, 208
    s_cbranch_scc1 L_c5
    s_lshl1_add_u32 s30, s53, s43
    s_lshl_b32 s29, s30, 8
    v_add_u32 v160, s29, v160
    v_add_u32 v161, s29, v161
    v_add_u32 v162, s29, v162
    v_add_u32 v163, s29, v163
    ds_read_b128 v[64:67], v160 offset:0
    ds_read_b128 v[68:71], v160 offset:4096
    ds_read_b128 v[72:75], v161 offset:0
    ds_read_b128 v[76:79], v161 offset:4096
    ds_read_b128 v[80:83], v162 offset:0
    ds_read_b128 v[84:87], v162 offset:4096
    ds_read_b128 v[88:91], v163 offset:0
    ds_read_b128 v[92:95], v163 offset:4096
    s_lshl1_add_u32 s54, s52, s42
    s_lshl_b32 s54, s54, 15
    s_lshl_b32 s29, s30, 13
    s_add_u32 s54, s54, s29
    s_add_u32 s54, s54, 42467328
    s_waitcnt lgkmcnt(7)
    buffer_store_dwordx4 v[64:67], v7, s[8:11], s54 offen offset:0 sc1
    s_waitcnt lgkmcnt(6)
    buffer_store_dwordx4 v[68:71], v7, s[8:11], s54 offen offset:1024 sc1
    s_waitcnt lgkmcnt(5)
    buffer_store_dwordx4 v[72:75], v7, s[8:11], s54 offen offset:2048 sc1
    s_waitcnt lgkmcnt(4)
    buffer_store_dwordx4 v[76:79], v7, s[8:11], s54 offen offset:3072 sc1
    s_add_u32 s54, s54, 4096
    s_waitcnt lgkmcnt(3)
    buffer_store_dwordx4 v[80:83], v7, s[8:11], s54 offen offset:0 sc1
    s_waitcnt lgkmcnt(2)
    buffer_store_dwordx4 v[84:87], v7, s[8:11], s54 offen offset:1024 sc1
    s_waitcnt lgkmcnt(1)
    buffer_store_dwordx4 v[88:91], v7, s[8:11], s54 offen offset:2048 sc1
    s_waitcnt lgkmcnt(0)
    buffer_store_dwordx4 v[92:95], v7, s[8:11], s54 offen offset:3072 sc1
    s_branch L_c6
L_c5:
    v_lshl_or_b32 v64, v33, 16, v32
    v_lshl_or_b32 v65, v35, 16, v34
    v_lshl_or_b32 v66, v37, 16, v36
    v_lshl_or_b32 v67, v39, 16, v38
    s_lshl_b32 s29, s54, 10
    s_add_u32 s29, s29, 81264640
    buffer_store_dwordx4 v[64:67], v7, s[8:11], s29 offen sc1
L_c6:
    s_waitcnt vmcnt(0)
    buffer_load_dword v27, v11, s[8:11], s68 offen sc1
    s_waitcnt vmcnt(0)
L_pfin:
    s_lshr_b32 s29, s6, 1
    s_lshl_b32 s29, s29, 3
    s_lshl1_add_u32 s29, s26, s29
    s_add_u32 s66, s29, 0
    s_cmp_lt_u32 s66, 125
    s_cselect_b32 s30, 0, 0x80000000
    v_or_b32 v3, s30, v7
    s_min_u32 s66, s66, 124
    s_add_u32 s66, s66, s37
    s_lshl_b32 s66, s66, 15
    s_add_u32 s67, s29, 1
    s_cmp_lt_u32 s67, 125
    s_cselect_b32 s30, 0, 0x80000000
    v_or_b32 v4, s30, v7
    s_min_u32 s67, s67, 124
    s_add_u32 s67, s67, s37
    s_lshl_b32 s67, s67, 15
    s_waitcnt vmcnt(4)
    s_barrier
    s_add_u32 m0, s33, 32768
    s_add_u32 s30, s62, 525312
    buffer_load_dwordx4 v29, s[76:79], s30 offen lds
    s_add_u32 m0, s33, 33792
    s_add_u32 s30, s62, 541696
    buffer_load_dwordx4 v29, s[76:79], s30 offen lds
    s_add_u32 m0, s33, 34816
    s_add_u32 s30, s62, 558080
    buffer_load_dwordx4 v29, s[76:79], s30 offen lds
    s_add_u32 m0, s33, 35840
    s_add_u32 s30, s62, 574464
    buffer_load_dwordx4 v29, s[76:79], s30 offen lds
    s_add_u32 m0, s33, 36864
    s_add_u32 s30, s62, 590848
    buffer_load_dwordx4 v29, s[76:79], s30 offen lds
    s_add_u32 m0, s33, 37888
    s_add_u32 s30, s62, 607232
    buffer_load_dwordx4 v29, s[76:79], s30 offen lds
    s_add_u32 m0, s33, 38912
    s_add_u32 s30, s62, 623616
    buffer_load_dwordx4 v29, s[76:79], s30 offen lds
    s_add_u32 m0, s33, 39936
    s_add_u32 s30, s62, 640000
    buffer_load_dwordx4 v29, s[76:79], s30 offen lds
    s_lshl_b32 s65, s64, 16
    s_add_u32 s65, s65, 42991616
    s_and_b32 s29, s2, 3
    s_lshl_b32 s70, s29, 2
    s_lshr_b32 s35, s2, 6
    s_add_u32 s70, s70, s35
    s_and_b32 s69, s2, 4
    s_lshl_b32 s69, s69, 1
    s_add_u32 s69, s69, s64
    s_lshl_b32 s71, s70, 4
    s_add_u32 s71, s71, s69
    s_lshl_b32 s69, s69, 15
    s_add_u32 s69, s69, 42467328
    s_lshl_b32 s70, s70, 15
    s_add_u32 s70, s70, 45613056
    v_mov_b32 v8, 0xc0135761
    v_mov_b32 v9, 0xbdd2d3e8
    v_add_u32 v5, 65536, v7
    v_mov_b32 v32, 0
    v_mov_b32 v33, 0
    v_mov_b32 v34, 0
    v_mov_b32 v35, 0
    v_mov_b32 v36, 0
    v_mov_b32 v37, 0
    v_mov_b32 v38, 0
    v_mov_b32 v39, 0
    v_mov_b32 v40, 0
    v_mov_b32 v41, 0
    v_mov_b32 v42, 0
    v_mov_b32 v43, 0
    v_mov_b32 v44, 0
    v_mov_b32 v45, 0
    v_mov_b32 v46, 0
    v_mov_b32 v47, 0
    v_mov_b32 v48, 0
    v_mov_b32 v49, 0
    v_mov_b32 v50, 0
    v_mov_b32 v51, 0
    v_mov_b32 v52, 0
    v_mov_b32 v53, 0
    v_mov_b32 v54, 0
    v_mov_b32 v55, 0
    v_mov_b32 v56, 0
    v_mov_b32 v57, 0
    v_mov_b32 v58, 0
    v_mov_b32 v59, 0
    v_mov_b32 v60, 0
    v_mov_b32 v61, 0
    v_mov_b32 v62, 0
    v_mov_b32 v63, 0
    s_lshl_b32 s35, s64, 12
    s_add_u32 s46, s66, s35
    s_add_u32 s47, s67, s35
    s_add_u32 s56, s46, 33554432
    s_add_u32 s57, s47, 33554432
    s_add_u32 s58, s46, 46137344
    s_add_u32 s59, s47, 46137344
    s_add_u32 s60, s46, 16777216
    s_add_u32 s61, s47, 16777216
    s_add_u32 s52, s46, 8388608
    s_add_u32 s53, s47, 8388608
    v_lshrrev_b32 v13, 3, v0
    v_and_b32 v14, 7, v0
    s_lshl_b32 s35, s64, 3
    s_add_u32 s35, s35, 64
    v_add_u32 v113, s35, v14
    s_lshr_b32 s35, s71, 5
    s_lshl_b32 s35, s35, 3
    v_add_u32 v114, s35, v14
    v_cmp_eq_u32 vcc, 1, v13
    s_lshl_b32 s35, s28, 4
    s_add_u32 s35, s35, 104
    v_cndmask_b32 v113, v113, v114, vcc
    v_add_u32 v114, s35, v0
    v_subrev_u32 v115, 3, v13
    v_cmp_gt_u32 vcc, 2, v115
    s_mul_i32 s35, s64, 5
    s_add_u32 s35, s35, 206
    v_cndmask_b32 v113, v113, v114, vcc
    v_min_u32 v114, 6, v14
    v_add_u32 v114, s35, v114
    v_cmp_eq_u32 vcc, 2, v13
    s_bfe_u32 s35, s71, 0x30001
    s_add_u32 s35, s35, 192
    v_cndmask_b32 v113, v113, v114, vcc
    v_lshl_add_u32 v114, v14, 3, s35
    v_subrev_u32 v115, 16, v0
    v_cmp_gt_u32 vcc, 2, v115
    s_nop 1
    v_cndmask_b32 v113, v113, v114, vcc
    v_lshlrev_b32 v113, 7, v113
    s_and_b32 s35, s26, 1
    s_lshl_b32 s35, s35, 10
    v_add_u32 v30, s35, v7
    s_lshr_b32 s35, s26, 1
    s_lshl_b32 s35, s35, 10
    v_add_u32 v31, s35, v7
    v_and_b32 v13, 3, v0
    v_cmp_eq_u32 vcc, 0, v13
    v_bfrev_b32 v14, 1
    v_and_b32 v13, 12, v0
    v_lshlrev_b32 v13, 4, v13
    v_and_or_b32 v13, v0, 48, v13
    s_lshr_b32 s73, s66, 4
    s_lshl_b32 s35, s64, 8
    s_add_u32 s73, s73, s35
    s_add_u32 s73, s73, 41943040
    s_lshr_b32 s74, s67, 4
    s_lshl_b32 s35, s64, 8
    s_add_u32 s74, s74, s35
    s_add_u32 s74, s74, 41943040
    v_cndmask_b32 v13, v14, v13, vcc
    v_and_b32 v12, v14, v3
    v_or_b32 v12, v12, v13
    v_and_b32 v15, v14, v4
    v_or_b32 v15, v15, v13
    s_cmp_eq_u32 s26, 0
    s_cselect_b32 s35, 0, 0x80000000
    v_or_b32 v24, s35, v3
    s_cmp_eq_u32 s26, 3
    s_cselect_b32 s35, 0, 0x80000000
    v_or_b32 v25, s35, v4
    s_waitcnt vmcnt(10)
    v_cmp_ne_u32 vcc, s75, v27
    s_cbranch_vccnz L_fas
L_fak:
    s_add_u32 s68, s66, 0
    buffer_load_dwordx4 a[0:3], v3, s[8:11], s68 offen offset:0 sc1
    buffer_load_dwordx4 a[4:7], v3, s[8:11], s68 offen offset:1024 sc1
    buffer_load_dwordx4 a[8:11], v3, s[8:11], s68 offen offset:2048 sc1
    buffer_load_dwordx4 a[12:15], v3, s[8:11], s68 offen offset:3072 sc1
    s_add_u32 s68, s68, 4096
    buffer_load_dwordx4 a[16:19], v3, s[8:11], s68 offen offset:0 sc1
    buffer_load_dwordx4 a[20:23], v3, s[8:11], s68 offen offset:1024 sc1
    buffer_load_dwordx4 a[24:27], v3, s[8:11], s68 offen offset:2048 sc1
    buffer_load_dwordx4 a[28:31], v3, s[8:11], s68 offen offset:3072 sc1
    s_add_u32 s68, s68, 4096
    buffer_load_dwordx4 a[32:35], v3, s[8:11], s68 offen offset:0 sc1
    buffer_load_dwordx4 a[36:39], v3, s[8:11], s68 offen offset:1024 sc1
    buffer_load_dwordx4 a[40:43], v3, s[8:11], s68 offen offset:2048 sc1
    buffer_load_dwordx4 a[44:47], v3, s[8:11], s68 offen offset:3072 sc1
    s_add_u32 s68, s68, 4096
    buffer_load_dwordx4 a[48:51], v3, s[8:11], s68 offen offset:0 sc1
    buffer_load_dwordx4 a[52:55], v3, s[8:11], s68 offen offset:1024 sc1
    buffer_load_dwordx4 a[56:59], v3, s[8:11], s68 offen offset:2048 sc1
    buffer_load_dwordx4 a[60:63], v3, s[8:11], s68 offen offset:3072 sc1
    v_mov_b32 v11, v113
    ds_read_b64_tr_b16 v[64:65], v6 offset:0
    ds_read_b64_tr_b16 v[66:67], v6 offset:512
    ds_read_b64_tr_b16 v[68:69], v6 offset:8
    ds_read_b64_tr_b16 v[70:71], v6 offset:520
    ds_read_b64_tr_b16 v[72:73], v28 offset:0
    ds_read_b64_tr_b16 v[74:75], v28 offset:512
    ds_read_b64_tr_b16 v[76:77], v28 offset:8
    ds_read_b64_tr_b16 v[78:79], v28 offset:520
    ds_read_b64_tr_b16 v[80:81], v6 offset:4096
    ds_read_b64_tr_b16 v[82:83], v6 offset:4608
    s_waitcnt vmcnt(14) lgkmcnt(2)
    v_mfma_f32_16x16x32_bf16 v[128:131], a[0:3], v[64:67], 0
    ds_read_b64_tr_b16 v[84:85], v6 offset:4104
    v_mfma_f32_16x16x32_bf16 v[132:135], a[4:7], v[64:67], 0
    ds_read_b64_tr_b16 v[86:87], v6 offset:4616
    s_add_u32 s68, s68, 4096
    buffer_load_dwordx4 a[64:67], v3, s[8:11], s68 offen offset:0 sc1
    v_mfma_f32_16x16x32_bf16 v[136:139], a[0:3], v[68:71], 0
    ds_read_b64_tr_b16 v[88:89], v28 offset:4096
    v_mfma_f32_16x16x32_bf16 v[140:143], a[4:7], v[68:71], 0
    ds_read_b64_tr_b16 v[90:91], v28 offset:4608
    v_mfma_f32_16x16x32_bf16 v[160:163], a[0:3], v[72:75], 0
    ds_read_b64_tr_b16 v[64:65], v28 offset:4104
    v_mfma_f32_16x16x32_bf16 v[164:167], a[4:7], v[72:75], 0
    ds_read_b64_tr_b16 v[66:67], v28 offset:4616
    buffer_load_dwordx4 a[68:71], v3, s[8:11], s68 offen offset:1024 sc1
    v_mfma_f32_16x16x32_bf16 v[168:171], a[0:3], v[76:79], 0
    ds_read_b64_tr_b16 v[68:69], v6 offset:8192
    v_mfma_f32_16x16x32_bf16 v[172:175], a[4:7], v[76:79], 0
    ds_read_b64_tr_b16 v[70:71], v6 offset:8704
    s_waitcnt vmcnt(14) lgkmcnt(2)
    v_mfma_f32_16x16x32_bf16 v[128:131], a[8:11], v[80:83], v[128:131]
    ds_read_b64_tr_b16 v[72:73], v6 offset:8200
    v_mfma_f32_16x16x32_bf16 v[132:135], a[12:15], v[80:83], v[132:135]
    ds_read_b64_tr_b16 v[74:75], v6 offset:8712
    buffer_load_dwordx4 a[72:75], v3, s[8:11], s68 offen offset:2048 sc1
    v_mfma_f32_16x16x32_bf16 v[136:139], a[8:11], v[84:87], v[136:139]
    ds_read_b64_tr_b16 v[76:77], v28 offset:8192
    v_mfma_f32_16x16x32_bf16 v[140:143], a[12:15], v[84:87], v[140:143]
    ds_read_b64_tr_b16 v[78:79], v28 offset:8704
    v_mfma_f32_16x16x32_bf16 v[160:163], a[8:11], v[88:91], v[160:163]
    ds_read_b64_tr_b16 v[80:81], v28 offset:8200
    v_mfma_f32_16x16x32_bf16 v[164:167], a[12:15], v[88:91], v[164:167]
    ds_read_b64_tr_b16 v[82:83], v28 offset:8712
    buffer_load_dwordx4 a[76:79], v3, s[8:11], s68 offen offset:3072 sc1
    v_mfma_f32_16x16x32_bf16 v[168:171], a[8:11], v[64:67], v[168:171]
    ds_read_b64_tr_b16 v[84:85], v6 offset:12288
    v_mfma_f32_16x16x32_bf16 v[172:175], a[12:15], v[64:67], v[172:175]
    ds_read_b64_tr_b16 v[86:87], v6 offset:12800
    s_waitcnt vmcnt(14) lgkmcnt(2)
    v_mfma_f32_16x16x32_bf16 v[128:131], a[16:19], v[68:71], v[128:131]
    ds_read_b64_tr_b16 v[88:89], v6 offset:12296
    v_mfma_f32_16x16x32_bf16 v[132:135], a[20:23], v[68:71], v[132:135]
    ds_read_b64_tr_b16 v[90:91], v6 offset:12808
    s_add_u32 s68, s68, 4096
    buffer_load_dwordx4 a[80:83], v3, s[8:11], s68 offen offset:0 sc1
    v_mfma_f32_16x16x32_bf16 v[136:139], a[16:19], v[72:75], v[136:139]
    ds_read_b64_tr_b16 v[64:65], v28 offset:12288
    v_mfma_f32_16x16x32_bf16 v[140:143], a[20:23], v[72:75], v[140:143]
    ds_read_b64_tr_b16 v[66:67], v28 offset:12800
    v_mfma_f32_16x16x32_bf16 v[160:163], a[16:19], v[76:79], v[160:163]
    ds_read_b64_tr_b16 v[68:69], v28 offset:12296
    v_mfma_f32_16x16x32_bf16 v[164:167], a[20:23], v[76:79], v[164:167]
    ds_read_b64_tr_b16 v[70:71], v28 offset:12808
    buffer_load_dwordx4 a[84:87], v3, s[8:11], s68 offen offset:1024 sc1
    v_mfma_f32_16x16x32_bf16 v[168:171], a[16:19], v[80:83], v[168:171]
    ds_read_b64_tr_b16 v[72:73], v6 offset:16384
    v_mfma_f32_16x16x32_bf16 v[172:175], a[20:23], v[80:83], v[172:175]
    ds_read_b64_tr_b16 v[74:75], v6 offset:16896
    s_waitcnt vmcnt(14) lgkmcnt(2)
    v_mfma_f32_16x16x32_bf16 v[128:131], a[24:27], v[84:87], v[128:131]
    ds_read_b64_tr_b16 v[76:77], v6 offset:16392
    v_mfma_f32_16x16x32_bf16 v[132:135], a[28:31], v[84:87], v[132:135]
    ds_read_b64_tr_b16 v[78:79], v6 offset:16904
    buffer_load_dwordx4 a[88:91], v3, s[8:11], s68 offen offset:2048 sc1
    v_mfma_f32_16x16x32_bf16 v[136:139], a[24:27], v[88:91], v[136:139]
    ds_read_b64_tr_b16 v[80:81], v28 offset:16384
    v_mfma_f32_16x16x32_bf16 v[140:143], a[28:31], v[88:91], v[140:143]
    ds_read_b64_tr_b16 v[82:83], v28 offset:16896
    v_mfma_f32_16x16x32_bf16 v[160:163], a[24:27], v[64:67], v[160:163]
    ds_read_b64_tr_b16 v[84:85], v28 offset:16392
    v_mfma_f32_16x16x32_bf16 v[164:167], a[28:31], v[64:67], v[164:167]
    ds_read_b64_tr_b16 v[86:87], v28 offset:16904
    buffer_load_dwordx4 a[92:95], v3, s[8:11], s68 offen offset:3072 sc1
    v_mfma_f32_16x16x32_bf16 v[168:171], a[24:27], v[68:71], v[168:171]
    ds_read_b64_tr_b16 v[88:89], v6 offset:20480
    v_mfma_f32_16x16x32_bf16 v[172:175], a[28:31], v[68:71], v[172:175]
    ds_read_b64_tr_b16 v[90:91], v6 offset:20992
    s_waitcnt vmcnt(14) lgkmcnt(2)
    v_mfma_f32_16x16x32_bf16 v[128:131], a[32:35], v[72:75], v[128:131]
    ds_read_b64_tr_b16 v[64:65], v6 offset:20488
    v_mfma_f32_16x16x32_bf16 v[132:135], a[36:39], v[72:75], v[132:135]
    ds_read_b64_tr_b16 v[66:67], v6 offset:21000
    s_add_u32 s68, s68, 4096
    buffer_load_dwordx4 a[96:99], v3, s[8:11], s68 offen offset:0 sc1
    v_mfma_f32_16x16x32_bf16 v[136:139], a[32:35], v[76:79], v[136:139]
    ds_read_b64_tr_b16 v[68:69], v28 offset:20480
    v_mfma_f32_16x16x32_bf16 v[140:143], a[36:39], v[76:79], v[140:143]
    ds_read_b64_tr_b16 v[70:71], v28 offset:20992
    v_mfma_f32_16x16x32_bf16 v[160:163], a[32:35], v[80:83], v[160:163]
    ds_read_b64_tr_b16 v[72:73], v28 offset:20488
    v_mfma_f32_16x16x32_bf16 v[164:167], a[36:39], v[80:83], v[164:167]
    ds_read_b64_tr_b16 v[74:75], v28 offset:21000
    buffer_load_dwordx4 a[100:103], v3, s[8:11], s68 offen offset:1024 sc1
    v_mfma_f32_16x16x32_bf16 v[168:171], a[32:35], v[84:87], v[168:171]
    ds_read_b64_tr_b16 v[76:77], v6 offset:24576
    v_mfma_f32_16x16x32_bf16 v[172:175], a[36:39], v[84:87], v[172:175]
    ds_read_b64_tr_b16 v[78:79], v6 offset:25088
    s_waitcnt vmcnt(14) lgkmcnt(2)
    v_mfma_f32_16x16x32_bf16 v[128:131], a[40:43], v[88:91], v[128:131]
    ds_read_b64_tr_b16 v[80:81], v6 offset:24584
    v_mfma_f32_16x16x32_bf16 v[132:135], a[44:47], v[88:91], v[132:135]
    ds_read_b64_tr_b16 v[82:83], v6 offset:25096
    buffer_load_dwordx4 a[104:107], v3, s[8:11], s68 offen offset:2048 sc1
    s_waitcnt vmcnt(27)
    s_barrier
    s_lshl_b32 s35, s3, 7
    s_add_u32 s35, s35, 80936960
    v_mov_b32 v14, s75
    buffer_store_dword v14, v10, s[8:11], s35 offen sc1
    v_mfma_f32_16x16x32_bf16 v[136:139], a[40:43], v[64:67], v[136:139]
    ds_read_b64_tr_b16 v[84:85], v28 offset:24576
    v_mfma_f32_16x16x32_bf16 v[140:143], a[44:47], v[64:67], v[140:143]
    ds_read_b64_tr_b16 v[86:87], v28 offset:25088
    v_mfma_f32_16x16x32_bf16 v[160:163], a[40:43], v[68:71], v[160:163]
    ds_read_b64_tr_b16 v[88:89], v28 offset:24584
    v_mfma_f32_16x16x32_bf16 v[164:167], a[44:47], v[68:71], v[164:167]
    ds_read_b64_tr_b16 v[90:91], v28 offset:25096
    buffer_load_dwordx4 a[108:111], v3, s[8:11], s68 offen offset:3072 sc1
    v_mfma_f32_16x16x32_bf16 v[168:171], a[40:43], v[72:75], v[168:171]
    ds_read_b64_tr_b16 v[64:65], v6 offset:28672
    v_mfma_f32_16x16x32_bf16 v[172:175], a[44:47], v[72:75], v[172:175]
    ds_read_b64_tr_b16 v[66:67], v6 offset:29184
    s_waitcnt vmcnt(15) lgkmcnt(2)
    v_mfma_f32_16x16x32_bf16 v[128:131], a[48:51], v[76:79], v[128:131]
    ds_read_b64_tr_b16 v[68:69], v6 offset:28680
    v_mfma_f32_16x16x32_bf16 v[132:135], a[52:55], v[76:79], v[132:135]
    ds_read_b64_tr_b16 v[70:71], v6 offset:29192
    s_add_u32 s68, s68, 4096
    buffer_load_dwordx4 a[112:115], v3, s[8:11], s68 offen offset:0 sc1
    v_mfma_f32_16x16x32_bf16 v[136:139], a[48:51], v[80:83], v[136:139]
    ds_read_b64_tr_b16 v[72:73], v28 offset:28672
    v_mfma_f32_16x16x32_bf16 v[140:143], a[52:55], v[80:83], v[140:143]
    ds_read_b64_tr_b16 v[74:75], v28 offset:29184
    v_mfma_f32_16x16x32_bf16 v[160:163], a[48:51], v[84:87], v[160:163]
    ds_read_b64_tr_b16 v[76:77], v28 offset:28680
    v_mfma_f32_16x16x32_bf16 v[164:167], a[52:55], v[84:87], v[164:167]
    ds_read_b64_tr_b16 v[78:79], v28 offset:29192
    buffer_load_dwordx4 a[116:119], v3, s[8:11], s68 offen offset:1024 sc1
    v_mfma_f32_16x16x32_bf16 v[168:171], a[48:51], v[88:91], v[168:171]
    ds_read_b64_tr_b16 v[80:81], v6 offset:32768
    v_mfma_f32_16x16x32_bf16 v[172:175], a[52:55], v[88:91], v[172:175]
    ds_read_b64_tr_b16 v[82:83], v6 offset:33280
    s_waitcnt vmcnt(15) lgkmcnt(2)
    v_mfma_f32_16x16x32_bf16 v[128:131], a[56:59], v[64:67], v[128:131]
    ds_read_b64_tr_b16 v[84:85], v6 offset:32776
    v_mfma_f32_16x16x32_bf16 v[132:135], a[60:63], v[64:67], v[132:135]
    ds_read_b64_tr_b16 v[86:87], v6 offset:33288
    buffer_load_dwordx4 a[120:123], v3, s[8:11], s68 offen offset:2048 sc1
    v_mfma_f32_16x16x32_bf16 v[136:139], a[56:59], v[68:71], v[136:139]
    ds_read_b64_tr_b16 v[88:89], v28 offset:32768
    v_mfma_f32_16x16x32_bf16 v[140:143], a[60:63], v[68:71], v[140:143]
    ds_read_b64_tr_b16 v[90:91], v28 offset:33280
    v_mfma_f32_16x16x32_bf16 v[160:163], a[56:59], v[72:75], v[160:163]
    ds_read_b64_tr_b16 v[64:65], v28 offset:32776
    v_mfma_f32_16x16x32_bf16 v[164:167], a[60:63], v[72:75], v[164:167]
    ds_read_b64_tr_b16 v[66:67], v28 offset:33288
    buffer_load_dwordx4 a[124:127], v3, s[8:11], s68 offen offset:3072 sc1
    v_mfma_f32_16x16x32_bf16 v[168:171], a[56:59], v[76:79], v[168:171]
    ds_read_b64_tr_b16 v[68:69], v6 offset:36864
    v_mfma_f32_16x16x32_bf16 v[172:175], a[60:63], v[76:79], v[172:175]
    ds_read_b64_tr_b16 v[70:71], v6 offset:37376
    s_waitcnt vmcnt(15) lgkmcnt(2)
    v_mfma_f32_16x16x32_bf16 v[128:131], a[64:67], v[80:83], v[128:131]
    ds_read_b64_tr_b16 v[72:73], v6 offset:36872
    v_mfma_f32_16x16x32_bf16 v[132:135], a[68:71], v[80:83], v[132:135]
    ds_read_b64_tr_b16 v[74:75], v6 offset:37384
    s_add_u32 s68, s67, 0
    buffer_load_dwordx4 a[128:131], v4, s[8:11], s68 offen offset:0 sc1
    v_mfma_f32_16x16x32_bf16 v[136:139], a[64:67], v[84:87], v[136:139]
    ds_read_b64_tr_b16 v[76:77], v28 offset:36864
    v_mfma_f32_16x16x32_bf16 v[140:143], a[68:71], v[84:87], v[140:143]
    ds_read_b64_tr_b16 v[78:79], v28 offset:37376
    v_mfma_f32_16x16x32_bf16 v[160:163], a[64:67], v[88:91], v[160:163]
    ds_read_b64_tr_b16 v[80:81], v28 offset:36872
    v_mfma_f32_16x16x32_bf16 v[164:167], a[68:71], v[88:91], v[164:167]
    ds_read_b64_tr_b16 v[82:83], v28 offset:37384
    buffer_load_dwordx4 a[132:135], v4, s[8:11], s68 offen offset:1024 sc1
    v_mfma_f32_16x16x32_bf16 v[168:171], a[64:67], v[64:67], v[168:171]
    ds_read_b64_tr_b16 v[84:85], v6 offset:40960
    v_mfma_f32_16x16x32_bf16 v[172:175], a[68:71], v[64:67], v[172:175]
    ds_read_b64_tr_b16 v[86:87], v6 offset:41472
    s_waitcnt vmcnt(15) lgkmcnt(2)
    v_mfma_f32_16x16x32_bf16 v[128:131], a[72:75], v[68:71], v[128:131]
    ds_read_b64_tr_b16 v[88:89], v6 offset:40968
    v_mfma_f32_16x16x32_bf16 v[132:135], a[76:79], v[68:71], v[132:135]
    ds_read_b64_tr_b16 v[90:91], v6 offset:41480
    buffer_load_dwordx4 a[136:139], v4, s[8:11], s68 offen offset:2048 sc1
    v_mfma_f32_16x16x32_bf16 v[136:139], a[72:75], v[72:75], v[136:139]
    ds_read_b64_tr_b16 v[64:65], v28 offset:40960
    v_mfma_f32_16x16x32_bf16 v[140:143], a[76:79], v[72:75], v[140:143]
    ds_read_b64_tr_b16 v[66:67], v28 offset:41472
    v_mfma_f32_16x16x32_bf16 v[160:163], a[72:75], v[76:79], v[160:163]
    ds_read_b64_tr_b16 v[68:69], v28 offset:40968
    v_mfma_f32_16x16x32_bf16 v[164:167], a[76:79], v[76:79], v[164:167]
    ds_read_b64_tr_b16 v[70:71], v28 offset:41480
    buffer_load_dwordx4 a[140:143], v4, s[8:11], s68 offen offset:3072 sc1
    v_mfma_f32_16x16x32_bf16 v[168:171], a[72:75], v[80:83], v[168:171]
    ds_read_b64_tr_b16 v[72:73], v6 offset:45056
    v_mfma_f32_16x16x32_bf16 v[172:175], a[76:79], v[80:83], v[172:175]
    ds_read_b64_tr_b16 v[74:75], v6 offset:45568
    s_waitcnt vmcnt(15) lgkmcnt(2)
    v_mfma_f32_16x16x32_bf16 v[128:131], a[80:83], v[84:87], v[128:131]
    ds_read_b64_tr_b16 v[76:77], v6 offset:45064
    v_mfma_f32_16x16x32_bf16 v[132:135], a[84:87], v[84:87], v[132:135]
    ds_read_b64_tr_b16 v[78:79], v6 offset:45576
    s_add_u32 s68, s68, 4096
    buffer_load_dwordx4 a[144:147], v4, s[8:11], s68 offen offset:0 sc1
    v_mfma_f32_16x16x32_bf16 v[136:139], a[80:83], v[88:91], v[136:139]
    ds_read_b64_tr_b16 v[80:81], v28 offset:45056
    v_mfma_f32_16x16x32_bf16 v[140:143], a[84:87], v[88:91], v[140:143]
    ds_read_b64_tr_b16 v[82:83], v28 offset:45568
    v_mfma_f32_16x16x32_bf16 v[160:163], a[80:83], v[64:67], v[160:163]
    ds_read_b64_tr_b16 v[84:85], v28 offset:45064
    v_mfma_f32_16x16x32_bf16 v[164:167], a[84:87], v[64:67], v[164:167]
    ds_read_b64_tr_b16 v[86:87], v28 offset:45576
    buffer_load_dwordx4 a[148:151], v4, s[8:11], s68 offen offset:1024 sc1
    v_mfma_f32_16x16x32_bf16 v[168:171], a[80:83], v[68:71], v[168:171]
    ds_read_b64_tr_b16 v[88:89], v6 offset:49152
    v_mfma_f32_16x16x32_bf16 v[172:175], a[84:87], v[68:71], v[172:175]
    ds_read_b64_tr_b16 v[90:91], v6 offset:49664
    s_waitcnt vmcnt(15) lgkmcnt(2)
    v_mfma_f32_16x16x32_bf16 v[128:131], a[88:91], v[72:75], v[128:131]
    ds_read_b64_tr_b16 v[64:65], v6 offset:49160
    v_mfma_f32_16x16x32_bf16 v[132:135], a[92:95], v[72:75], v[132:135]
    ds_read_b64_tr_b16 v[66:67], v6 offset:49672
    buffer_load_dwordx4 a[152:155], v4, s[8:11], s68 offen offset:2048 sc1
    v_mfma_f32_16x16x32_bf16 v[136:139], a[88:91], v[76:79], v[136:139]
    ds_read_b64_tr_b16 v[68:69], v28 offset:49152
    v_mfma_f32_16x16x32_bf16 v[140:143], a[92:95], v[76:79], v[140:143]
    ds_read_b64_tr_b16 v[70:71], v28 offset:49664
    v_mfma_f32_16x16x32_bf16 v[160:163], a[88:91], v[80:83], v[160:163]
    ds_read_b64_tr_b16 v[72:73], v28 offset:49160
    v_mfma_f32_16x16x32_bf16 v[164:167], a[92:95], v[80:83], v[164:167]
    ds_read_b64_tr_b16 v[74:75], v28 offset:49672
    buffer_load_dwordx4 a[156:159], v4, s[8:11], s68 offen offset:3072 sc1
    v_mfma_f32_16x16x32_bf16 v[168:171], a[88:91], v[84:87], v[168:171]
    ds_read_b64_tr_b16 v[76:77], v6 offset:53248
    v_mfma_f32_16x16x32_bf16 v[172:175], a[92:95], v[84:87], v[172:175]
    ds_read_b64_tr_b16 v[78:79], v6 offset:53760
    s_waitcnt vmcnt(15) lgkmcnt(2)
    v_mfma_f32_16x16x32_bf16 v[128:131], a[96:99], v[88:91], v[128:131]
    ds_read_b64_tr_b16 v[80:81], v6 offset:53256
    v_mfma_f32_16x16x32_bf16 v[132:135], a[100:103], v[88:91], v[132:135]
    ds_read_b64_tr_b16 v[82:83], v6 offset:53768
    s_add_u32 s68, s68, 4096
    buffer_load_dwordx4 a[160:163], v4, s[8:11], s68 offen offset:0 sc1
    v_mfma_f32_16x16x32_bf16 v[136:139], a[96:99], v[64:67], v[136:139]
    ds_read_b64_tr_b16 v[84:85], v28 offset:53248
    v_mfma_f32_16x16x32_bf16 v[140:143], a[100:103], v[64:67], v[140:143]
    ds_read_b64_tr_b16 v[86:87], v28 offset:53760
    v_mfma_f32_16x16x32_bf16 v[160:163], a[96:99], v[68:71], v[160:163]
    ds_read_b64_tr_b16 v[88:89], v28 offset:53256
    v_mfma_f32_16x16x32_bf16 v[164:167], a[100:103], v[68:71], v[164:167]
    ds_read_b64_tr_b16 v[90:91], v28 offset:53768
    buffer_load_dwordx4 a[164:167], v4, s[8:11], s68 offen offset:1024 sc1
    v_mfma_f32_16x16x32_bf16 v[168:171], a[96:99], v[72:75], v[168:171]
    ds_read_b64_tr_b16 v[64:65], v6 offset:57344
    v_mfma_f32_16x16x32_bf16 v[172:175], a[100:103], v[72:75], v[172:175]
    ds_read_b64_tr_b16 v[66:67], v6 offset:57856
    s_waitcnt vmcnt(14) lgkmcnt(2)
    v_mfma_f32_16x16x32_bf16 v[128:131], a[104:107], v[76:79], v[128:131]
    ds_read_b64_tr_b16 v[68:69], v6 offset:57352
    v_mfma_f32_16x16x32_bf16 v[132:135], a[108:111], v[76:79], v[132:135]
    ds_read_b64_tr_b16 v[70:71], v6 offset:57864
    buffer_load_dwordx4 a[168:171], v4, s[8:11], s68 offen offset:2048 sc1
    v_mfma_f32_16x16x32_bf16 v[136:139], a[104:107], v[80:83], v[136:139]
    ds_read_b64_tr_b16 v[72:73], v28 offset:57344
    v_mfma_f32_16x16x32_bf16 v[140:143], a[108:111], v[80:83], v[140:143]
    ds_read_b64_tr_b16 v[74:75], v28 offset:57856
    v_mfma_f32_16x16x32_bf16 v[160:163], a[104:107], v[84:87], v[160:163]
    ds_read_b64_tr_b16 v[76:77], v28 offset:57352
    v_mfma_f32_16x16x32_bf16 v[164:167], a[108:111], v[84:87], v[164:167]
    ds_read_b64_tr_b16 v[78:79], v28 offset:57864
    buffer_load_dwordx4 a[172:175], v4, s[8:11], s68 offen offset:3072 sc1
    v_mfma_f32_16x16x32_bf16 v[168:171], a[104:107], v[88:91], v[168:171]
    ds_read_b64_tr_b16 v[80:81], v6 offset:61440
    v_mfma_f32_16x16x32_bf16 v[172:175], a[108:111], v[88:91], v[172:175]
    ds_read_b64_tr_b16 v[82:83], v6 offset:61952
    s_waitcnt vmcnt(14) lgkmcnt(2)
    v_mfma_f32_16x16x32_bf16 v[128:131], a[112:115], v[64:67], v[128:131]
    ds_read_b64_tr_b16 v[84:85], v6 offset:61448
    v_mfma_f32_16x16x32_bf16 v[132:135], a[116:119], v[64:67], v[132:135]
    ds_read_b64_tr_b16 v[86:87], v6 offset:61960
    s_add_u32 s68, s68, 4096
    buffer_load_dwordx4 a[176:179], v4, s[8:11], s68 offen offset:0 sc1
    v_mfma_f32_16x16x32_bf16 v[136:139], a[112:115], v[68:71], v[136:139]
    ds_read_b64_tr_b16 v[88:89], v28 offset:61440
    v_mfma_f32_16x16x32_bf16 v[140:143], a[116:119], v[68:71], v[140:143]
    ds_read_b64_tr_b16 v[90:91], v28 offset:61952
    v_mfma_f32_16x16x32_bf16 v[160:163], a[112:115], v[72:75], v[160:163]
    ds_read_b64_tr_b16 v[64:65], v28 offset:61448
    v_mfma_f32_16x16x32_bf16 v[164:167], a[116:119], v[72:75], v[164:167]
    ds_read_b64_tr_b16 v[66:67], v28 offset:61960
    buffer_load_dwordx4 a[180:183], v4, s[8:11], s68 offen offset:1024 sc1
    v_mfma_f32_16x16x32_bf16 v[168:171], a[112:115], v[76:79], v[168:171]
    ds_read_b64_tr_b16 v[68:69], v6 offset:0
    v_mfma_f32_16x16x32_bf16 v[172:175], a[116:119], v[76:79], v[172:175]
    ds_read_b64_tr_b16 v[70:71], v6 offset:512
    s_waitcnt vmcnt(14) lgkmcnt(2)
    v_mfma_f32_16x16x32_bf16 v[128:131], a[120:123], v[80:83], v[128:131]
    ds_read_b64_tr_b16 v[72:73], v6 offset:8
    v_mfma_f32_16x16x32_bf16 v[132:135], a[124:127], v[80:83], v[132:135]
    ds_read_b64_tr_b16 v[74:75], v6 offset:520
    buffer_load_dwordx4 a[184:187], v4, s[8:11], s68 offen offset:2048 sc1
    v_mfma_f32_16x16x32_bf16 v[136:139], a[120:123], v[84:87], v[136:139]
    ds_read_b64_tr_b16 v[76:77], v28 offset:0
    v_mfma_f32_16x16x32_bf16 v[140:143], a[124:127], v[84:87], v[140:143]
    ds_read_b64_tr_b16 v[78:79], v28 offset:512
    v_mfma_f32_16x16x32_bf16 v[160:163], a[120:123], v[88:91], v[160:163]
    ds_read_b64_tr_b16 v[80:81], v28 offset:8
    v_mfma_f32_16x16x32_bf16 v[164:167], a[124:127], v[88:91], v[164:167]
    ds_read_b64_tr_b16 v[82:83], v28 offset:520
    buffer_load_dwordx4 a[188:191], v4, s[8:11], s68 offen offset:3072 sc1
    v_mfma_f32_16x16x32_bf16 v[168:171], a[120:123], v[64:67], v[168:171]
    ds_read_b64_tr_b16 v[84:85], v6 offset:4096
    v_mfma_f32_16x16x32_bf16 v[172:175], a[124:127], v[64:67], v[172:175]
    ds_read_b64_tr_b16 v[86:87], v6 offset:4608
    s_waitcnt vmcnt(14) lgkmcnt(2)
    v_mfma_f32_16x16x32_bf16 v[144:147], a[128:131], v[68:71], 0
    ds_read_b64_tr_b16 v[88:89], v6 offset:4104
    v_mfma_f32_16x16x32_bf16 v[148:151], a[132:135], v[68:71], 0
    ds_read_b64_tr_b16 v[90:91], v6 offset:4616
    s_add_u32 s68, s68, 4096
    buffer_load_dwordx4 a[192:195], v4, s[8:11], s68 offen offset:0 sc1
    v_mfma_f32_16x16x32_bf16 v[152:155], a[128:131], v[72:75], 0
    ds_read_b64_tr_b16 v[64:65], v28 offset:4096
    v_mfma_f32_16x16x32_bf16 v[156:159], a[132:135], v[72:75], 0
    ds_read_b64_tr_b16 v[66:67], v28 offset:4608
    v_mul_f32 v16, v128, v128
    v_mul_f32 v17, v129, v129
    v_mfma_f32_16x16x32_bf16 v[176:179], a[128:131], v[76:79], 0
    ds_read_b64_tr_b16 v[68:69], v28 offset:4104
    v_fma_f32 v16, v16, v9, v8
    v_fma_f32 v17, v17, v9, v8
    v_mfma_f32_16x16x32_bf16 v[180:183], a[132:135], v[76:79], 0
    ds_read_b64_tr_b16 v[70:71], v28 offset:4616
    buffer_load_dwordx4 a[196:199], v4, s[8:11], s68 offen offset:1024 sc1
    v_mfma_f32_16x16x32_bf16 v[184:187], a[128:131], v[80:83], 0
    ds_read_b64_tr_b16 v[72:73], v6 offset:8192
    v_mul_f32 v16, v16, v128
    v_mul_f32 v17, v17, v129
    v_mfma_f32_16x16x32_bf16 v[188:191], a[132:135], v[80:83], 0
    ds_read_b64_tr_b16 v[74:75], v6 offset:8704
    v_mul_f32 v18, v130, v130
    s_waitcnt vmcnt(14) lgkmcnt(2)
    v_mfma_f32_16x16x32_bf16 v[144:147], a[136:139], v[84:87], v[144:147]
    ds_read_b64_tr_b16 v[76:77], v6 offset:8200
    v_exp_f32 v16, v16
    v_mfma_f32_16x16x32_bf16 v[148:151], a[140:143], v[84:87], v[148:151]
    ds_read_b64_tr_b16 v[78:79], v6 offset:8712
    buffer_load_dwordx4 a[200:203], v4, s[8:11], s68 offen offset:2048 sc1
    v_mfma_f32_16x16x32_bf16 v[152:155], a[136:139], v[88:91], v[152:155]
    ds_read_b64_tr_b16 v[80:81], v28 offset:8192
    v_add_f32 v16, 1.0, v16
    v_fma_f32 v18, v18, v9, v8
    v_mfma_f32_16x16x32_bf16 v[156:159], a[140:143], v[88:91], v[156:159]
    ds_read_b64_tr_b16 v[82:83], v28 offset:8704
    v_rcp_f32 v16, v16
    v_mfma_f32_16x16x32_bf16 v[176:179], a[136:139], v[64:67], v[176:179]
    ds_read_b64_tr_b16 v[84:85], v28 offset:8200
    v_exp_f32 v17, v17
    v_mfma_f32_16x16x32_bf16 v[180:183], a[140:143], v[64:67], v[180:183]
    ds_read_b64_tr_b16 v[86:87], v28 offset:8712
    buffer_load_dwordx4 a[204:207], v4, s[8:11], s68 offen offset:3072 sc1
    v_mfma_f32_16x16x32_bf16 v[184:187], a[136:139], v[68:71], v[184:187]
    ds_read_b64_tr_b16 v[88:89], v6 offset:12288
    v_mul_f32 v128, v128, v16
    v_add_f32 v17, 1.0, v17
    v_mfma_f32_16x16x32_bf16 v[188:191], a[140:143], v[68:71], v[188:191]
    ds_read_b64_tr_b16 v[90:91], v6 offset:12800
    v_mul_f32 v18, v18, v130
    s_waitcnt vmcnt(14) lgkmcnt(2)
    v_mfma_f32_16x16x32_bf16 v[144:147], a[144:147], v[72:75], v[144:147]
    ds_read_b64_tr_b16 v[64:65], v6 offset:12296
    v_mul_f32 v19, v131, v131
    v_add_f32 v32, v32, v128
    v_mfma_f32_16x16x32_bf16 v[148:151], a[148:151], v[72:75], v[148:151]
    ds_read_b64_tr_b16 v[66:67], v6 offset:12808
    s_add_u32 s68, s68, 4096
    buffer_load_dwordx4 a[208:211], v4, s[8:11], s68 offen offset:0 sc1
    v_mfma_f32_16x16x32_bf16 v[152:155], a[144:147], v[76:79], v[152:155]
    ds_read_b64_tr_b16 v[68:69], v28 offset:12288
    v_rcp_f32 v17, v17
    v_mfma_f32_16x16x32_bf16 v[156:159], a[148:151], v[76:79], v[156:159]
    ds_read_b64_tr_b16 v[70:71], v28 offset:12800
    v_exp_f32 v18, v18
    v_mfma_f32_16x16x32_bf16 v[176:179], a[144:147], v[80:83], v[176:179]
    ds_read_b64_tr_b16 v[72:73], v28 offset:12296
    v_fma_f32 v19, v19, v9, v8
    v_fmac_f32 v40, v128, v128
    v_mfma_f32_16x16x32_bf16 v[180:183], a[148:151], v[80:83], v[180:183]
    ds_read_b64_tr_b16 v[74:75], v28 offset:12808
    buffer_load_dwordx4 a[212:215], v4, s[8:11], s68 offen offset:1024 sc1
    v_mfma_f32_16x16x32_bf16 v[184:187], a[144:147], v[84:87], v[184:187]
    ds_read_b64_tr_b16 v[76:77], v6 offset:16384
    v_mul_f32 v129, v129, v17
    v_add_f32 v18, 1.0, v18
    v_mfma_f32_16x16x32_bf16 v[188:191], a[148:151], v[84:87], v[188:191]
    ds_read_b64_tr_b16 v[78:79], v6 offset:16896
    v_mul_f32 v19, v19, v131
    s_waitcnt vmcnt(14) lgkmcnt(2)
    v_mfma_f32_16x16x32_bf16 v[144:147], a[152:155], v[88:91], v[144:147]
    ds_read_b64_tr_b16 v[80:81], v6 offset:16392
    v_mul_f32 v16, v132, v132
    v_add_f32 v33, v33, v129
    v_mfma_f32_16x16x32_bf16 v[148:151], a[156:159], v[88:91], v[148:151]
    ds_read_b64_tr_b16 v[82:83], v6 offset:16904
    buffer_load_dwordx4 a[216:219], v4, s[8:11], s68 offen offset:2048 sc1
    v_mfma_f32_16x16x32_bf16 v[152:155], a[152:155], v[64:67], v[152:155]
    ds_read_b64_tr_b16 v[84:85], v28 offset:16384
    v_rcp_f32 v18, v18
    v_mfma_f32_16x16x32_bf16 v[156:159], a[156:159], v[64:67], v[156:159]
    ds_read_b64_tr_b16 v[86:87], v28 offset:16896
    v_exp_f32 v19, v19
    v_mfma_f32_16x16x32_bf16 v[176:179], a[152:155], v[68:71], v[176:179]
    ds_read_b64_tr_b16 v[88:89], v28 offset:16392
    v_fma_f32 v16, v16, v9, v8
    v_fmac_f32 v41, v129, v129
    v_mfma_f32_16x16x32_bf16 v[180:183], a[156:159], v[68:71], v[180:183]
    ds_read_b64_tr_b16 v[90:91], v28 offset:16904
    buffer_load_dwordx4 a[220:223], v4, s[8:11], s68 offen offset:3072 sc1
    v_mfma_f32_16x16x32_bf16 v[184:187], a[152:155], v[72:75], v[184:187]
    ds_read_b64_tr_b16 v[64:65], v6 offset:20480
    v_mul_f32 v130, v130, v18
    v_add_f32 v19, 1.0, v19
    v_mfma_f32_16x16x32_bf16 v[188:191], a[156:159], v[72:75], v[188:191]
    ds_read_b64_tr_b16 v[66:67], v6 offset:20992
    s_add_u32 s68, s68, 4096
    buffer_load_dwordx4 a[224:227], v4, s[8:11], s68 offen offset:0 sc1
    s_waitcnt vmcnt(15) lgkmcnt(2)
    v_mfma_f32_16x16x32_bf16 v[144:147], a[160:163], v[76:79], v[144:147]
    ds_read_b64_tr_b16 v[68:69], v6 offset:20488
    v_mul_f32 v16, v16, v132
    v_mul_f32 v17, v133, v133
    v_mfma_f32_16x16x32_bf16 v[148:151], a[164:167], v[76:79], v[148:151]
    ds_read_b64_tr_b16 v[70:71], v6 offset:21000
    buffer_load_dwordx4 a[228:231], v4, s[8:11], s68 offen offset:1024 sc1
    v_mfma_f32_16x16x32_bf16 v[152:155], a[160:163], v[80:83], v[152:155]
    ds_read_b64_tr_b16 v[72:73], v28 offset:20480
    v_add_f32 v34, v34, v130
    v_fma_f32 v17, v17, v9, v8
    v_mfma_f32_16x16x32_bf16 v[156:159], a[164:167], v[80:83], v[156:159]
    ds_read_b64_tr_b16 v[74:75], v28 offset:20992
    buffer_load_dwordx4 a[232:235], v4, s[8:11], s68 offen offset:2048 sc1
    v_mfma_f32_16x16x32_bf16 v[176:179], a[160:163], v[84:87], v[176:179]
    ds_read_b64_tr_b16 v[76:77], v28 offset:20488
    v_rcp_f32 v19, v19
    v_mfma_f32_16x16x32_bf16 v[180:183], a[164:167], v[84:87], v[180:183]
    ds_read_b64_tr_b16 v[78:79], v28 offset:21000
    buffer_load_dwordx4 a[236:239], v4, s[8:11], s68 offen offset:3072 sc1
    v_mfma_f32_16x16x32_bf16 v[184:187], a[160:163], v[88:91], v[184:187]
    ds_read_b64_tr_b16 v[80:81], v6 offset:24576
    v_exp_f32 v16, v16
    v_mfma_f32_16x16x32_bf16 v[188:191], a[164:167], v[88:91], v[188:191]
    ds_read_b64_tr_b16 v[82:83], v6 offset:25088
    s_add_u32 s68, s68, 4096
    buffer_load_dwordx4 a[240:243], v4, s[8:11], s68 offen offset:0 sc1
    s_waitcnt vmcnt(17) lgkmcnt(2)
    v_mfma_f32_16x16x32_bf16 v[144:147], a[168:171], v[64:67], v[144:147]
    ds_read_b64_tr_b16 v[84:85], v6 offset:24584
    v_fmac_f32 v42, v130, v130
    v_mul_f32 v131, v131, v19
    v_mfma_f32_16x16x32_bf16 v[148:151], a[172:175], v[64:67], v[148:151]
    ds_read_b64_tr_b16 v[86:87], v6 offset:25096
    buffer_load_dwordx4 a[244:247], v4, s[8:11], s68 offen offset:1024 sc1
    v_mfma_f32_16x16x32_bf16 v[152:155], a[168:171], v[68:71], v[152:155]
    ds_read_b64_tr_b16 v[88:89], v28 offset:24576
    v_add_f32 v16, 1.0, v16
    v_mul_f32 v17, v17, v133
    v_mfma_f32_16x16x32_bf16 v[156:159], a[172:175], v[68:71], v[156:159]
    ds_read_b64_tr_b16 v[90:91], v28 offset:25088
    buffer_load_dwordx4 a[248:251], v4, s[8:11], s68 offen offset:2048 sc1
    v_mfma_f32_16x16x32_bf16 v[176:179], a[168:171], v[72:75], v[176:179]
    ds_read_b64_tr_b16 v[64:65], v28 offset:24584
    v_mul_f32 v18, v134, v134
    v_add_f32 v35, v35, v131
    v_mfma_f32_16x16x32_bf16 v[180:183], a[172:175], v[72:75], v[180:183]
    ds_read_b64_tr_b16 v[66:67], v28 offset:25096
    buffer_load_dwordx4 a[252:255], v4, s[8:11], s68 offen offset:3072 sc1
    v_mfma_f32_16x16x32_bf16 v[184:187], a[168:171], v[76:79], v[184:187]
    ds_read_b64_tr_b16 v[68:69], v6 offset:28672
    v_rcp_f32 v16, v16
    v_mfma_f32_16x16x32_bf16 v[188:191], a[172:175], v[76:79], v[188:191]
    ds_read_b64_tr_b16 v[70:71], v6 offset:29184
    s_add_u32 m0, s33, 65536
    s_add_u32 s30, s62, 0
    buffer_load_dwordx4 v29, s[76:79], s30 offen lds
    s_waitcnt vmcnt(19) lgkmcnt(2)
    v_mfma_f32_16x16x32_bf16 v[144:147], a[176:179], v[80:83], v[144:147]
    ds_read_b64_tr_b16 v[72:73], v6 offset:28680
    v_exp_f32 v17, v17
    v_mfma_f32_16x16x32_bf16 v[148:151], a[180:183], v[80:83], v[148:151]
    ds_read_b64_tr_b16 v[74:75], v6 offset:29192
    s_add_u32 m0, s33, 66560
    s_add_u32 s30, s62, 16384
    buffer_load_dwordx4 v29, s[76:79], s30 offen lds
    v_mfma_f32_16x16x32_bf16 v[152:155], a[176:179], v[84:87], v[152:155]
    ds_read_b64_tr_b16 v[76:77], v28 offset:28672
    v_fma_f32 v18, v18, v9, v8
    v_fmac_f32 v43, v131, v131
    v_mfma_f32_16x16x32_bf16 v[156:159], a[180:183], v[84:87], v[156:159]
    ds_read_b64_tr_b16 v[78:79], v28 offset:29184
    s_add_u32 m0, s33, 67584
    s_add_u32 s30, s62, 32768
    buffer_load_dwordx4 v29, s[76:79], s30 offen lds
    v_mfma_f32_16x16x32_bf16 v[176:179], a[176:179], v[88:91], v[176:179]
    ds_read_b64_tr_b16 v[80:81], v28 offset:28680
    v_mul_f32 v132, v132, v16
    v_add_f32 v17, 1.0, v17
    v_mfma_f32_16x16x32_bf16 v[180:183], a[180:183], v[88:91], v[180:183]
    ds_read_b64_tr_b16 v[82:83], v28 offset:29192
    s_add_u32 m0, s33, 68608
    s_add_u32 s30, s62, 49152
    buffer_load_dwordx4 v29, s[76:79], s30 offen lds
    v_mfma_f32_16x16x32_bf16 v[184:187], a[176:179], v[64:67], v[184:187]
    ds_read_b64_tr_b16 v[84:85], v6 offset:32768
    v_mul_f32 v18, v18, v134
    v_mul_f32 v19, v135, v135
    v_mfma_f32_16x16x32_bf16 v[188:191], a[180:183], v[64:67], v[188:191]
    ds_read_b64_tr_b16 v[86:87], v6 offset:33280
    s_add_u32 m0, s33, 69632
    s_add_u32 s30, s62, 65536
    buffer_load_dwordx4 v29, s[76:79], s30 offen lds
    s_waitcnt vmcnt(21) lgkmcnt(2)
    v_mfma_f32_16x16x32_bf16 v[144:147], a[184:187], v[68:71], v[144:147]
    ds_read_b64_tr_b16 v[88:89], v6 offset:32776
    v_add_f32 v36, v36, v132
    v_fma_f32 v19, v19, v9, v8
    v_mfma_f32_16x16x32_bf16 v[148:151], a[188:191], v[68:71], v[148:151]
    ds_read_b64_tr_b16 v[90:91], v6 offset:33288
    s_add_u32 m0, s33, 70656
    s_add_u32 s30, s62, 81920
    buffer_load_dwordx4 v29, s[76:79], s30 offen lds
    v_mfma_f32_16x16x32_bf16 v[152:155], a[184:187], v[72:75], v[152:155]
    ds_read_b64_tr_b16 v[64:65], v28 offset:32768
    v_rcp_f32 v17, v17
    v_mfma_f32_16x16x32_bf16 v[156:159], a[188:191], v[72:75], v[156:159]
    ds_read_b64_tr_b16 v[66:67], v28 offset:33280
    s_add_u32 m0, s33, 71680
    s_add_u32 s30, s62, 98304
    buffer_load_dwordx4 v29, s[76:79], s30 offen lds
    v_mfma_f32_16x16x32_bf16 v[176:179], a[184:187], v[76:79], v[176:179]
    ds_read_b64_tr_b16 v[68:69], v28 offset:32776
    v_exp_f32 v18, v18
    v_mfma_f32_16x16x32_bf16 v[180:183], a[188:191], v[76:79], v[180:183]
    ds_read_b64_tr_b16 v[70:71], v28 offset:33288
    s_add_u32 m0, s33, 72704
    s_add_u32 s30, s62, 114688
    buffer_load_dwordx4 v29, s[76:79], s30 offen lds
    v_mfma_f32_16x16x32_bf16 v[184:187], a[184:187], v[80:83], v[184:187]
    ds_read_b64_tr_b16 v[72:73], v6 offset:36864
    v_fmac_f32 v44, v132, v132
    v_mul_f32 v133, v133, v17
    v_mfma_f32_16x16x32_bf16 v[188:191], a[188:191], v[80:83], v[188:191]
    ds_read_b64_tr_b16 v[74:75], v6 offset:37376
    s_add_u32 m0, s33, 98304
    s_add_u32 s30, s62, 524288
    buffer_load_dwordx4 v29, s[76:79], s30 offen lds
    s_waitcnt vmcnt(23) lgkmcnt(2)
    v_mfma_f32_16x16x32_bf16 v[144:147], a[192:195], v[84:87], v[144:147]
    ds_read_b64_tr_b16 v[76:77], v6 offset:36872
    v_add_f32 v18, 1.0, v18
    v_mul_f32 v19, v19, v135
    v_mfma_f32_16x16x32_bf16 v[148:151], a[196:199], v[84:87], v[148:151]
    ds_read_b64_tr_b16 v[78:79], v6 offset:37384
    s_add_u32 m0, s33, 99328
    s_add_u32 s30, s62, 540672
    buffer_load_dwordx4 v29, s[76:79], s30 offen lds
    v_mfma_f32_16x16x32_bf16 v[152:155], a[192:195], v[88:91], v[152:155]
    ds_read_b64_tr_b16 v[80:81], v28 offset:36864
    v_add_f32 v37, v37, v133
    v_fmac_f32 v45, v133, v133
    v_mfma_f32_16x16x32_bf16 v[156:159], a[196:199], v[88:91], v[156:159]
    ds_read_b64_tr_b16 v[82:83], v28 offset:37376
    s_add_u32 m0, s33, 100352
    s_add_u32 s30, s62, 557056
    buffer_load_dwordx4 v29, s[76:79], s30 offen lds
    v_mfma_f32_16x16x32_bf16 v[176:179], a[192:195], v[64:67], v[176:179]
    ds_read_b64_tr_b16 v[84:85], v28 offset:36872
    v_rcp_f32 v18, v18
    v_mfma_f32_16x16x32_bf16 v[180:183], a[196:199], v[64:67], v[180:183]
    ds_read_b64_tr_b16 v[86:87], v28 offset:37384
    s_add_u32 m0, s33, 101376
    s_add_u32 s30, s62, 573440
    buffer_load_dwordx4 v29, s[76:79], s30 offen lds
    v_mfma_f32_16x16x32_bf16 v[184:187], a[192:195], v[68:71], v[184:187]
    ds_read_b64_tr_b16 v[88:89], v6 offset:40960
    v_exp_f32 v19, v19
    v_mfma_f32_16x16x32_bf16 v[188:191], a[196:199], v[68:71], v[188:191]
    ds_read_b64_tr_b16 v[90:91], v6 offset:41472
    s_add_u32 m0, s33, 102400
    s_add_u32 s30, s62, 589824
    buffer_load_dwordx4 v29, s[76:79], s30 offen lds
    s_waitcnt vmcnt(25) lgkmcnt(2)
    v_mfma_f32_16x16x32_bf16 v[144:147], a[200:203], v[72:75], v[144:147]
    ds_read_b64_tr_b16 v[64:65], v6 offset:40968
    v_mul_f32 v134, v134, v18
    v_add_f32 v19, 1.0, v19
    v_mfma_f32_16x16x32_bf16 v[148:151], a[204:207], v[72:75], v[148:151]
    ds_read_b64_tr_b16 v[66:67], v6 offset:41480
    s_add_u32 m0, s33, 103424
    s_add_u32 s30, s62, 606208
    buffer_load_dwordx4 v29, s[76:79], s30 offen lds
    s_mov_b32 s46, 80936960
    buffer_load_dword v27, v11, s[8:11], s46 offen sc1
    v_mfma_f32_16x16x32_bf16 v[152:155], a[200:203], v[76:79], v[152:155]
    ds_read_b64_tr_b16 v[68:69], v28 offset:40960
    v_add_f32 v38, v38, v134
    v_fmac_f32 v46, v134, v134
    v_mfma_f32_16x16x32_bf16 v[156:159], a[204:207], v[76:79], v[156:159]
    ds_read_b64_tr_b16 v[70:71], v28 offset:41472
    s_add_u32 m0, s33, 104448
    s_add_u32 s30, s62, 622592
    buffer_load_dwordx4 v29, s[76:79], s30 offen lds
    v_mfma_f32_16x16x32_bf16 v[176:179], a[200:203], v[80:83], v[176:179]
    ds_read_b64_tr_b16 v[72:73], v28 offset:40968
    v_rcp_f32 v19, v19
    v_mfma_f32_16x16x32_bf16 v[180:183], a[204:207], v[80:83], v[180:183]
    ds_read_b64_tr_b16 v[74:75], v28 offset:41480
    s_add_u32 m0, s33, 105472
    s_add_u32 s30, s62, 638976
    buffer_load_dwordx4 v29, s[76:79], s30 offen lds
    v_mfma_f32_16x16x32_bf16 v[184:187], a[200:203], v[84:87], v[184:187]
    ds_read_b64_tr_b16 v[76:77], v6 offset:45056
    v_mul_f32 v135, v135, v19
    v_cvt_pk_bf16_f32 v96, v128, v129
    v_mfma_f32_16x16x32_bf16 v[188:191], a[204:207], v[84:87], v[188:191]
    ds_read_b64_tr_b16 v[78:79], v6 offset:45568
    v_add_f32 v39, v39, v135
    s_waitcnt vmcnt(27) lgkmcnt(2)
    v_mfma_f32_16x16x32_bf16 v[144:147], a[208:211], v[88:91], v[144:147]
    ds_read_b64_tr_b16 v[80:81], v6 offset:45064
    v_fmac_f32 v47, v135, v135
    v_cvt_pk_bf16_f32 v97, v130, v131
    v_mfma_f32_16x16x32_bf16 v[148:151], a[212:215], v[88:91], v[148:151]
    ds_read_b64_tr_b16 v[82:83], v6 offset:45576
    v_cvt_pk_bf16_f32 v98, v132, v133
    v_cvt_pk_bf16_f32 v99, v134, v135
    v_mfma_f32_16x16x32_bf16 v[152:155], a[208:211], v[64:67], v[152:155]
    ds_read_b64_tr_b16 v[84:85], v28 offset:45056
    buffer_store_dwordx4 v[96:99], v24, s[8:11], s56 offen offset:0 sc1
    v_mfma_f32_16x16x32_bf16 v[156:159], a[212:215], v[64:67], v[156:159]
    ds_read_b64_tr_b16 v[86:87], v28 offset:45568
    v_mul_f32 v16, v136, v136
    v_mul_f32 v17, v137, v137
    v_mfma_f32_16x16x32_bf16 v[176:179], a[208:211], v[68:71], v[176:179]
    ds_read_b64_tr_b16 v[88:89], v28 offset:45064
    v_fma_f32 v16, v16, v9, v8
    v_fma_f32 v17, v17, v9, v8
    v_mfma_f32_16x16x32_bf16 v[180:183], a[212:215], v[68:71], v[180:183]
    ds_read_b64_tr_b16 v[90:91], v28 offset:45576
    v_mul_f32 v16, v16, v136
    v_mul_f32 v17, v17, v137
    v_mfma_f32_16x16x32_bf16 v[184:187], a[208:211], v[72:75], v[184:187]
    ds_read_b64_tr_b16 v[64:65], v6 offset:49152
    v_exp_f32 v16, v16
    v_mfma_f32_16x16x32_bf16 v[188:191], a[212:215], v[72:75], v[188:191]
    ds_read_b64_tr_b16 v[66:67], v6 offset:49664
    v_add_f32 v16, 1.0, v16
    s_waitcnt vmcnt(26) lgkmcnt(2)
    v_mfma_f32_16x16x32_bf16 v[144:147], a[216:219], v[76:79], v[144:147]
    ds_read_b64_tr_b16 v[68:69], v6 offset:49160
    v_mul_f32 v18, v138, v138
    v_mul_f32 v19, v139, v139
    v_mfma_f32_16x16x32_bf16 v[148:151], a[220:223], v[76:79], v[148:151]
    ds_read_b64_tr_b16 v[70:71], v6 offset:49672
    v_rcp_f32 v16, v16
    v_mfma_f32_16x16x32_bf16 v[152:155], a[216:219], v[80:83], v[152:155]
    ds_read_b64_tr_b16 v[72:73], v28 offset:49152
    v_exp_f32 v17, v17
    v_mfma_f32_16x16x32_bf16 v[156:159], a[220:223], v[80:83], v[156:159]
    ds_read_b64_tr_b16 v[74:75], v28 offset:49664
    v_fma_f32 v18, v18, v9, v8
    v_mul_f32 v136, v136, v16
    v_mfma_f32_16x16x32_bf16 v[176:179], a[216:219], v[84:87], v[176:179]
    ds_read_b64_tr_b16 v[76:77], v28 offset:49160
    v_add_f32 v17, 1.0, v17
    v_mul_f32 v18, v18, v138
    v_mfma_f32_16x16x32_bf16 v[180:183], a[220:223], v[84:87], v[180:183]
    ds_read_b64_tr_b16 v[78:79], v28 offset:49672
    v_add_f32 v32, v32, v136
    v_fma_f32 v19, v19, v9, v8
    v_mfma_f32_16x16x32_bf16 v[184:187], a[216:219], v[88:91], v[184:187]
    ds_read_b64_tr_b16 v[80:81], v6 offset:53248
    v_rcp_f32 v17, v17
    v_mfma_f32_16x16x32_bf16 v[188:191], a[220:223], v[88:91], v[188:191]
    ds_read_b64_tr_b16 v[82:83], v6 offset:53760
    v_fmac_f32 v40, v136, v136
    s_waitcnt vmcnt(24) lgkmcnt(2)
    v_mfma_f32_16x16x32_bf16 v[144:147], a[224:227], v[64:67], v[144:147]
    ds_read_b64_tr_b16 v[84:85], v6 offset:53256
    v_exp_f32 v18, v18
    v_mfma_f32_16x16x32_bf16 v[148:151], a[228:231], v[64:67], v[148:151]
    ds_read_b64_tr_b16 v[86:87], v6 offset:53768
    v_mul_f32 v137, v137, v17
    v_add_f32 v18, 1.0, v18
    v_mfma_f32_16x16x32_bf16 v[152:155], a[224:227], v[68:71], v[152:155]
    ds_read_b64_tr_b16 v[88:89], v28 offset:53248
    v_mul_f32 v19, v19, v139
    v_mul_f32 v16, v140, v140
    v_mfma_f32_16x16x32_bf16 v[156:159], a[228:231], v[68:71], v[156:159]
    ds_read_b64_tr_b16 v[90:91], v28 offset:53760
    v_add_f32 v33, v33, v137
    v_fma_f32 v16, v16, v9, v8
    v_mfma_f32_16x16x32_bf16 v[176:179], a[224:227], v[72:75], v[176:179]
    ds_read_b64_tr_b16 v[64:65], v28 offset:53256
    v_rcp_f32 v18, v18
    v_mfma_f32_16x16x32_bf16 v[180:183], a[228:231], v[72:75], v[180:183]
    ds_read_b64_tr_b16 v[66:67], v28 offset:53768
    v_exp_f32 v19, v19
    v_mfma_f32_16x16x32_bf16 v[184:187], a[224:227], v[76:79], v[184:187]
    ds_read_b64_tr_b16 v[68:69], v6 offset:57344
    v_fmac_f32 v41, v137, v137
    v_mul_f32 v138, v138, v18
    v_mfma_f32_16x16x32_bf16 v[188:191], a[228:231], v[76:79], v[188:191]
    ds_read_b64_tr_b16 v[70:71], v6 offset:57856
    v_add_f32 v19, 1.0, v19
    s_waitcnt vmcnt(22) lgkmcnt(2)
    v_mfma_f32_16x16x32_bf16 v[144:147], a[232:235], v[80:83], v[144:147]
    ds_read_b64_tr_b16 v[72:73], v6 offset:57352
    v_mul_f32 v16, v16, v140
    v_mul_f32 v17, v141, v141
    v_mfma_f32_16x16x32_bf16 v[148:151], a[236:239], v[80:83], v[148:151]
    ds_read_b64_tr_b16 v[74:75], v6 offset:57864
    v_add_f32 v34, v34, v138
    v_fma_f32 v17, v17, v9, v8
    v_mfma_f32_16x16x32_bf16 v[152:155], a[232:235], v[84:87], v[152:155]
    ds_read_b64_tr_b16 v[76:77], v28 offset:57344
    v_rcp_f32 v19, v19
    v_mfma_f32_16x16x32_bf16 v[156:159], a[236:239], v[84:87], v[156:159]
    ds_read_b64_tr_b16 v[78:79], v28 offset:57856
    v_exp_f32 v16, v16
    v_mfma_f32_16x16x32_bf16 v[176:179], a[232:235], v[88:91], v[176:179]
    ds_read_b64_tr_b16 v[80:81], v28 offset:57352
    v_fmac_f32 v42, v138, v138
    v_mul_f32 v139, v139, v19
    v_mfma_f32_16x16x32_bf16 v[180:183], a[236:239], v[88:91], v[180:183]
    ds_read_b64_tr_b16 v[82:83], v28 offset:57864
    v_add_f32 v16, 1.0, v16
    v_mul_f32 v17, v17, v141
    v_mfma_f32_16x16x32_bf16 v[184:187], a[232:235], v[64:67], v[184:187]
    ds_read_b64_tr_b16 v[84:85], v6 offset:61440
    v_mul_f32 v18, v142, v142
    v_add_f32 v35, v35, v139
    v_mfma_f32_16x16x32_bf16 v[188:191], a[236:239], v[64:67], v[188:191]
    ds_read_b64_tr_b16 v[86:87], v6 offset:61952
    v_fma_f32 v18, v18, v9, v8
    s_waitcnt vmcnt(20) lgkmcnt(2)
    v_mfma_f32_16x16x32_bf16 v[144:147], a[240:243], v[68:71], v[144:147]
    ds_read_b64_tr_b16 v[88:89], v6 offset:61448
    v_rcp_f32 v16, v16
    v_mfma_f32_16x16x32_bf16 v[148:151], a[244:247], v[68:71], v[148:151]
    ds_read_b64_tr_b16 v[90:91], v6 offset:61960
    v_exp_f32 v17, v17
    s_waitcnt vmcnt(1)
    s_barrier
    v_mfma_f32_16x16x32_bf16 v[152:155], a[240:243], v[72:75], v[152:155]
    ds_read_b64_tr_b16 v[64:65], v28 offset:61440
    v_fmac_f32 v43, v139, v139
    v_mul_f32 v140, v140, v16
    v_mfma_f32_16x16x32_bf16 v[156:159], a[244:247], v[72:75], v[156:159]
    ds_read_b64_tr_b16 v[66:67], v28 offset:61952
    v_add_f32 v17, 1.0, v17
    v_mul_f32 v18, v18, v142
    v_mfma_f32_16x16x32_bf16 v[176:179], a[240:243], v[76:79], v[176:179]
    ds_read_b64_tr_b16 v[68:69], v28 offset:61448
    v_mul_f32 v19, v143, v143
    v_add_f32 v36, v36, v140
    v_mfma_f32_16x16x32_bf16 v[180:183], a[244:247], v[76:79], v[180:183]
    ds_read_b64_tr_b16 v[70:71], v28 offset:61960
    v_rcp_f32 v17, v17
    v_add_u32 v6, 65536, v6
    v_add_u32 v28, 65536, v28
    v_add_u32 v29, 131072, v7
    v_mfma_f32_16x16x32_bf16 v[184:187], a[240:243], v[80:83], v[184:187]
    ds_read_b64_tr_b16 v[72:73], v6 offset:0
    v_exp_f32 v18, v18
    v_mfma_f32_16x16x32_bf16 v[188:191], a[244:247], v[80:83], v[188:191]
    ds_read_b64_tr_b16 v[74:75], v6 offset:512
    v_fma_f32 v19, v19, v9, v8
    s_waitcnt vmcnt(18) lgkmcnt(2)
    v_mfma_f32_16x16x32_bf16 v[144:147], a[248:251], v[84:87], v[144:147]
    ds_read_b64_tr_b16 v[76:77], v6 offset:4096
    v_fmac_f32 v44, v140, v140
    v_mul_f32 v141, v141, v17
    v_mfma_f32_16x16x32_bf16 v[148:151], a[252:255], v[84:87], v[148:151]
    ds_read_b64_tr_b16 v[78:79], v6 offset:4608
    v_add_f32 v18, 1.0, v18
    v_mul_f32 v19, v19, v143
    v_mfma_f32_16x16x32_bf16 v[152:155], a[248:251], v[88:91], v[152:155]
    ds_read_b64_tr_b16 v[80:81], v6 offset:8192
    v_add_f32 v37, v37, v141
    v_fmac_f32 v45, v141, v141
    v_mfma_f32_16x16x32_bf16 v[156:159], a[252:255], v[88:91], v[156:159]
    ds_read_b64_tr_b16 v[82:83], v6 offset:8704
    v_rcp_f32 v18, v18
    v_mfma_f32_16x16x32_bf16 v[176:179], a[248:251], v[64:67], v[176:179]
    ds_read_b64_tr_b16 v[84:85], v6 offset:12288
    v_exp_f32 v19, v19
    v_mfma_f32_16x16x32_bf16 v[180:183], a[252:255], v[64:67], v[180:183]
    ds_read_b64_tr_b16 v[86:87], v6 offset:12800
    v_mul_f32 v142, v142, v18
    v_add_f32 v19, 1.0, v19
    v_mfma_f32_16x16x32_bf16 v[184:187], a[248:251], v[68:71], v[184:187]
    ds_read_b64_tr_b16 v[88:89], v6 offset:16384
    v_add_f32 v38, v38, v142
    v_fmac_f32 v46, v142, v142
    v_mfma_f32_16x16x32_bf16 v[188:191], a[252:255], v[68:71], v[188:191]
    ds_read_b64_tr_b16 v[90:91], v6 offset:16896
    v_cvt_pk_bf16_f32 v100, v136, v137
    s_waitcnt lgkmcnt(2)
    v_mfma_f32_16x16x32_bf16 v[192:195], v[72:75], a[0:3], 0
    ds_read_b64_tr_b16 v[64:65], v6 offset:20480
    v_rcp_f32 v19, v19
    v_mfma_f32_16x16x32_bf16 v[192:195], v[76:79], a[8:11], v[192:195]
    ds_read_b64_tr_b16 v[66:67], v6 offset:20992
    v_mul_f32 v143, v143, v19
    v_cvt_pk_bf16_f32 v101, v138, v139
    v_mfma_f32_16x16x32_bf16 v[200:203], v[72:75], a[4:7], 0
    v_add_f32 v39, v39, v143
    v_fmac_f32 v47, v143, v143
    v_cvt_pk_bf16_f32 v102, v140, v141
    v_mfma_f32_16x16x32_bf16 v[200:203], v[76:79], a[12:15], v[200:203]
    v_cvt_pk_bf16_f32 v103, v142, v143
    v_mul_f32 v16, v144, v144
    v_mul_f32 v17, v145, v145
    s_waitcnt vmcnt(3)
    v_cmp_ne_u32 vcc, s75, v27
    s_cbranch_vccnz L_frs
L_frk:
    s_barrier
    v_mfma_f32_16x16x32_bf16 v[208:211], v[72:75], a[128:131], 0
    ds_read_b64_tr_b16 v[68:69], v6 offset:24576
    buffer_store_dwordx4 v[100:103], v24, s[8:11], s56 offen offset:1024 sc1
    v_mfma_f32_16x16x32_bf16 v[208:211], v[76:79], a[136:139], v[208:211]
    ds_read_b64_tr_b16 v[70:71], v6 offset:25088
    v_fma_f32 v16, v16, v9, v8
    v_fma_f32 v17, v17, v9, v8
    v_mfma_f32_16x16x32_bf16 v[216:219], v[72:75], a[132:135], 0
    s_add_u32 m0, s33, 0
    s_nop 0
    buffer_load_dwordx4 v1, s[8:11], s69 offen offset:0 sc1 lds
    v_mfma_f32_16x16x32_bf16 v[216:219], v[76:79], a[140:143], v[216:219]
    v_mul_f32 v16, v16, v144
    v_mul_f32 v17, v17, v145
    v_mul_f32 v18, v146, v146
    v_mfma_f32_16x16x32_bf16 v[216:219], v[80:83], a[148:151], v[216:219]
    ds_read_b64_tr_b16 v[72:73], v6 offset:28672
    v_exp_f32 v16, v16
    v_mfma_f32_16x16x32_bf16 v[216:219], v[84:87], a[156:159], v[216:219]
    ds_read_b64_tr_b16 v[74:75], v6 offset:29184
    v_add_f32 v16, 1.0, v16
    v_fma_f32 v18, v18, v9, v8
    v_mfma_f32_16x16x32_bf16 v[208:211], v[80:83], a[144:147], v[208:211]
    buffer_load_dwordx4 v1, s[8:11], s69 offen offset:1024 sc1 lds
    v_mfma_f32_16x16x32_bf16 v[208:211], v[84:87], a[152:155], v[208:211]
    v_rcp_f32 v16, v16
    v_mul_f32 v18, v18, v146
    v_mfma_f32_16x16x32_bf16 v[200:203], v[80:83], a[20:23], v[200:203]
    ds_read_b64_tr_b16 v[76:77], v6 offset:32768
    v_exp_f32 v17, v17
    v_mfma_f32_16x16x32_bf16 v[200:203], v[84:87], a[28:31], v[200:203]
    ds_read_b64_tr_b16 v[78:79], v6 offset:33280
    v_mul_f32 v144, v144, v16
    v_add_f32 v17, 1.0, v17
    v_mfma_f32_16x16x32_bf16 v[192:195], v[80:83], a[16:19], v[192:195]
    buffer_load_dwordx4 v1, s[8:11], s69 offen offset:2048 sc1 lds
    v_mfma_f32_16x16x32_bf16 v[192:195], v[84:87], a[24:27], v[192:195]
    v_mul_f32 v19, v147, v147
    v_add_f32 v48, v48, v144
    s_waitcnt lgkmcnt(2)
    v_mfma_f32_16x16x32_bf16 v[192:195], v[88:91], a[32:35], v[192:195]
    ds_read_b64_tr_b16 v[80:81], v6 offset:36864
    v_rcp_f32 v17, v17
    v_mfma_f32_16x16x32_bf16 v[192:195], v[64:67], a[40:43], v[192:195]
    ds_read_b64_tr_b16 v[82:83], v6 offset:37376
    v_exp_f32 v18, v18
    v_mfma_f32_16x16x32_bf16 v[200:203], v[88:91], a[36:39], v[200:203]
    buffer_load_dwordx4 v1, s[8:11], s69 offen offset:3072 sc1 lds
    v_mfma_f32_16x16x32_bf16 v[200:203], v[64:67], a[44:47], v[200:203]
    v_fma_f32 v19, v19, v9, v8
    v_fmac_f32 v56, v144, v144
    v_mul_f32 v145, v145, v17
    v_mfma_f32_16x16x32_bf16 v[208:211], v[88:91], a[160:163], v[208:211]
    ds_read_b64_tr_b16 v[84:85], v6 offset:40960
    v_add_f32 v18, 1.0, v18
    v_mul_f32 v19, v19, v147
    v_mfma_f32_16x16x32_bf16 v[208:211], v[64:67], a[168:171], v[208:211]
    ds_read_b64_tr_b16 v[86:87], v6 offset:41472
    v_mul_f32 v16, v148, v148
    v_add_f32 v49, v49, v145
    v_mfma_f32_16x16x32_bf16 v[216:219], v[88:91], a[164:167], v[216:219]
    s_add_u32 m0, s33, 4096
    s_nop 0
    buffer_load_dwordx4 v2, s[8:11], s69 offen offset:0 sc1 lds
    v_mfma_f32_16x16x32_bf16 v[216:219], v[64:67], a[172:175], v[216:219]
    v_rcp_f32 v18, v18
    v_fma_f32 v16, v16, v9, v8
    v_mfma_f32_16x16x32_bf16 v[216:219], v[68:71], a[180:183], v[216:219]
    ds_read_b64_tr_b16 v[88:89], v6 offset:45056
    v_exp_f32 v19, v19
    v_mfma_f32_16x16x32_bf16 v[216:219], v[72:75], a[188:191], v[216:219]
    ds_read_b64_tr_b16 v[90:91], v6 offset:45568
    v_fmac_f32 v57, v145, v145
    v_mul_f32 v146, v146, v18
    v_mfma_f32_16x16x32_bf16 v[208:211], v[68:71], a[176:179], v[208:211]
    buffer_load_dwordx4 v2, s[8:11], s69 offen offset:1024 sc1 lds
    v_mfma_f32_16x16x32_bf16 v[208:211], v[72:75], a[184:187], v[208:211]
    v_add_f32 v19, 1.0, v19
    v_mul_f32 v16, v16, v148
    v_mul_f32 v17, v149, v149
    v_mfma_f32_16x16x32_bf16 v[200:203], v[68:71], a[52:55], v[200:203]
    ds_read_b64_tr_b16 v[64:65], v6 offset:49152
    v_add_f32 v50, v50, v146
    v_fma_f32 v17, v17, v9, v8
    v_mfma_f32_16x16x32_bf16 v[200:203], v[72:75], a[60:63], v[200:203]
    ds_read_b64_tr_b16 v[66:67], v6 offset:49664
    v_rcp_f32 v19, v19
    v_mfma_f32_16x16x32_bf16 v[192:195], v[68:71], a[48:51], v[192:195]
    buffer_load_dwordx4 v2, s[8:11], s69 offen offset:2048 sc1 lds
    v_mfma_f32_16x16x32_bf16 v[192:195], v[72:75], a[56:59], v[192:195]
    v_exp_f32 v16, v16
    s_waitcnt lgkmcnt(2)
    v_mfma_f32_16x16x32_bf16 v[192:195], v[76:79], a[64:67], v[192:195]
    ds_read_b64_tr_b16 v[68:69], v6 offset:53248
    v_fmac_f32 v58, v146, v146
    v_mul_f32 v147, v147, v19
    v_mfma_f32_16x16x32_bf16 v[192:195], v[80:83], a[72:75], v[192:195]
    ds_read_b64_tr_b16 v[70:71], v6 offset:53760
    v_add_f32 v16, 1.0, v16
    v_mul_f32 v17, v17, v149
    v_mfma_f32_16x16x32_bf16 v[200:203], v[76:79], a[68:71], v[200:203]
    buffer_load_dwordx4 v2, s[8:11], s69 offen offset:3072 sc1 lds
    v_mfma_f32_16x16x32_bf16 v[200:203], v[80:83], a[76:79], v[200:203]
    v_mul_f32 v18, v150, v150
    v_add_f32 v51, v51, v147
    v_fmac_f32 v59, v147, v147
    v_mfma_f32_16x16x32_bf16 v[208:211], v[76:79], a[192:195], v[208:211]
    ds_read_b64_tr_b16 v[72:73], v6 offset:57344
    v_rcp_f32 v16, v16
    v_mfma_f32_16x16x32_bf16 v[208:211], v[80:83], a[200:203], v[208:211]
    ds_read_b64_tr_b16 v[74:75], v6 offset:57856
    v_exp_f32 v17, v17
    v_mfma_f32_16x16x32_bf16 v[216:219], v[76:79], a[196:199], v[216:219]
    s_add_u32 m0, s33, 32768
    s_nop 0
    buffer_load_dwordx4 v1, s[8:11], s70 offen offset:0 sc1 lds
    v_mfma_f32_16x16x32_bf16 v[216:219], v[80:83], a[204:207], v[216:219]
    v_fma_f32 v18, v18, v9, v8
    v_mul_f32 v148, v148, v16
    v_add_f32 v17, 1.0, v17
    v_mfma_f32_16x16x32_bf16 v[216:219], v[84:87], a[212:215], v[216:219]
    ds_read_b64_tr_b16 v[76:77], v6 offset:61440
    v_mul_f32 v18, v18, v150
    v_mul_f32 v19, v151, v151
    v_mfma_f32_16x16x32_bf16 v[216:219], v[88:91], a[220:223], v[216:219]
    ds_read_b64_tr_b16 v[78:79], v6 offset:61952
    v_add_f32 v52, v52, v148
    v_fma_f32 v19, v19, v9, v8
    v_mfma_f32_16x16x32_bf16 v[208:211], v[84:87], a[208:211], v[208:211]
    buffer_load_dwordx4 v1, s[8:11], s70 offen offset:1024 sc1 lds
    v_mfma_f32_16x16x32_bf16 v[208:211], v[88:91], a[216:219], v[208:211]
    v_rcp_f32 v17, v17
    v_fmac_f32 v60, v148, v148
    v_mfma_f32_16x16x32_bf16 v[200:203], v[84:87], a[84:87], v[200:203]
    ds_read_b64_tr_b16 v[80:81], v6 offset:8
    v_exp_f32 v18, v18
    v_mfma_f32_16x16x32_bf16 v[200:203], v[88:91], a[92:95], v[200:203]
    ds_read_b64_tr_b16 v[82:83], v6 offset:520
    v_mul_f32 v149, v149, v17
    v_add_f32 v18, 1.0, v18
    v_mfma_f32_16x16x32_bf16 v[192:195], v[84:87], a[80:83], v[192:195]
    buffer_load_dwordx4 v1, s[8:11], s70 offen offset:2048 sc1 lds
    v_mfma_f32_16x16x32_bf16 v[192:195], v[88:91], a[88:91], v[192:195]
    v_mul_f32 v19, v19, v151
    v_add_f32 v53, v53, v149
    s_waitcnt lgkmcnt(2)
    v_mfma_f32_16x16x32_bf16 v[192:195], v[64:67], a[96:99], v[192:195]
    ds_read_b64_tr_b16 v[84:85], v6 offset:4104
    v_rcp_f32 v18, v18
    v_mfma_f32_16x16x32_bf16 v[192:195], v[68:71], a[104:107], v[192:195]
    ds_read_b64_tr_b16 v[86:87], v6 offset:4616
    v_exp_f32 v19, v19
    v_mfma_f32_16x16x32_bf16 v[200:203], v[64:67], a[100:103], v[200:203]
    buffer_load_dwordx4 v1, s[8:11], s70 offen offset:3072 sc1 lds
    v_mfma_f32_16x16x32_bf16 v[200:203], v[68:71], a[108:111], v[200:203]
    v_fmac_f32 v61, v149, v149
    v_mul_f32 v150, v150, v18
    v_add_f32 v19, 1.0, v19
    v_mfma_f32_16x16x32_bf16 v[208:211], v[64:67], a[224:227], v[208:211]
    ds_read_b64_tr_b16 v[88:89], v6 offset:8200
    v_add_f32 v54, v54, v150
    v_fmac_f32 v62, v150, v150
    v_mfma_f32_16x16x32_bf16 v[208:211], v[68:71], a[232:235], v[208:211]
    ds_read_b64_tr_b16 v[90:91], v6 offset:8712
    v_rcp_f32 v19, v19
    v_mfma_f32_16x16x32_bf16 v[216:219], v[64:67], a[228:231], v[216:219]
    s_add_u32 m0, s33, 36864
    s_nop 0
    buffer_load_dwordx4 v2, s[8:11], s70 offen offset:0 sc1 lds
    v_mfma_f32_16x16x32_bf16 v[216:219], v[68:71], a[236:239], v[216:219]
    v_mul_f32 v151, v151, v19
    v_cvt_pk_bf16_f32 v104, v144, v145
    v_cvt_pk_bf16_f32 v105, v146, v147
    v_mfma_f32_16x16x32_bf16 v[216:219], v[72:75], a[244:247], v[216:219]
    ds_read_b64_tr_b16 v[64:65], v6 offset:12296
    v_add_f32 v55, v55, v151
    v_fmac_f32 v63, v151, v151
    v_mfma_f32_16x16x32_bf16 v[216:219], v[76:79], a[252:255], v[216:219]
    ds_read_b64_tr_b16 v[66:67], v6 offset:12808
    v_cvt_pk_bf16_f32 v106, v148, v149
    v_cvt_pk_bf16_f32 v107, v150, v151
    v_mfma_f32_16x16x32_bf16 v[208:211], v[72:75], a[240:243], v[208:211]
    buffer_load_dwordx4 v2, s[8:11], s70 offen offset:1024 sc1 lds
    v_mfma_f32_16x16x32_bf16 v[208:211], v[76:79], a[248:251], v[208:211]
    buffer_store_dwordx4 v[104:107], v25, s[8:11], s57 offen offset:0 sc1
    v_mul_f32 v16, v152, v152
    v_mfma_f32_16x16x32_bf16 v[200:203], v[72:75], a[116:119], v[200:203]
    ds_read_b64_tr_b16 v[68:69], v6 offset:16392
    v_fma_f32 v16, v16, v9, v8
    v_mul_f32 v17, v153, v153
    v_mfma_f32_16x16x32_bf16 v[200:203], v[76:79], a[124:127], v[200:203]
    ds_read_b64_tr_b16 v[70:71], v6 offset:16904
    v_mul_f32 v16, v16, v152
    v_fma_f32 v17, v17, v9, v8
    v_mfma_f32_16x16x32_bf16 v[192:195], v[72:75], a[112:115], v[192:195]
    buffer_load_dwordx4 v2, s[8:11], s70 offen offset:2048 sc1 lds
    v_mfma_f32_16x16x32_bf16 v[192:195], v[76:79], a[120:123], v[192:195]
    v_exp_f32 v16, v16
    s_waitcnt lgkmcnt(2)
    v_mfma_f32_16x16x32_bf16 v[196:199], v[80:83], a[0:3], 0
    ds_read_b64_tr_b16 v[72:73], v6 offset:20488
    v_add_f32 v16, 1.0, v16
    v_mul_f32 v17, v17, v153
    v_mfma_f32_16x16x32_bf16 v[196:199], v[84:87], a[8:11], v[196:199]
    ds_read_b64_tr_b16 v[74:75], v6 offset:21000
    v_mul_f32 v18, v154, v154
    v_mul_f32 v19, v155, v155
    v_mfma_f32_16x16x32_bf16 v[204:207], v[80:83], a[4:7], 0
    buffer_load_dwordx4 v2, s[8:11], s70 offen offset:3072 sc1 lds
    v_mfma_f32_16x16x32_bf16 v[204:207], v[84:87], a[12:15], v[204:207]
    v_rcp_f32 v16, v16
    v_fma_f32 v18, v18, v9, v8
    v_mfma_f32_16x16x32_bf16 v[212:215], v[80:83], a[128:131], 0
    ds_read_b64_tr_b16 v[76:77], v6 offset:24584
    v_exp_f32 v17, v17
    v_mfma_f32_16x16x32_bf16 v[212:215], v[84:87], a[136:139], v[212:215]
    ds_read_b64_tr_b16 v[78:79], v6 offset:25096
    v_mul_f32 v152, v152, v16
    v_add_f32 v17, 1.0, v17
    v_mfma_f32_16x16x32_bf16 v[220:223], v[80:83], a[132:135], 0
    s_add_u32 s30, s65, 0
    s_add_u32 m0, s33, 131072
    s_nop 0
    buffer_load_dwordx4 v1, s[8:11], s30 offen offset:0 sc1 lds
    v_mfma_f32_16x16x32_bf16 v[220:223], v[84:87], a[140:143], v[220:223]
    v_mul_f32 v18, v18, v154
    v_add_f32 v48, v48, v152
    v_fma_f32 v19, v19, v9, v8
    v_mfma_f32_16x16x32_bf16 v[220:223], v[88:91], a[148:151], v[220:223]
    ds_read_b64_tr_b16 v[80:81], v6 offset:28680
    v_rcp_f32 v17, v17
    v_mfma_f32_16x16x32_bf16 v[220:223], v[64:67], a[156:159], v[220:223]
    ds_read_b64_tr_b16 v[82:83], v6 offset:29192
    v_exp_f32 v18, v18
    v_mfma_f32_16x16x32_bf16 v[212:215], v[88:91], a[144:147], v[212:215]
    buffer_load_dwordx4 v1, s[8:11], s30 offen offset:1024 sc1 lds
    v_mfma_f32_16x16x32_bf16 v[212:215], v[64:67], a[152:155], v[212:215]
    v_fmac_f32 v56, v152, v152
    v_mul_f32 v153, v153, v17
    v_add_f32 v18, 1.0, v18
    v_mfma_f32_16x16x32_bf16 v[204:207], v[88:91], a[20:23], v[204:207]
    ds_read_b64_tr_b16 v[84:85], v6 offset:32776
    v_mul_f32 v19, v19, v155
    v_mul_f32 v16, v156, v156
    v_mfma_f32_16x16x32_bf16 v[204:207], v[64:67], a[28:31], v[204:207]
    ds_read_b64_tr_b16 v[86:87], v6 offset:33288
    v_add_f32 v49, v49, v153
    v_fma_f32 v16, v16, v9, v8
    v_mfma_f32_16x16x32_bf16 v[196:199], v[88:91], a[16:19], v[196:199]
    buffer_load_dwordx4 v1, s[8:11], s30 offen offset:2048 sc1 lds
    v_mfma_f32_16x16x32_bf16 v[196:199], v[64:67], a[24:27], v[196:199]
    v_rcp_f32 v18, v18
    s_waitcnt lgkmcnt(2)
    v_mfma_f32_16x16x32_bf16 v[196:199], v[68:71], a[32:35], v[196:199]
    ds_read_b64_tr_b16 v[88:89], v6 offset:36872
    v_exp_f32 v19, v19
    v_mfma_f32_16x16x32_bf16 v[196:199], v[72:75], a[40:43], v[196:199]
    ds_read_b64_tr_b16 v[90:91], v6 offset:37384
    v_fmac_f32 v57, v153, v153
    v_mul_f32 v154, v154, v18
    v_mfma_f32_16x16x32_bf16 v[204:207], v[68:71], a[36:39], v[204:207]
    buffer_load_dwordx4 v1, s[8:11], s30 offen offset:3072 sc1 lds
    v_mfma_f32_16x16x32_bf16 v[204:207], v[72:75], a[44:47], v[204:207]
    v_add_f32 v19, 1.0, v19
    v_mul_f32 v16, v16, v156
    v_mul_f32 v17, v157, v157
    v_mfma_f32_16x16x32_bf16 v[212:215], v[68:71], a[160:163], v[212:215]
    ds_read_b64_tr_b16 v[64:65], v6 offset:40968
    v_add_f32 v50, v50, v154
    v_fma_f32 v17, v17, v9, v8
    v_mfma_f32_16x16x32_bf16 v[212:215], v[72:75], a[168:171], v[212:215]
    ds_read_b64_tr_b16 v[66:67], v6 offset:41480
    v_rcp_f32 v19, v19
    v_mfma_f32_16x16x32_bf16 v[220:223], v[68:71], a[164:167], v[220:223]
    s_add_u32 m0, s33, 135168
    s_nop 0
    buffer_load_dwordx4 v2, s[8:11], s30 offen offset:0 sc1 lds
    v_mfma_f32_16x16x32_bf16 v[220:223], v[72:75], a[172:175], v[220:223]
    v_exp_f32 v16, v16
    v_fmac_f32 v58, v154, v154
    v_mfma_f32_16x16x32_bf16 v[220:223], v[76:79], a[180:183], v[220:223]
    ds_read_b64_tr_b16 v[68:69], v6 offset:45064
    v_mul_f32 v155, v155, v19
    v_add_f32 v16, 1.0, v16
    v_mfma_f32_16x16x32_bf16 v[220:223], v[80:83], a[188:191], v[220:223]
    ds_read_b64_tr_b16 v[70:71], v6 offset:45576
    v_mul_f32 v17, v17, v157
    v_mul_f32 v18, v158, v158
    v_mfma_f32_16x16x32_bf16 v[212:215], v[76:79], a[176:179], v[212:215]
    buffer_load_dwordx4 v2, s[8:11], s30 offen offset:1024 sc1 lds
    v_mfma_f32_16x16x32_bf16 v[212:215], v[80:83], a[184:187], v[212:215]
    v_add_f32 v51, v51, v155
    v_rcp_f32 v16, v16
    v_mfma_f32_16x16x32_bf16 v[204:207], v[76:79], a[52:55], v[204:207]
    ds_read_b64_tr_b16 v[72:73], v6 offset:49160
    v_exp_f32 v17, v17
    v_mfma_f32_16x16x32_bf16 v[204:207], v[80:83], a[60:63], v[204:207]
    ds_read_b64_tr_b16 v[74:75], v6 offset:49672
    v_fma_f32 v18, v18, v9, v8
    v_fmac_f32 v59, v155, v155
    v_mfma_f32_16x16x32_bf16 v[196:199], v[76:79], a[48:51], v[196:199]
    buffer_load_dwordx4 v2, s[8:11], s30 offen offset:2048 sc1 lds
    v_mfma_f32_16x16x32_bf16 v[196:199], v[80:83], a[56:59], v[196:199]
    v_mul_f32 v156, v156, v16
    v_add_f32 v17, 1.0, v17
    s_waitcnt lgkmcnt(2)
    v_mfma_f32_16x16x32_bf16 v[196:199], v[84:87], a[64:67], v[196:199]
    ds_read_b64_tr_b16 v[76:77], v6 offset:53256
    v_mul_f32 v18, v18, v158
    v_mul_f32 v19, v159, v159
    v_mfma_f32_16x16x32_bf16 v[196:199], v[88:91], a[72:75], v[196:199]
    ds_read_b64_tr_b16 v[78:79], v6 offset:53768
    v_add_f32 v52, v52, v156
    v_fma_f32 v19, v19, v9, v8
    v_mfma_f32_16x16x32_bf16 v[204:207], v[84:87], a[68:71], v[204:207]
    buffer_load_dwordx4 v2, s[8:11], s30 offen offset:3072 sc1 lds
    v_mfma_f32_16x16x32_bf16 v[204:207], v[88:91], a[76:79], v[204:207]
    v_rcp_f32 v17, v17
    v_fmac_f32 v60, v156, v156
    v_mfma_f32_16x16x32_bf16 v[212:215], v[84:87], a[192:195], v[212:215]
    ds_read_b64_tr_b16 v[80:81], v6 offset:57352
    v_exp_f32 v18, v18
    v_mfma_f32_16x16x32_bf16 v[212:215], v[88:91], a[200:203], v[212:215]
    ds_read_b64_tr_b16 v[82:83], v6 offset:57864
    v_mul_f32 v157, v157, v17
    v_add_f32 v18, 1.0, v18
    v_mfma_f32_16x16x32_bf16 v[220:223], v[84:87], a[196:199], v[220:223]
    v_mul_f32 v19, v19, v159
    v_add_f32 v53, v53, v157
    v_fmac_f32 v61, v157, v157
    v_mfma_f32_16x16x32_bf16 v[220:223], v[88:91], a[204:207], v[220:223]
    v_rcp_f32 v18, v18
    v_cvt_pk_bf16_f32 v108, v152, v153
    v_mfma_f32_16x16x32_bf16 v[220:223], v[64:67], a[212:215], v[220:223]
    ds_read_b64_tr_b16 v[84:85], v6 offset:61448
    v_exp_f32 v19, v19
    v_mfma_f32_16x16x32_bf16 v[220:223], v[68:71], a[220:223], v[220:223]
    ds_read_b64_tr_b16 v[86:87], v6 offset:61960
    v_mul_f32 v158, v158, v18
    v_add_f32 v19, 1.0, v19
    v_mfma_f32_16x16x32_bf16 v[212:215], v[64:67], a[208:211], v[212:215]
    v_add_f32 v54, v54, v158
    v_rcp_f32 v19, v19
    v_mfma_f32_16x16x32_bf16 v[212:215], v[68:71], a[216:219], v[212:215]
    v_fmac_f32 v62, v158, v158
    v_mul_f32 v159, v159, v19
    v_cvt_pk_bf16_f32 v109, v154, v155
    v_mfma_f32_16x16x32_bf16 v[204:207], v[64:67], a[84:87], v[204:207]
    ds_read_b64_tr_b16 v[88:89], v28 offset:0
    v_add_f32 v55, v55, v159
    v_fmac_f32 v63, v159, v159
    v_mfma_f32_16x16x32_bf16 v[204:207], v[68:71], a[92:95], v[204:207]
    ds_read_b64_tr_b16 v[90:91], v28 offset:512
    v_cvt_pk_bf16_f32 v110, v156, v157
    v_cvt_pk_bf16_f32 v111, v158, v159
    v_mfma_f32_16x16x32_bf16 v[196:199], v[64:67], a[80:83], v[196:199]
    buffer_store_dwordx4 v[108:111], v25, s[8:11], s57 offen offset:1024 sc1
    v_mul_f32 v20, v160, v160
    v_mfma_f32_16x16x32_bf16 v[196:199], v[68:71], a[88:91], v[196:199]
    v_fma_f32 v20, v20, v9, v8
    v_mul_f32 v21, v161, v161
    s_waitcnt lgkmcnt(2)
    v_mfma_f32_16x16x32_bf16 v[196:199], v[72:75], a[96:99], v[196:199]
    ds_read_b64_tr_b16 v[64:65], v28 offset:4096
    v_mul_f32 v20, v20, v160
    v_fma_f32 v21, v21, v9, v8
    v_mfma_f32_16x16x32_bf16 v[196:199], v[76:79], a[104:107], v[196:199]
    ds_read_b64_tr_b16 v[66:67], v28 offset:4608
    v_exp_f32 v20, v20
    v_mfma_f32_16x16x32_bf16 v[204:207], v[72:75], a[100:103], v[204:207]
    v_add_f32 v20, 1.0, v20
    v_mul_f32 v21, v21, v161
    v_mul_f32 v22, v162, v162
    v_mfma_f32_16x16x32_bf16 v[204:207], v[76:79], a[108:111], v[204:207]
    v_rcp_f32 v20, v20
    v_fma_f32 v22, v22, v9, v8
    s_waitcnt vmcnt(9)
    s_barrier
    ds_read_b128 v[112:115], v30 offset:0
    ds_read_b128 v[116:119], v31 offset:32768
    v_mfma_f32_16x16x32_bf16 v[212:215], v[72:75], a[224:227], v[212:215]
    ds_read_b64_tr_b16 v[68:69], v28 offset:8192
    v_exp_f32 v21, v21
    v_mfma_f32_16x16x32_bf16 v[212:215], v[76:79], a[232:235], v[212:215]
    ds_read_b64_tr_b16 v[70:71], v28 offset:8704
    v_mul_f32 v160, v160, v20
    v_add_f32 v21, 1.0, v21
    v_mfma_f32_16x16x32_bf16 v[220:223], v[72:75], a[228:231], v[220:223]
    v_mul_f32 v22, v22, v162
    v_mul_f32 v23, v163, v163
    v_add_f32 v32, v32, v160
    v_mfma_f32_16x16x32_bf16 v[220:223], v[76:79], a[236:239], v[220:223]
    v_rcp_f32 v21, v21
    v_fma_f32 v23, v23, v9, v8
    ds_read_b128 v[120:123], v30 offset:2048
    ds_read_b128 v[124:127], v31 offset:34816
    v_mfma_f32_16x16x32_bf16 v[220:223], v[80:83], a[244:247], v[220:223]
    ds_read_b64_tr_b16 v[72:73], v28 offset:12288
    v_exp_f32 v22, v22
    v_mfma_f32_16x16x32_bf16 v[220:223], v[84:87], a[252:255], v[220:223]
    ds_read_b64_tr_b16 v[74:75], v28 offset:12800
    v_fmac_f32 v40, v160, v160
    v_mul_f32 v161, v161, v21
    v_mfma_f32_16x16x32_bf16 v[212:215], v[80:83], a[240:243], v[212:215]
    v_add_f32 v22, 1.0, v22
    v_mul_f32 v23, v23, v163
    v_mul_f32 v20, v164, v164
    v_mfma_f32_16x16x32_bf16 v[212:215], v[84:87], a[248:251], v[212:215]
    v_add_f32 v33, v33, v161
    v_rcp_f32 v22, v22
    s_waitcnt lgkmcnt(6)
    v_mfma_f32_16x16x32_bf16 v[92:95], v[112:115], v[116:119], 0
    ds_read_b128 v[112:115], v30 offset:4096
    ds_read_b128 v[116:119], v31 offset:36864
    v_mfma_f32_16x16x32_bf16 v[204:207], v[80:83], a[116:119], v[204:207]
    ds_read_b64_tr_b16 v[76:77], v28 offset:16384
    v_exp_f32 v23, v23
    v_mfma_f32_16x16x32_bf16 v[204:207], v[84:87], a[124:127], v[204:207]
    ds_read_b64_tr_b16 v[78:79], v28 offset:16896
    v_fma_f32 v20, v20, v9, v8
    v_fmac_f32 v41, v161, v161
    v_mfma_f32_16x16x32_bf16 v[196:199], v[80:83], a[112:115], v[196:199]
    v_mul_f32 v162, v162, v22
    v_add_f32 v23, 1.0, v23
    v_mul_f32 v20, v20, v164
    v_mfma_f32_16x16x32_bf16 v[196:199], v[84:87], a[120:123], v[196:199]
    v_mul_f32 v21, v165, v165
    v_add_f32 v34, v34, v162
    s_waitcnt lgkmcnt(6)
    v_mfma_f32_16x16x32_bf16 v[92:95], v[120:123], v[124:127], v[92:95]
    ds_read_b128 v[120:123], v30 offset:6144
    ds_read_b128 v[124:127], v31 offset:38912
    s_waitcnt lgkmcnt(6)
    v_mfma_f32_16x16x32_bf16 v[224:227], v[88:91], a[0:3], 0
    ds_read_b64_tr_b16 v[80:81], v28 offset:20480
    v_rcp_f32 v23, v23
    v_mfma_f32_16x16x32_bf16 v[224:227], v[64:67], a[8:11], v[224:227]
    ds_read_b64_tr_b16 v[82:83], v28 offset:20992
    v_exp_f32 v20, v20
    v_mfma_f32_16x16x32_bf16 v[232:235], v[88:91], a[4:7], 0
    v_fma_f32 v21, v21, v9, v8
    v_fmac_f32 v42, v162, v162
    v_mul_f32 v163, v163, v23
    v_mfma_f32_16x16x32_bf16 v[232:235], v[64:67], a[12:15], v[232:235]
    v_add_f32 v20, 1.0, v20
    v_mul_f32 v21, v21, v165
    v_mul_f32 v22, v166, v166
    s_waitcnt lgkmcnt(6)
    v_mfma_f32_16x16x32_bf16 v[92:95], v[112:115], v[116:119], v[92:95]
    ds_read_b128 v[112:115], v30 offset:8192
    ds_read_b128 v[116:119], v31 offset:40960
    v_mfma_f32_16x16x32_bf16 v[240:243], v[88:91], a[128:131], 0
    ds_read_b64_tr_b16 v[84:85], v28 offset:24576
    v_add_f32 v35, v35, v163
    v_fma_f32 v22, v22, v9, v8
    v_mfma_f32_16x16x32_bf16 v[240:243], v[64:67], a[136:139], v[240:243]
    ds_read_b64_tr_b16 v[86:87], v28 offset:25088
    v_rcp_f32 v20, v20
    v_mfma_f32_16x16x32_bf16 v[248:251], v[88:91], a[132:135], 0
    v_exp_f32 v21, v21
    v_fmac_f32 v43, v163, v163
    v_mfma_f32_16x16x32_bf16 v[248:251], v[64:67], a[140:143], v[248:251]
    v_mul_f32 v164, v164, v20
    v_add_f32 v21, 1.0, v21
    v_mul_f32 v22, v22, v166
    s_waitcnt lgkmcnt(6)
    v_mfma_f32_16x16x32_bf16 v[92:95], v[120:123], v[124:127], v[92:95]
    ds_read_b128 v[120:123], v30 offset:10240
    ds_read_b128 v[124:127], v31 offset:43008
    v_mfma_f32_16x16x32_bf16 v[248:251], v[68:71], a[148:151], v[248:251]
    ds_read_b64_tr_b16 v[88:89], v28 offset:28672
    v_mul_f32 v23, v167, v167
    v_add_f32 v36, v36, v164
    v_mfma_f32_16x16x32_bf16 v[248:251], v[72:75], a[156:159], v[248:251]
    ds_read_b64_tr_b16 v[90:91], v28 offset:29184
    v_rcp_f32 v21, v21
    v_mfma_f32_16x16x32_bf16 v[240:243], v[68:71], a[144:147], v[240:243]
    v_exp_f32 v22, v22
    v_fma_f32 v23, v23, v9, v8
    v_mfma_f32_16x16x32_bf16 v[240:243], v[72:75], a[152:155], v[240:243]
    v_fmac_f32 v44, v164, v164
    v_mul_f32 v165, v165, v21
    v_add_f32 v22, 1.0, v22
    s_waitcnt lgkmcnt(6)
    v_mfma_f32_16x16x32_bf16 v[92:95], v[112:115], v[116:119], v[92:95]
    ds_read_b128 v[112:115], v30 offset:12288
    ds_read_b128 v[116:119], v31 offset:45056
    v_mfma_f32_16x16x32_bf16 v[232:235], v[68:71], a[20:23], v[232:235]
    ds_read_b64_tr_b16 v[64:65], v28 offset:32768
    v_mul_f32 v23, v23, v167
    v_add_f32 v37, v37, v165
    v_mfma_f32_16x16x32_bf16 v[232:235], v[72:75], a[28:31], v[232:235]
    ds_read_b64_tr_b16 v[66:67], v28 offset:33280
    v_rcp_f32 v22, v22
    v_mfma_f32_16x16x32_bf16 v[224:227], v[68:71], a[16:19], v[224:227]
    v_exp_f32 v23, v23
    v_fmac_f32 v45, v165, v165
    v_mfma_f32_16x16x32_bf16 v[224:227], v[72:75], a[24:27], v[224:227]
    v_mul_f32 v166, v166, v22
    v_add_f32 v23, 1.0, v23
    s_waitcnt lgkmcnt(6)
    v_mfma_f32_16x16x32_bf16 v[92:95], v[120:123], v[124:127], v[92:95]
    ds_read_b128 v[120:123], v30 offset:14336
    ds_read_b128 v[124:127], v31 offset:47104
    s_waitcnt lgkmcnt(6)
    v_mfma_f32_16x16x32_bf16 v[224:227], v[76:79], a[32:35], v[224:227]
    ds_read_b64_tr_b16 v[68:69], v28 offset:36864
    v_add_f32 v38, v38, v166
    v_fmac_f32 v46, v166, v166
    v_mfma_f32_16x16x32_bf16 v[224:227], v[80:83], a[40:43], v[224:227]
    ds_read_b64_tr_b16 v[70:71], v28 offset:37376
    v_rcp_f32 v23, v23
    v_mfma_f32_16x16x32_bf16 v[232:235], v[76:79], a[36:39], v[232:235]
    v_mul_f32 v167, v167, v23
    v_cvt_pk_bf16_f32 v160, v160, v161
    v_cvt_pk_bf16_f32 v161, v162, v163
    v_mfma_f32_16x16x32_bf16 v[232:235], v[80:83], a[44:47], v[232:235]
    v_add_f32 v39, v39, v167
    v_fmac_f32 v47, v167, v167
    v_cvt_pk_bf16_f32 v162, v164, v165
    s_waitcnt lgkmcnt(6)
    v_mfma_f32_16x16x32_bf16 v[92:95], v[112:115], v[116:119], v[92:95]
    ds_read_b128 v[112:115], v30 offset:16384
    ds_read_b128 v[116:119], v31 offset:49152
    v_mfma_f32_16x16x32_bf16 v[240:243], v[76:79], a[160:163], v[240:243]
    ds_read_b64_tr_b16 v[72:73], v28 offset:40960
    v_cvt_pk_bf16_f32 v163, v166, v167
    v_mul_f32 v20, v168, v168
    v_mfma_f32_16x16x32_bf16 v[240:243], v[80:83], a[168:171], v[240:243]
    ds_read_b64_tr_b16 v[74:75], v28 offset:41472
    buffer_store_dwordx4 v[160:163], v24, s[8:11], s56 offen offset:2048 sc1
    v_mfma_f32_16x16x32_bf16 v[248:251], v[76:79], a[164:167], v[248:251]
    v_fma_f32 v20, v20, v9, v8
    v_mul_f32 v21, v169, v169
    v_mul_f32 v22, v170, v170
    v_mfma_f32_16x16x32_bf16 v[248:251], v[80:83], a[172:175], v[248:251]
    v_mul_f32 v20, v20, v168
    v_fma_f32 v21, v21, v9, v8
    v_fma_f32 v22, v22, v9, v8
    s_waitcnt lgkmcnt(6)
    v_mfma_f32_16x16x32_bf16 v[92:95], v[120:123], v[124:127], v[92:95]
    ds_read_b128 v[120:123], v30 offset:18432
    ds_read_b128 v[124:127], v31 offset:51200
    v_mfma_f32_16x16x32_bf16 v[248:251], v[84:87], a[180:183], v[248:251]
    ds_read_b64_tr_b16 v[76:77], v28 offset:45056
    v_exp_f32 v20, v20
    v_mfma_f32_16x16x32_bf16 v[248:251], v[88:91], a[188:191], v[248:251]
    ds_read_b64_tr_b16 v[78:79], v28 offset:45568
    v_add_f32 v20, 1.0, v20
    v_mul_f32 v21, v21, v169
    v_mfma_f32_16x16x32_bf16 v[240:243], v[84:87], a[176:179], v[240:243]
    v_rcp_f32 v20, v20
    v_mul_f32 v22, v22, v170
    v_mfma_f32_16x16x32_bf16 v[240:243], v[88:91], a[184:187], v[240:243]
    v_exp_f32 v21, v21
    v_mul_f32 v168, v168, v20
    s_waitcnt lgkmcnt(6)
    v_mfma_f32_16x16x32_bf16 v[92:95], v[112:115], v[116:119], v[92:95]
    ds_read_b128 v[112:115], v30 offset:20480
    ds_read_b128 v[116:119], v31 offset:53248
    v_mfma_f32_16x16x32_bf16 v[232:235], v[84:87], a[52:55], v[232:235]
    ds_read_b64_tr_b16 v[80:81], v28 offset:49152
    v_add_f32 v21, 1.0, v21
    v_mul_f32 v23, v171, v171
    v_mfma_f32_16x16x32_bf16 v[232:235], v[88:91], a[60:63], v[232:235]
    ds_read_b64_tr_b16 v[82:83], v28 offset:49664
    v_add_f32 v32, v32, v168
    v_fma_f32 v23, v23, v9, v8
    v_mfma_f32_16x16x32_bf16 v[224:227], v[84:87], a[48:51], v[224:227]
    v_rcp_f32 v21, v21
    v_fmac_f32 v40, v168, v168
    v_mfma_f32_16x16x32_bf16 v[224:227], v[88:91], a[56:59], v[224:227]
    v_exp_f32 v22, v22
    s_waitcnt lgkmcnt(6)
    v_mfma_f32_16x16x32_bf16 v[92:95], v[120:123], v[124:127], v[92:95]
    ds_read_b128 v[120:123], v30 offset:22528
    ds_read_b128 v[124:127], v31 offset:55296
    s_waitcnt lgkmcnt(6)
    v_mfma_f32_16x16x32_bf16 v[224:227], v[64:67], a[64:67], v[224:227]
    ds_read_b64_tr_b16 v[84:85], v28 offset:53248
    v_mul_f32 v169, v169, v21
    v_add_f32 v22, 1.0, v22
    v_mfma_f32_16x16x32_bf16 v[224:227], v[68:71], a[72:75], v[224:227]
    ds_read_b64_tr_b16 v[86:87], v28 offset:53760
    v_mul_f32 v23, v23, v171
    v_mul_f32 v20, v172, v172
    v_mfma_f32_16x16x32_bf16 v[232:235], v[64:67], a[68:71], v[232:235]
    v_add_f32 v33, v33, v169
    v_rcp_f32 v22, v22
    v_mfma_f32_16x16x32_bf16 v[232:235], v[68:71], a[76:79], v[232:235]
    v_exp_f32 v23, v23
    v_fma_f32 v20, v20, v9, v8
    s_waitcnt lgkmcnt(6)
    v_mfma_f32_16x16x32_bf16 v[92:95], v[112:115], v[116:119], v[92:95]
    ds_read_b128 v[112:115], v30 offset:24576
    ds_read_b128 v[116:119], v31 offset:57344
    v_mfma_f32_16x16x32_bf16 v[240:243], v[64:67], a[192:195], v[240:243]
    ds_read_b64_tr_b16 v[88:89], v28 offset:57344
    v_fmac_f32 v41, v169, v169
    v_mul_f32 v170, v170, v22
    v_mfma_f32_16x16x32_bf16 v[240:243], v[68:71], a[200:203], v[240:243]
    ds_read_b64_tr_b16 v[90:91], v28 offset:57856
    v_add_f32 v23, 1.0, v23
    v_mul_f32 v20, v20, v172
    v_mfma_f32_16x16x32_bf16 v[248:251], v[64:67], a[196:199], v[248:251]
    v_mul_f32 v21, v173, v173
    v_add_f32 v34, v34, v170
    v_fmac_f32 v42, v170, v170
    v_mfma_f32_16x16x32_bf16 v[248:251], v[68:71], a[204:207], v[248:251]
    v_rcp_f32 v23, v23
    v_fma_f32 v21, v21, v9, v8
    s_waitcnt lgkmcnt(6)
    v_mfma_f32_16x16x32_bf16 v[92:95], v[120:123], v[124:127], v[92:95]
    ds_read_b128 v[120:123], v30 offset:26624
    ds_read_b128 v[124:127], v31 offset:59392
    v_mfma_f32_16x16x32_bf16 v[248:251], v[72:75], a[212:215], v[248:251]
    ds_read_b64_tr_b16 v[64:65], v28 offset:61440
    v_exp_f32 v20, v20
    v_mfma_f32_16x16x32_bf16 v[248:251], v[76:79], a[220:223], v[248:251]
    ds_read_b64_tr_b16 v[66:67], v28 offset:61952
    v_mul_f32 v171, v171, v23
    v_add_f32 v20, 1.0, v20
    v_mfma_f32_16x16x32_bf16 v[240:243], v[72:75], a[208:211], v[240:243]
    v_mul_f32 v21, v21, v173
    v_mul_f32 v22, v174, v174
    v_add_f32 v35, v35, v171
    v_mfma_f32_16x16x32_bf16 v[240:243], v[76:79], a[216:219], v[240:243]
    v_rcp_f32 v20, v20
    v_fma_f32 v22, v22, v9, v8
    s_waitcnt lgkmcnt(6)
    v_mfma_f32_16x16x32_bf16 v[92:95], v[112:115], v[116:119], v[92:95]
    ds_read_b128 v[112:115], v30 offset:28672
    ds_read_b128 v[116:119], v31 offset:61440
    v_mfma_f32_16x16x32_bf16 v[232:235], v[72:75], a[84:87], v[232:235]
    ds_read_b64_tr_b16 v[68:69], v28 offset:8
    v_exp_f32 v21, v21
    v_mfma_f32_16x16x32_bf16 v[232:235], v[76:79], a[92:95], v[232:235]
    ds_read_b64_tr_b16 v[70:71], v28 offset:520
    v_fmac_f32 v43, v171, v171
    v_mul_f32 v172, v172, v20
    v_mfma_f32_16x16x32_bf16 v[224:227], v[72:75], a[80:83], v[224:227]
    v_add_f32 v21, 1.0, v21
    v_mul_f32 v22, v22, v174
    v_mul_f32 v23, v175, v175
    v_mfma_f32_16x16x32_bf16 v[224:227], v[76:79], a[88:91], v[224:227]
    v_add_f32 v36, v36, v172
    v_fma_f32 v23, v23, v9, v8
    s_waitcnt lgkmcnt(6)
    v_mfma_f32_16x16x32_bf16 v[92:95], v[120:123], v[124:127], v[92:95]
    ds_read_b128 v[120:123], v30 offset:30720
    ds_read_b128 v[124:127], v31 offset:63488
    s_waitcnt lgkmcnt(6)
    v_mfma_f32_16x16x32_bf16 v[224:227], v[80:83], a[96:99], v[224:227]
    ds_read_b64_tr_b16 v[72:73], v28 offset:4104
    v_rcp_f32 v21, v21
    v_mfma_f32_16x16x32_bf16 v[224:227], v[84:87], a[104:107], v[224:227]
    ds_read_b64_tr_b16 v[74:75], v28 offset:4616
    v_exp_f32 v22, v22
    v_mfma_f32_16x16x32_bf16 v[232:235], v[80:83], a[100:103], v[232:235]
    v_fmac_f32 v44, v172, v172
    v_mul_f32 v173, v173, v21
    v_add_f32 v22, 1.0, v22
    v_mfma_f32_16x16x32_bf16 v[232:235], v[84:87], a[108:111], v[232:235]
    v_mul_f32 v23, v23, v175
    v_add_f32 v37, v37, v173
    v_fmac_f32 v45, v173, v173
    s_waitcnt lgkmcnt(6)
    v_mfma_f32_16x16x32_bf16 v[92:95], v[112:115], v[116:119], v[92:95]
    v_mfma_f32_16x16x32_bf16 v[240:243], v[80:83], a[224:227], v[240:243]
    ds_read_b64_tr_b16 v[76:77], v28 offset:8200
    v_rcp_f32 v22, v22
    v_mfma_f32_16x16x32_bf16 v[240:243], v[84:87], a[232:235], v[240:243]
    ds_read_b64_tr_b16 v[78:79], v28 offset:8712
    v_exp_f32 v23, v23
    v_mfma_f32_16x16x32_bf16 v[248:251], v[80:83], a[228:231], v[248:251]
    v_mul_f32 v174, v174, v22
    v_add_f32 v23, 1.0, v23
    v_cvt_pk_bf16_f32 v168, v168, v169
    v_mfma_f32_16x16x32_bf16 v[248:251], v[84:87], a[236:239], v[248:251]
    v_add_f32 v38, v38, v174
    v_rcp_f32 v23, v23
    s_waitcnt lgkmcnt(4)
    v_mfma_f32_16x16x32_bf16 v[92:95], v[120:123], v[124:127], v[92:95]
    v_mfma_f32_16x16x32_bf16 v[248:251], v[88:91], a[244:247], v[248:251]
    ds_read_b64_tr_b16 v[80:81], v28 offset:12296
    v_fmac_f32 v46, v174, v174
    v_mul_f32 v175, v175, v23
    v_mfma_f32_16x16x32_bf16 v[248:251], v[64:67], a[252:255], v[248:251]
    ds_read_b64_tr_b16 v[82:83], v28 offset:12808
    v_add_f32 v39, v39, v175
    v_fmac_f32 v47, v175, v175
    v_mfma_f32_16x16x32_bf16 v[240:243], v[88:91], a[240:243], v[240:243]
    v_cvt_pk_bf16_f32 v169, v170, v171
    v_cvt_pk_bf16_f32 v170, v172, v173
    v_cvt_pk_bf16_f32 v171, v174, v175
    v_mfma_f32_16x16x32_bf16 v[240:243], v[64:67], a[248:251], v[240:243]
    buffer_store_dwordx4 v[168:171], v24, s[8:11], s56 offen offset:3072 sc1
    v_add_f32_dpp v32, v32, v32 row_ror:8 row_mask:0xf bank_mask:0x3
    s_lshl_b32 s69, s71, 11
    s_lshl_b32 s35, s26, 9
    s_add_u32 s69, s69, s35
    s_add_u32 s69, s69, 43515904
    v_lshlrev_b32 v30, 3, v0
    v_add_u32 v5, 65536, v30
    s_nop 1
    v_cvt_pk_bf16_f32 v92, v92, v93
    v_cvt_pk_bf16_f32 v93, v94, v95
    buffer_store_dwordx2 v[92:93], v30, s[8:11], s69 offen sc1
    v_mfma_f32_16x16x32_bf16 v[232:235], v[88:91], a[116:119], v[232:235]
    ds_read_b64_tr_b16 v[84:85], v28 offset:16392
    v_add_f32_dpp v33, v33, v33 row_ror:8 row_mask:0xf bank_mask:0x3
    v_add_f32_dpp v34, v34, v34 row_ror:8 row_mask:0xf bank_mask:0x3
    v_mfma_f32_16x16x32_bf16 v[232:235], v[64:67], a[124:127], v[232:235]
    ds_read_b64_tr_b16 v[86:87], v28 offset:16904
    v_add_f32_dpp v35, v35, v35 row_ror:8 row_mask:0xf bank_mask:0x3
    v_add_f32_dpp v36, v36, v36 row_ror:8 row_mask:0xf bank_mask:0x3
    v_mfma_f32_16x16x32_bf16 v[224:227], v[88:91], a[112:115], v[224:227]
    v_add_f32_dpp v37, v37, v37 row_ror:8 row_mask:0xf bank_mask:0x3
    v_add_f32_dpp v38, v38, v38 row_ror:8 row_mask:0xf bank_mask:0x3
    v_add_f32_dpp v39, v39, v39 row_ror:8 row_mask:0xf bank_mask:0x3
    v_mfma_f32_16x16x32_bf16 v[224:227], v[64:67], a[120:123], v[224:227]
    v_add_f32_dpp v32, v40, v40 row_ror:8 row_mask:0xf bank_mask:0xc
    v_add_f32_dpp v33, v41, v41 row_ror:8 row_mask:0xf bank_mask:0xc
    s_waitcnt lgkmcnt(2)
    v_mfma_f32_16x16x32_bf16 v[228:231], v[68:71], a[0:3], 0
    ds_read_b64_tr_b16 v[88:89], v28 offset:20488
    v_add_f32_dpp v34, v42, v42 row_ror:8 row_mask:0xf bank_mask:0xc
    v_add_f32_dpp v35, v43, v43 row_ror:8 row_mask:0xf bank_mask:0xc
    v_mfma_f32_16x16x32_bf16 v[228:231], v[72:75], a[8:11], v[228:231]
    ds_read_b64_tr_b16 v[90:91], v28 offset:21000
    v_add_f32_dpp v36, v44, v44 row_ror:8 row_mask:0xf bank_mask:0xc
    v_add_f32_dpp v37, v45, v45 row_ror:8 row_mask:0xf bank_mask:0xc
    v_mfma_f32_16x16x32_bf16 v[236:239], v[68:71], a[4:7], 0
    v_add_f32_dpp v38, v46, v46 row_ror:8 row_mask:0xf bank_mask:0xc
    v_add_f32_dpp v39, v47, v47 row_ror:8 row_mask:0xf bank_mask:0xc
    v_add_f32_dpp v32, v32, v32 row_half_mirror row_mask:0xf bank_mask:0x5
    v_mfma_f32_16x16x32_bf16 v[236:239], v[72:75], a[12:15], v[236:239]
    v_add_f32_dpp v33, v33, v33 row_half_mirror row_mask:0xf bank_mask:0x5
    v_add_f32_dpp v34, v34, v34 row_half_mirror row_mask:0xf bank_mask:0x5
    v_add_f32_dpp v35, v35, v35 row_half_mirror row_mask:0xf bank_mask:0x5
    v_mfma_f32_16x16x32_bf16 v[244:247], v[68:71], a[128:131], 0
    ds_read_b64_tr_b16 v[64:65], v28 offset:24584
    v_add_f32_dpp v32, v36, v36 row_half_mirror row_mask:0xf bank_mask:0xa
    v_mul_f32 v20, v176, v176
    v_mfma_f32_16x16x32_bf16 v[244:247], v[72:75], a[136:139], v[244:247]
    ds_read_b64_tr_b16 v[66:67], v28 offset:25096
    v_add_f32_dpp v33, v37, v37 row_half_mirror row_mask:0xf bank_mask:0xa
    v_add_f32_dpp v34, v38, v38 row_half_mirror row_mask:0xf bank_mask:0xa
    v_mfma_f32_16x16x32_bf16 v[252:255], v[68:71], a[132:135], 0
    v_add_f32_dpp v35, v39, v39 row_half_mirror row_mask:0xf bank_mask:0xa
    v_add_f32_dpp v32, v32, v32 quad_perm:[2,3,0,1] row_mask:0xf bank_mask:0xf
    v_fma_f32 v20, v20, v9, v8
    v_mfma_f32_16x16x32_bf16 v[252:255], v[72:75], a[140:143], v[252:255]
    v_add_f32_dpp v33, v33, v33 quad_perm:[2,3,0,1] row_mask:0xf bank_mask:0xf
    v_add_f32_dpp v34, v34, v34 quad_perm:[2,3,0,1] row_mask:0xf bank_mask:0xf
    v_mul_f32 v20, v20, v176
    v_mfma_f32_16x16x32_bf16 v[252:255], v[76:79], a[148:151], v[252:255]
    ds_read_b64_tr_b16 v[68:69], v28 offset:28680
    v_add_f32_dpp v35, v35, v35 quad_perm:[2,3,0,1] row_mask:0xf bank_mask:0xf
    v_add_f32_dpp v32, v32, v32 quad_perm:[1,0,3,2] row_mask:0xf bank_mask:0xf
    v_mfma_f32_16x16x32_bf16 v[252:255], v[80:83], a[156:159], v[252:255]
    ds_read_b64_tr_b16 v[70:71], v28 offset:29192
    v_add_f32_dpp v33, v33, v33 quad_perm:[1,0,3,2] row_mask:0xf bank_mask:0xf
    v_add_f32_dpp v34, v34, v34 quad_perm:[1,0,3,2] row_mask:0xf bank_mask:0xf
    v_mfma_f32_16x16x32_bf16 v[244:247], v[76:79], a[144:147], v[244:247]
    v_add_f32_dpp v35, v35, v35 quad_perm:[1,0,3,2] row_mask:0xf bank_mask:0xf
    v_mul_f32 v21, v177, v177
    v_mul_f32 v22, v178, v178
    v_mfma_f32_16x16x32_bf16 v[244:247], v[80:83], a[152:155], v[244:247]
    buffer_store_dwordx4 v[32:35], v12, s[8:11], s73 offen sc1
    v_fma_f32 v21, v21, v9, v8
    v_mfma_f32_16x16x32_bf16 v[236:239], v[76:79], a[20:23], v[236:239]
    ds_read_b64_tr_b16 v[72:73], v28 offset:32776
    v_exp_f32 v20, v20
    v_mfma_f32_16x16x32_bf16 v[236:239], v[80:83], a[28:31], v[236:239]
    ds_read_b64_tr_b16 v[74:75], v28 offset:33288
    v_add_f32 v20, 1.0, v20
    v_mul_f32 v21, v21, v177
    v_mfma_f32_16x16x32_bf16 v[228:231], v[76:79], a[16:19], v[228:231]
    v_rcp_f32 v20, v20
    v_fma_f32 v22, v22, v9, v8
    v_mfma_f32_16x16x32_bf16 v[228:231], v[80:83], a[24:27], v[228:231]
    v_exp_f32 v21, v21
    s_waitcnt lgkmcnt(2)
    v_mfma_f32_16x16x32_bf16 v[228:231], v[84:87], a[32:35], v[228:231]
    ds_read_b64_tr_b16 v[76:77], v28 offset:36872
    v_mul_f32 v176, v176, v20
    v_add_f32 v21, 1.0, v21
    v_mfma_f32_16x16x32_bf16 v[228:231], v[88:91], a[40:43], v[228:231]
    ds_read_b64_tr_b16 v[78:79], v28 offset:37384
    v_mul_f32 v22, v22, v178
    v_mul_f32 v23, v179, v179
    v_mfma_f32_16x16x32_bf16 v[236:239], v[84:87], a[36:39], v[236:239]
    v_add_f32 v48, v48, v176
    v_rcp_f32 v21, v21
    v_mfma_f32_16x16x32_bf16 v[236:239], v[88:91], a[44:47], v[236:239]
    v_exp_f32 v22, v22
    v_fma_f32 v23, v23, v9, v8
    v_mfma_f32_16x16x32_bf16 v[244:247], v[84:87], a[160:163], v[244:247]
    ds_read_b64_tr_b16 v[80:81], v28 offset:40968
    v_fmac_f32 v56, v176, v176
    v_mul_f32 v177, v177, v21
    v_mfma_f32_16x16x32_bf16 v[244:247], v[88:91], a[168:171], v[244:247]
    ds_read_b64_tr_b16 v[82:83], v28 offset:41480
    v_add_f32 v22, 1.0, v22
    v_mul_f32 v23, v23, v179
    v_mfma_f32_16x16x32_bf16 v[252:255], v[84:87], a[164:167], v[252:255]
    v_mul_f32 v20, v180, v180
    v_add_f32 v49, v49, v177
    v_fmac_f32 v57, v177, v177
    v_mfma_f32_16x16x32_bf16 v[252:255], v[88:91], a[172:175], v[252:255]
    v_rcp_f32 v22, v22
    v_fma_f32 v20, v20, v9, v8
    v_mfma_f32_16x16x32_bf16 v[252:255], v[64:67], a[180:183], v[252:255]
    ds_read_b64_tr_b16 v[84:85], v28 offset:45064
    v_exp_f32 v23, v23
    v_mfma_f32_16x16x32_bf16 v[252:255], v[68:71], a[188:191], v[252:255]
    ds_read_b64_tr_b16 v[86:87], v28 offset:45576
    v_mul_f32 v178, v178, v22
    v_add_f32 v23, 1.0, v23
    v_mfma_f32_16x16x32_bf16 v[244:247], v[64:67], a[176:179], v[244:247]
    v_mul_f32 v20, v20, v180
    v_mul_f32 v21, v181, v181
    v_add_f32 v50, v50, v178
    v_mfma_f32_16x16x32_bf16 v[244:247], v[68:71], a[184:187], v[244:247]
    v_rcp_f32 v23, v23
    v_fma_f32 v21, v21, v9, v8
    v_mfma_f32_16x16x32_bf16 v[236:239], v[64:67], a[52:55], v[236:239]
    ds_read_b64_tr_b16 v[88:89], v28 offset:49160
    v_exp_f32 v20, v20
    v_mfma_f32_16x16x32_bf16 v[236:239], v[68:71], a[60:63], v[236:239]
    ds_read_b64_tr_b16 v[90:91], v28 offset:49672
    v_fmac_f32 v58, v178, v178
    v_mul_f32 v179, v179, v23
    v_mfma_f32_16x16x32_bf16 v[228:231], v[64:67], a[48:51], v[228:231]
    v_add_f32 v20, 1.0, v20
    v_mul_f32 v21, v21, v181
    v_mul_f32 v22, v182, v182
    v_mfma_f32_16x16x32_bf16 v[228:231], v[68:71], a[56:59], v[228:231]
    v_add_f32 v51, v51, v179
    v_fma_f32 v22, v22, v9, v8
    s_waitcnt lgkmcnt(2)
    v_mfma_f32_16x16x32_bf16 v[228:231], v[72:75], a[64:67], v[228:231]
    ds_read_b64_tr_b16 v[64:65], v28 offset:53256
    v_rcp_f32 v20, v20
    v_mfma_f32_16x16x32_bf16 v[228:231], v[76:79], a[72:75], v[228:231]
    ds_read_b64_tr_b16 v[66:67], v28 offset:53768
    v_exp_f32 v21, v21
    v_mfma_f32_16x16x32_bf16 v[236:239], v[72:75], a[68:71], v[236:239]
    v_fmac_f32 v59, v179, v179
    v_mul_f32 v180, v180, v20
    v_add_f32 v21, 1.0, v21
    v_mfma_f32_16x16x32_bf16 v[236:239], v[76:79], a[76:79], v[236:239]
    v_mul_f32 v22, v22, v182
    v_mul_f32 v23, v183, v183
    v_add_f32 v52, v52, v180
    s_waitcnt vmcnt(5)
    s_barrier
    v_mfma_f32_16x16x32_bf16 v[244:247], v[72:75], a[192:195], v[244:247]
    ds_read_b64_tr_b16 v[68:69], v28 offset:57352
    v_rcp_f32 v21, v21
    v_mfma_f32_16x16x32_bf16 v[244:247], v[76:79], a[200:203], v[244:247]
    ds_read_b64_tr_b16 v[70:71], v28 offset:57864
    v_exp_f32 v22, v22
    v_mfma_f32_16x16x32_bf16 v[252:255], v[72:75], a[196:199], v[252:255]
    s_add_u32 s30, s65, 32768
    s_add_u32 m0, s33, 32768
    s_nop 0
    buffer_load_dwordx4 v1, s[8:11], s30 offen offset:0 sc1 lds
    v_mfma_f32_16x16x32_bf16 v[252:255], v[76:79], a[204:207], v[252:255]
    v_fma_f32 v23, v23, v9, v8
    v_fmac_f32 v60, v180, v180
    v_mul_f32 v181, v181, v21
    v_mfma_f32_16x16x32_bf16 v[252:255], v[80:83], a[212:215], v[252:255]
    ds_read_b64_tr_b16 v[72:73], v28 offset:61448
    v_add_f32 v22, 1.0, v22
    v_mul_f32 v23, v23, v183
    v_mfma_f32_16x16x32_bf16 v[252:255], v[84:87], a[220:223], v[252:255]
    ds_read_b64_tr_b16 v[74:75], v28 offset:61960
    v_add_f32 v53, v53, v181
    v_fmac_f32 v61, v181, v181
    v_mfma_f32_16x16x32_bf16 v[244:247], v[80:83], a[208:211], v[244:247]
    buffer_load_dwordx4 v1, s[8:11], s30 offen offset:1024 sc1 lds
    v_mfma_f32_16x16x32_bf16 v[244:247], v[84:87], a[216:219], v[244:247]
    v_rcp_f32 v22, v22
    v_cvt_pk_bf16_f32 v176, v176, v177
    v_mfma_f32_16x16x32_bf16 v[236:239], v[80:83], a[84:87], v[236:239]
    ds_read_b128 v[76:79], v29 offset:0
    v_exp_f32 v23, v23
    v_mfma_f32_16x16x32_bf16 v[236:239], v[84:87], a[92:95], v[236:239]
    v_mul_f32 v182, v182, v22
    v_add_f32 v23, 1.0, v23
    v_cvt_pk_bf16_f32 v177, v178, v179
    v_mfma_f32_16x16x32_bf16 v[228:231], v[80:83], a[80:83], v[228:231]
    buffer_load_dwordx4 v1, s[8:11], s30 offen offset:2048 sc1 lds
    v_mfma_f32_16x16x32_bf16 v[228:231], v[84:87], a[88:91], v[228:231]
    v_add_f32 v54, v54, v182
    v_fmac_f32 v62, v182, v182
    s_waitcnt lgkmcnt(1)
    v_mfma_f32_16x16x32_bf16 v[228:231], v[88:91], a[96:99], v[228:231]
    ds_read_b128 v[80:83], v29 offset:2048
    v_rcp_f32 v23, v23
    v_mfma_f32_16x16x32_bf16 v[228:231], v[64:67], a[104:107], v[228:231]
    v_mul_f32 v183, v183, v23
    v_cvt_pk_bf16_f32 v178, v180, v181
    v_mul_f32 v20, v184, v184
    v_mfma_f32_16x16x32_bf16 v[236:239], v[88:91], a[100:103], v[236:239]
    buffer_load_dwordx4 v1, s[8:11], s30 offen offset:3072 sc1 lds
    v_mfma_f32_16x16x32_bf16 v[236:239], v[64:67], a[108:111], v[236:239]
    v_add_f32 v55, v55, v183
    v_fmac_f32 v63, v183, v183
    v_cvt_pk_bf16_f32 v179, v182, v183
    s_waitcnt vmcnt(5)
    s_barrier
    s_lshl_b32 s35, s71, 7
    s_add_u32 s35, s35, 80740352
    v_mov_b32 v14, s75
    buffer_store_dword v14, v10, s[8:11], s35 offen sc1
    v_mfma_f32_16x16x32_bf16 v[244:247], v[88:91], a[224:227], v[244:247]
    ds_read_b128 v[84:87], v29 offset:4096
    buffer_store_dwordx4 v[176:179], v25, s[8:11], s57 offen offset:2048 sc1
    v_mfma_f32_16x16x32_bf16 v[244:247], v[64:67], a[232:235], v[244:247]
    v_fma_f32 v20, v20, v9, v8
    v_mul_f32 v21, v185, v185
    v_mul_f32 v22, v186, v186
    v_mfma_f32_16x16x32_bf16 v[252:255], v[88:91], a[228:231], v[252:255]
    s_add_u32 m0, s33, 36864
    s_nop 0
    buffer_load_dwordx4 v2, s[8:11], s30 offen offset:0 sc1 lds
    v_mfma_f32_16x16x32_bf16 v[252:255], v[64:67], a[236:239], v[252:255]
    v_mul_f32 v20, v20, v184
    v_fma_f32 v21, v21, v9, v8
    v_fma_f32 v22, v22, v9, v8
    v_mfma_f32_16x16x32_bf16 v[252:255], v[68:71], a[244:247], v[252:255]
    ds_read_b128 v[88:91], v29 offset:6144
    v_exp_f32 v20, v20
    v_mfma_f32_16x16x32_bf16 v[252:255], v[72:75], a[252:255], v[252:255]
    v_add_f32 v20, 1.0, v20
    v_mul_f32 v21, v21, v185
    v_mul_f32 v22, v22, v186
    v_mfma_f32_16x16x32_bf16 v[244:247], v[68:71], a[240:243], v[244:247]
    buffer_load_dwordx4 v2, s[8:11], s30 offen offset:1024 sc1 lds
    v_mfma_f32_16x16x32_bf16 v[244:247], v[72:75], a[248:251], v[244:247]
    v_rcp_f32 v20, v20
    v_mul_f32 v23, v187, v187
    v_mfma_f32_16x16x32_bf16 v[236:239], v[68:71], a[116:119], v[236:239]
    ds_read_b128 v[64:67], v29 offset:8192
    v_exp_f32 v21, v21
    v_mfma_f32_16x16x32_bf16 v[236:239], v[72:75], a[124:127], v[236:239]
    v_mul_f32 v184, v184, v20
    v_add_f32 v21, 1.0, v21
    v_fma_f32 v23, v23, v9, v8
    v_mfma_f32_16x16x32_bf16 v[228:231], v[68:71], a[112:115], v[228:231]
    buffer_load_dwordx4 v2, s[8:11], s30 offen offset:2048 sc1 lds
    v_mfma_f32_16x16x32_bf16 v[228:231], v[72:75], a[120:123], v[228:231]
    v_add_f32 v48, v48, v184
    v_fmac_f32 v56, v184, v184
    s_waitcnt lgkmcnt(1)
    v_mfma_f32_16x16x32_bf16 v[128:131], v[76:79], a[0:3], 0
    ds_read_b128 v[68:71], v29 offset:10240
    v_rcp_f32 v21, v21
    v_mfma_f32_16x16x32_bf16 v[128:131], v[80:83], a[8:11], v[128:131]
    v_exp_f32 v22, v22
    v_mul_f32 v185, v185, v21
    v_mfma_f32_16x16x32_bf16 v[136:139], v[76:79], a[4:7], 0
    buffer_load_dwordx4 v2, s[8:11], s30 offen offset:3072 sc1 lds
    v_mfma_f32_16x16x32_bf16 v[136:139], v[80:83], a[12:15], v[136:139]
    v_add_f32 v22, 1.0, v22
    v_mul_f32 v23, v23, v187
    v_mul_f32 v20, v188, v188
    v_mfma_f32_16x16x32_bf16 v[144:147], v[76:79], a[128:131], 0
    ds_read_b128 v[72:75], v29 offset:12288
    v_add_f32 v49, v49, v185
    v_fma_f32 v20, v20, v9, v8
    v_mfma_f32_16x16x32_bf16 v[144:147], v[80:83], a[136:139], v[144:147]
    v_rcp_f32 v22, v22
    v_fmac_f32 v57, v185, v185
    v_mfma_f32_16x16x32_bf16 v[152:155], v[76:79], a[132:135], 0
    v_exp_f32 v23, v23
    v_mul_f32 v186, v186, v22
    v_mfma_f32_16x16x32_bf16 v[152:155], v[80:83], a[140:143], v[152:155]
    v_add_f32 v23, 1.0, v23
    v_mul_f32 v20, v20, v188
    v_mul_f32 v21, v189, v189
    v_mfma_f32_16x16x32_bf16 v[152:155], v[84:87], a[148:151], v[152:155]
    ds_read_b128 v[76:79], v29 offset:14336
    v_add_f32 v50, v50, v186
    v_fma_f32 v21, v21, v9, v8
    v_mfma_f32_16x16x32_bf16 v[152:155], v[88:91], a[156:159], v[152:155]
    v_rcp_f32 v23, v23
    v_fmac_f32 v58, v186, v186
    v_mfma_f32_16x16x32_bf16 v[144:147], v[84:87], a[144:147], v[144:147]
    v_exp_f32 v20, v20
    v_mul_f32 v187, v187, v23
    v_mfma_f32_16x16x32_bf16 v[144:147], v[88:91], a[152:155], v[144:147]
    v_add_f32 v20, 1.0, v20
    v_mul_f32 v21, v21, v189
    v_mul_f32 v22, v190, v190
    v_mfma_f32_16x16x32_bf16 v[136:139], v[84:87], a[20:23], v[136:139]
    ds_read_b128 v[80:83], v29 offset:16384
    v_add_f32 v51, v51, v187
    v_fma_f32 v22, v22, v9, v8
    v_mfma_f32_16x16x32_bf16 v[136:139], v[88:91], a[28:31], v[136:139]
    v_rcp_f32 v20, v20
    v_fmac_f32 v59, v187, v187
    v_mfma_f32_16x16x32_bf16 v[128:131], v[84:87], a[16:19], v[128:131]
    v_exp_f32 v21, v21
    v_mul_f32 v188, v188, v20
    v_mfma_f32_16x16x32_bf16 v[128:131], v[88:91], a[24:27], v[128:131]
    v_add_f32 v21, 1.0, v21
    v_mul_f32 v22, v22, v190
    s_waitcnt lgkmcnt(1)
    v_mfma_f32_16x16x32_bf16 v[128:131], v[64:67], a[32:35], v[128:131]
    ds_read_b128 v[84:87], v29 offset:18432
    v_mul_f32 v23, v191, v191
    v_add_f32 v52, v52, v188
    v_mfma_f32_16x16x32_bf16 v[128:131], v[68:71], a[40:43], v[128:131]
    v_rcp_f32 v21, v21
    v_fma_f32 v23, v23, v9, v8
    v_mfma_f32_16x16x32_bf16 v[136:139], v[64:67], a[36:39], v[136:139]
    v_exp_f32 v22, v22
    v_fmac_f32 v60, v188, v188
    v_mfma_f32_16x16x32_bf16 v[136:139], v[68:71], a[44:47], v[136:139]
    v_mul_f32 v189, v189, v21
    v_add_f32 v22, 1.0, v22
    v_mul_f32 v23, v23, v191
    v_mfma_f32_16x16x32_bf16 v[144:147], v[64:67], a[160:163], v[144:147]
    ds_read_b128 v[88:91], v29 offset:20480
    v_add_f32 v53, v53, v189
    v_fmac_f32 v61, v189, v189
    v_mfma_f32_16x16x32_bf16 v[144:147], v[68:71], a[168:171], v[144:147]
    v_rcp_f32 v22, v22
    v_cvt_pk_bf16_f32 v184, v184, v185
    v_mfma_f32_16x16x32_bf16 v[152:155], v[64:67], a[164:167], v[152:155]
    v_exp_f32 v23, v23
    v_mul_f32 v190, v190, v22
    v_mfma_f32_16x16x32_bf16 v[152:155], v[68:71], a[172:175], v[152:155]
    v_add_f32 v23, 1.0, v23
    v_add_f32 v54, v54, v190
    v_fmac_f32 v62, v190, v190
    v_mfma_f32_16x16x32_bf16 v[152:155], v[72:75], a[180:183], v[152:155]
    ds_read_b128 v[64:67], v29 offset:22528
    v_rcp_f32 v23, v23
    v_mfma_f32_16x16x32_bf16 v[152:155], v[76:79], a[188:191], v[152:155]
    v_mul_f32 v191, v191, v23
    v_cvt_pk_bf16_f32 v185, v186, v187
    v_cvt_pk_bf16_f32 v186, v188, v189
    v_mfma_f32_16x16x32_bf16 v[144:147], v[72:75], a[176:179], v[144:147]
    v_add_f32 v55, v55, v191
    v_fmac_f32 v63, v191, v191
    v_cvt_pk_bf16_f32 v187, v190, v191
    v_mfma_f32_16x16x32_bf16 v[144:147], v[76:79], a[184:187], v[144:147]
    buffer_store_dwordx4 v[184:187], v25, s[8:11], s57 offen offset:3072 sc1
    v_add_f32_dpp v48, v48, v48 row_ror:8 row_mask:0xf bank_mask:0x3
    v_mfma_f32_16x16x32_bf16 v[136:139], v[72:75], a[52:55], v[136:139]
    ds_read_b128 v[68:71], v29 offset:24576
    v_add_f32_dpp v49, v49, v49 row_ror:8 row_mask:0xf bank_mask:0x3
    v_add_f32_dpp v50, v50, v50 row_ror:8 row_mask:0xf bank_mask:0x3
    v_mfma_f32_16x16x32_bf16 v[136:139], v[76:79], a[60:63], v[136:139]
    v_add_f32_dpp v51, v51, v51 row_ror:8 row_mask:0xf bank_mask:0x3
    v_add_f32_dpp v52, v52, v52 row_ror:8 row_mask:0xf bank_mask:0x3
    v_add_f32_dpp v53, v53, v53 row_ror:8 row_mask:0xf bank_mask:0x3
    v_mfma_f32_16x16x32_bf16 v[128:131], v[72:75], a[48:51], v[128:131]
    v_add_f32_dpp v54, v54, v54 row_ror:8 row_mask:0xf bank_mask:0x3
    v_add_f32_dpp v55, v55, v55 row_ror:8 row_mask:0xf bank_mask:0x3
    v_add_f32_dpp v48, v56, v56 row_ror:8 row_mask:0xf bank_mask:0xc
    v_mfma_f32_16x16x32_bf16 v[128:131], v[76:79], a[56:59], v[128:131]
    v_add_f32_dpp v49, v57, v57 row_ror:8 row_mask:0xf bank_mask:0xc
    v_add_f32_dpp v50, v58, v58 row_ror:8 row_mask:0xf bank_mask:0xc
    s_waitcnt lgkmcnt(1)
    v_mfma_f32_16x16x32_bf16 v[128:131], v[80:83], a[64:67], v[128:131]
    ds_read_b128 v[72:75], v29 offset:26624
    v_add_f32_dpp v51, v59, v59 row_ror:8 row_mask:0xf bank_mask:0xc
    v_add_f32_dpp v52, v60, v60 row_ror:8 row_mask:0xf bank_mask:0xc
    v_mfma_f32_16x16x32_bf16 v[128:131], v[84:87], a[72:75], v[128:131]
    v_add_f32_dpp v53, v61, v61 row_ror:8 row_mask:0xf bank_mask:0xc
    v_add_f32_dpp v54, v62, v62 row_ror:8 row_mask:0xf bank_mask:0xc
    v_add_f32_dpp v55, v63, v63 row_ror:8 row_mask:0xf bank_mask:0xc
    v_mfma_f32_16x16x32_bf16 v[136:139], v[80:83], a[68:71], v[136:139]
    v_add_f32_dpp v48, v48, v48 row_half_mirror row_mask:0xf bank_mask:0x5
    v_add_f32_dpp v49, v49, v49 row_half_mirror row_mask:0xf bank_mask:0x5
    v_add_f32_dpp v50, v50, v50 row_half_mirror row_mask:0xf bank_mask:0x5
    v_mfma_f32_16x16x32_bf16 v[136:139], v[84:87], a[76:79], v[136:139]
    v_add_f32_dpp v51, v51, v51 row_half_mirror row_mask:0xf bank_mask:0x5
    v_mul_f32 v16, v192, v192
    v_mul_f32 v17, v193, v193
    v_mfma_f32_16x16x32_bf16 v[144:147], v[80:83], a[192:195], v[144:147]
    ds_read_b128 v[76:79], v29 offset:28672
    v_add_f32_dpp v48, v52, v52 row_half_mirror row_mask:0xf bank_mask:0xa
    v_add_f32_dpp v49, v53, v53 row_half_mirror row_mask:0xf bank_mask:0xa
    v_mfma_f32_16x16x32_bf16 v[144:147], v[84:87], a[200:203], v[144:147]
    v_add_f32_dpp v50, v54, v54 row_half_mirror row_mask:0xf bank_mask:0xa
    v_add_f32_dpp v51, v55, v55 row_half_mirror row_mask:0xf bank_mask:0xa
    v_fma_f32 v16, v16, v9, v8
    v_mfma_f32_16x16x32_bf16 v[152:155], v[80:83], a[196:199], v[152:155]
    v_add_f32_dpp v48, v48, v48 quad_perm:[2,3,0,1] row_mask:0xf bank_mask:0xf
    v_add_f32_dpp v49, v49, v49 quad_perm:[2,3,0,1] row_mask:0xf bank_mask:0xf
    v_mul_f32 v16, v16, v192
    v_mfma_f32_16x16x32_bf16 v[152:155], v[84:87], a[204:207], v[152:155]
    v_add_f32_dpp v50, v50, v50 quad_perm:[2,3,0,1] row_mask:0xf bank_mask:0xf
    v_add_f32_dpp v51, v51, v51 quad_perm:[2,3,0,1] row_mask:0xf bank_mask:0xf
    v_fma_f32 v17, v17, v9, v8
    v_mfma_f32_16x16x32_bf16 v[152:155], v[88:91], a[212:215], v[152:155]
    ds_read_b128 v[80:83], v29 offset:30720
    v_add_f32_dpp v48, v48, v48 quad_perm:[1,0,3,2] row_mask:0xf bank_mask:0xf
    v_add_f32_dpp v49, v49, v49 quad_perm:[1,0,3,2] row_mask:0xf bank_mask:0xf
    v_mfma_f32_16x16x32_bf16 v[152:155], v[64:67], a[220:223], v[152:155]
    v_add_f32_dpp v50, v50, v50 quad_perm:[1,0,3,2] row_mask:0xf bank_mask:0xf
    v_add_f32_dpp v51, v51, v51 quad_perm:[1,0,3,2] row_mask:0xf bank_mask:0xf
    v_mul_f32 v18, v194, v194
    v_mfma_f32_16x16x32_bf16 v[144:147], v[88:91], a[208:211], v[144:147]
    buffer_store_dwordx4 v[48:51], v15, s[8:11], s74 offen sc1
    v_mul_f32 v17, v17, v193
    v_mfma_f32_16x16x32_bf16 v[144:147], v[64:67], a[216:219], v[144:147]
    v_exp_f32 v16, v16
    v_fma_f32 v18, v18, v9, v8
    v_mfma_f32_16x16x32_bf16 v[136:139], v[88:91], a[84:87], v[136:139]
    ds_read_b128 v[84:87], v29 offset:1024
    v_mul_f32 v19, v195, v195
    v_mfma_f32_16x16x32_bf16 v[136:139], v[64:67], a[92:95], v[136:139]
    v_add_f32 v16, 1.0, v16
    v_mul_f32 v18, v18, v194
    v_mfma_f32_16x16x32_bf16 v[128:131], v[88:91], a[80:83], v[128:131]
    v_exp_f32 v17, v17
    v_mfma_f32_16x16x32_bf16 v[128:131], v[64:67], a[88:91], v[128:131]
    v_fma_f32 v19, v19, v9, v8
    s_waitcnt lgkmcnt(1)
    v_mfma_f32_16x16x32_bf16 v[128:131], v[68:71], a[96:99], v[128:131]
    ds_read_b128 v[88:91], v29 offset:3072
    v_mul_f32 v20, v196, v196
    v_mfma_f32_16x16x32_bf16 v[128:131], v[72:75], a[104:107], v[128:131]
    v_rcp_f32 v16, v16
    v_mfma_f32_16x16x32_bf16 v[136:139], v[68:71], a[100:103], v[136:139]
    v_add_f32 v17, 1.0, v17
    v_mul_f32 v19, v19, v195
    v_mfma_f32_16x16x32_bf16 v[136:139], v[72:75], a[108:111], v[136:139]
    v_exp_f32 v18, v18
    v_mfma_f32_16x16x32_bf16 v[144:147], v[68:71], a[224:227], v[144:147]
    ds_read_b128 v[64:67], v29 offset:5120
    v_fma_f32 v20, v20, v9, v8
    v_mfma_f32_16x16x32_bf16 v[144:147], v[72:75], a[232:235], v[144:147]
    v_mul_f32 v21, v197, v197
    v_mul_f32 v192, v192, v16
    v_mfma_f32_16x16x32_bf16 v[152:155], v[68:71], a[228:231], v[152:155]
    v_rcp_f32 v17, v17
    v_mfma_f32_16x16x32_bf16 v[152:155], v[72:75], a[236:239], v[152:155]
    v_add_f32 v18, 1.0, v18
    v_mul_f32 v20, v20, v196
    v_mfma_f32_16x16x32_bf16 v[152:155], v[76:79], a[244:247], v[152:155]
    ds_read_b128 v[68:71], v29 offset:7168
    v_fma_f32 v21, v21, v9, v8
    v_mfma_f32_16x16x32_bf16 v[152:155], v[80:83], a[252:255], v[152:155]
    v_exp_f32 v19, v19
    v_mfma_f32_16x16x32_bf16 v[144:147], v[76:79], a[240:243], v[144:147]
    v_mul_f32 v22, v198, v198
    v_mul_f32 v193, v193, v17
    v_mfma_f32_16x16x32_bf16 v[144:147], v[80:83], a[248:251], v[144:147]
    v_rcp_f32 v18, v18
    v_mfma_f32_16x16x32_bf16 v[136:139], v[76:79], a[116:119], v[136:139]
    ds_read_b128 v[72:75], v29 offset:9216
    v_add_f32 v19, 1.0, v19
    v_mfma_f32_16x16x32_bf16 v[136:139], v[80:83], a[124:127], v[136:139]
    v_exp_f32 v20, v20
    v_mfma_f32_16x16x32_bf16 v[128:131], v[76:79], a[112:115], v[128:131]
    v_mul_f32 v21, v21, v197
    v_fma_f32 v22, v22, v9, v8
    v_mfma_f32_16x16x32_bf16 v[128:131], v[80:83], a[120:123], v[128:131]
    v_mul_f32 v23, v199, v199
    s_waitcnt lgkmcnt(1)
    v_mfma_f32_16x16x32_bf16 v[132:135], v[84:87], a[0:3], 0
    ds_read_b128 v[76:79], v29 offset:11264
    v_mul_f32 v194, v194, v18
    v_mfma_f32_16x16x32_bf16 v[132:135], v[88:91], a[8:11], v[132:135]
    v_rcp_f32 v19, v19
    v_mfma_f32_16x16x32_bf16 v[140:143], v[84:87], a[4:7], 0
    v_add_f32 v20, 1.0, v20
    v_mul_f32 v22, v22, v198
    v_mfma_f32_16x16x32_bf16 v[140:143], v[88:91], a[12:15], v[140:143]
    v_exp_f32 v21, v21
    v_and_b32 v11, 31, v0
    v_lshlrev_b32 v11, 7, v11
    s_lshl_b32 s70, s64, 12
    s_add_u32 s70, s70, 80740352
    buffer_load_dword v27, v11, s[8:11], s70 offen sc1
    v_mfma_f32_16x16x32_bf16 v[148:151], v[84:87], a[128:131], 0
    ds_read_b128 v[80:83], v29 offset:13312
    v_fma_f32 v23, v23, v9, v8
    v_mfma_f32_16x16x32_bf16 v[148:151], v[88:91], a[136:139], v[148:151]
    v_mul_f32 v195, v195, v19
    v_add_f32 v21, 1.0, v21
    v_mfma_f32_16x16x32_bf16 v[156:159], v[84:87], a[132:135], 0
    v_rcp_f32 v20, v20
    v_mfma_f32_16x16x32_bf16 v[156:159], v[88:91], a[140:143], v[156:159]
    v_exp_f32 v22, v22
    v_mfma_f32_16x16x32_bf16 v[156:159], v[64:67], a[148:151], v[156:159]
    ds_read_b128 v[84:87], v29 offset:15360
    v_mul_f32 v23, v23, v199
    v_mfma_f32_16x16x32_bf16 v[156:159], v[68:71], a[156:159], v[156:159]
    v_mul_f32 v196, v196, v20
    v_add_f32 v22, 1.0, v22
    v_mfma_f32_16x16x32_bf16 v[148:151], v[64:67], a[144:147], v[148:151]
    v_rcp_f32 v21, v21
    v_mfma_f32_16x16x32_bf16 v[148:151], v[68:71], a[152:155], v[148:151]
    v_exp_f32 v23, v23
    v_mfma_f32_16x16x32_bf16 v[140:143], v[64:67], a[20:23], v[140:143]
    ds_read_b128 v[88:91], v29 offset:17408
    v_mul_f32 v197, v197, v21
    v_mfma_f32_16x16x32_bf16 v[140:143], v[68:71], a[28:31], v[140:143]
    v_rcp_f32 v22, v22
    v_mfma_f32_16x16x32_bf16 v[132:135], v[64:67], a[16:19], v[132:135]
    v_add_f32 v23, 1.0, v23
    v_mul_f32 v198, v198, v22
    v_mfma_f32_16x16x32_bf16 v[132:135], v[68:71], a[24:27], v[132:135]
    v_mul_f32 v16, v200, v200
    s_waitcnt lgkmcnt(1)
    v_mfma_f32_16x16x32_bf16 v[132:135], v[72:75], a[32:35], v[132:135]
    ds_read_b128 v[64:67], v29 offset:19456
    v_fma_f32 v16, v16, v9, v8
    v_mfma_f32_16x16x32_bf16 v[132:135], v[76:79], a[40:43], v[132:135]
    v_rcp_f32 v23, v23
    v_mfma_f32_16x16x32_bf16 v[140:143], v[72:75], a[36:39], v[140:143]
    v_mul_f32 v199, v199, v23
    v_mul_f32 v17, v201, v201
    v_mfma_f32_16x16x32_bf16 v[140:143], v[76:79], a[44:47], v[140:143]
    v_mul_f32 v16, v16, v200
    v_fma_f32 v17, v17, v9, v8
    v_mfma_f32_16x16x32_bf16 v[148:151], v[72:75], a[160:163], v[148:151]
    ds_read_b128 v[68:71], v29 offset:21504
    v_mul_f32 v18, v202, v202
    v_mfma_f32_16x16x32_bf16 v[148:151], v[76:79], a[168:171], v[148:151]
    v_exp_f32 v16, v16
    v_mfma_f32_16x16x32_bf16 v[156:159], v[72:75], a[164:167], v[156:159]
    v_mul_f32 v17, v17, v201
    v_fma_f32 v18, v18, v9, v8
    v_mfma_f32_16x16x32_bf16 v[156:159], v[76:79], a[172:175], v[156:159]
    v_mul_f32 v19, v203, v203
    v_add_f32 v16, 1.0, v16
    v_mfma_f32_16x16x32_bf16 v[156:159], v[80:83], a[180:183], v[156:159]
    ds_read_b128 v[72:75], v29 offset:23552
    v_mul_f32 v18, v18, v202
    v_mfma_f32_16x16x32_bf16 v[156:159], v[84:87], a[188:191], v[156:159]
    v_exp_f32 v17, v17
    v_mfma_f32_16x16x32_bf16 v[148:151], v[80:83], a[176:179], v[148:151]
    v_fma_f32 v19, v19, v9, v8
    v_mul_f32 v20, v204, v204
    v_mfma_f32_16x16x32_bf16 v[148:151], v[84:87], a[184:187], v[148:151]
    v_rcp_f32 v16, v16
    v_mfma_f32_16x16x32_bf16 v[140:143], v[80:83], a[52:55], v[140:143]
    ds_read_b128 v[76:79], v29 offset:25600
    v_add_f32 v17, 1.0, v17
    v_mfma_f32_16x16x32_bf16 v[140:143], v[84:87], a[60:63], v[140:143]
    v_exp_f32 v18, v18
    v_mfma_f32_16x16x32_bf16 v[132:135], v[80:83], a[48:51], v[132:135]
    v_mul_f32 v19, v19, v203
    v_fma_f32 v20, v20, v9, v8
    v_mfma_f32_16x16x32_bf16 v[132:135], v[84:87], a[56:59], v[132:135]
    v_mul_f32 v21, v205, v205
    s_waitcnt lgkmcnt(1)
    v_mfma_f32_16x16x32_bf16 v[132:135], v[88:91], a[64:67], v[132:135]
    ds_read_b128 v[80:83], v29 offset:27648
    v_mul_f32 v200, v200, v16
    v_mfma_f32_16x16x32_bf16 v[132:135], v[64:67], a[72:75], v[132:135]
    v_rcp_f32 v17, v17
    v_mfma_f32_16x16x32_bf16 v[140:143], v[88:91], a[68:71], v[140:143]
    v_add_f32 v18, 1.0, v18
    v_mul_f32 v20, v20, v204
    v_mfma_f32_16x16x32_bf16 v[140:143], v[64:67], a[76:79], v[140:143]
    v_exp_f32 v19, v19
    s_waitcnt vmcnt(3)
    s_barrier
    v_mfma_f32_16x16x32_bf16 v[148:151], v[88:91], a[192:195], v[148:151]
    ds_read_b128 v[84:87], v29 offset:29696
    v_fma_f32 v21, v21, v9, v8
    v_mfma_f32_16x16x32_bf16 v[148:151], v[64:67], a[200:203], v[148:151]
    v_mul_f32 v22, v206, v206
    v_mul_f32 v201, v201, v17
    v_mfma_f32_16x16x32_bf16 v[156:159], v[88:91], a[196:199], v[156:159]
    v_rcp_f32 v18, v18
    v_mfma_f32_16x16x32_bf16 v[156:159], v[64:67], a[204:207], v[156:159]
    v_add_f32 v19, 1.0, v19
    v_mul_f32 v21, v21, v205
    v_mfma_f32_16x16x32_bf16 v[156:159], v[68:71], a[212:215], v[156:159]
    ds_read_b128 v[88:91], v29 offset:31744
    v_fma_f32 v22, v22, v9, v8
    v_mfma_f32_16x16x32_bf16 v[156:159], v[72:75], a[220:223], v[156:159]
    v_exp_f32 v20, v20
    v_mfma_f32_16x16x32_bf16 v[148:151], v[68:71], a[208:211], v[148:151]
    v_mul_f32 v23, v207, v207
    v_mul_f32 v202, v202, v18
    v_mfma_f32_16x16x32_bf16 v[148:151], v[72:75], a[216:219], v[148:151]
    v_rcp_f32 v19, v19
    v_mfma_f32_16x16x32_bf16 v[140:143], v[68:71], a[84:87], v[140:143]
    ds_read_b128 v[64:67], v7 offset:32768
    v_add_f32 v20, 1.0, v20
    v_mfma_f32_16x16x32_bf16 v[140:143], v[72:75], a[92:95], v[140:143]
    v_exp_f32 v21, v21
    v_mfma_f32_16x16x32_bf16 v[132:135], v[68:71], a[80:83], v[132:135]
    v_mul_f32 v22, v22, v206
    v_fma_f32 v23, v23, v9, v8
    v_mfma_f32_16x16x32_bf16 v[132:135], v[72:75], a[88:91], v[132:135]
    v_mul_f32 v203, v203, v19
    s_waitcnt lgkmcnt(1)
    v_mfma_f32_16x16x32_bf16 v[132:135], v[76:79], a[96:99], v[132:135]
    ds_read_b128 v[68:71], v7 offset:34816
    v_add_f32 v21, 1.0, v21
    v_mfma_f32_16x16x32_bf16 v[132:135], v[80:83], a[104:107], v[132:135]
    v_rcp_f32 v20, v20
    v_mfma_f32_16x16x32_bf16 v[140:143], v[76:79], a[100:103], v[140:143]
    v_exp_f32 v22, v22
    v_mfma_f32_16x16x32_bf16 v[140:143], v[80:83], a[108:111], v[140:143]
    v_mul_f32 v23, v23, v207
    v_mul_f32 v204, v204, v20
    v_mfma_f32_16x16x32_bf16 v[148:151], v[76:79], a[224:227], v[148:151]
    ds_read_b128 v[72:75], v7 offset:36864
    v_add_f32 v22, 1.0, v22
    v_mfma_f32_16x16x32_bf16 v[148:151], v[80:83], a[232:235], v[148:151]
    v_rcp_f32 v21, v21
    v_mfma_f32_16x16x32_bf16 v[156:159], v[76:79], a[228:231], v[156:159]
    v_exp_f32 v23, v23
    v_mfma_f32_16x16x32_bf16 v[156:159], v[80:83], a[236:239], v[156:159]
    v_mul_f32 v205, v205, v21
    v_add_f32 v23, 1.0, v23
    v_mfma_f32_16x16x32_bf16 v[156:159], v[84:87], a[244:247], v[156:159]
    ds_read_b128 v[76:79], v7 offset:38912
    v_mul_f32 v16, v208, v208
    v_mfma_f32_16x16x32_bf16 v[156:159], v[88:91], a[252:255], v[156:159]
    v_rcp_f32 v22, v22
    v_mfma_f32_16x16x32_bf16 v[148:151], v[84:87], a[240:243], v[148:151]
    v_mul_f32 v206, v206, v22
    v_fma_f32 v16, v16, v9, v8
    v_mfma_f32_16x16x32_bf16 v[148:151], v[88:91], a[248:251], v[148:151]
    v_rcp_f32 v23, v23
    s_waitcnt vmcnt(1)
    s_barrier
    s_lshl_b32 s35, s72, 7
    s_add_u32 s35, s35, 80773120
    v_mov_b32 v14, s75
    buffer_store_dword v14, v10, s[8:11], s35 offen sc1
    v_mfma_f32_16x16x32_bf16 v[140:143], v[84:87], a[116:119], v[140:143]
    ds_read_b128 v[80:83], v7 offset:40960
    v_mul_f32 v207, v207, v23
    v_mfma_f32_16x16x32_bf16 v[140:143], v[88:91], a[124:127], v[140:143]
    v_mul_f32 v17, v209, v209
    v_mul_f32 v16, v16, v208
    v_mfma_f32_16x16x32_bf16 v[132:135], v[84:87], a[112:115], v[132:135]
    v_fma_f32 v17, v17, v9, v8
    v_mul_f32 v18, v210, v210
    v_mfma_f32_16x16x32_bf16 v[132:135], v[88:91], a[120:123], v[132:135]
    v_mul_f32 v17, v17, v209
    s_waitcnt lgkmcnt(1)
    v_mfma_f32_16x16x32_bf16 v[32:35], v[64:67], a[0:3], 0
    ds_read_b128 v[84:87], v7 offset:43008
    v_fma_f32 v18, v18, v9, v8
    v_mfma_f32_16x16x32_bf16 v[32:35], v[68:71], a[8:11], v[32:35]
    v_exp_f32 v16, v16
    v_mfma_f32_16x16x32_bf16 v[40:43], v[64:67], a[4:7], 0
    v_mul_f32 v19, v211, v211
    v_add_f32 v16, 1.0, v16
    v_mfma_f32_16x16x32_bf16 v[40:43], v[68:71], a[12:15], v[40:43]
    v_exp_f32 v17, v17
    v_mfma_f32_16x16x32_bf16 v[48:51], v[64:67], a[128:131], 0
    ds_read_b128 v[88:91], v7 offset:45056
    v_mul_f32 v18, v18, v210
    v_mfma_f32_16x16x32_bf16 v[48:51], v[68:71], a[136:139], v[48:51]
    v_fma_f32 v19, v19, v9, v8
    v_mul_f32 v20, v212, v212
    v_mfma_f32_16x16x32_bf16 v[56:59], v[64:67], a[132:135], 0
    v_rcp_f32 v16, v16
    v_mfma_f32_16x16x32_bf16 v[56:59], v[68:71], a[140:143], v[56:59]
    v_cvt_pk_bf16_f32 v144, v144, v145
    v_cvt_pk_bf16_f32 v145, v146, v147
    v_mfma_f32_16x16x32_bf16 v[56:59], v[72:75], a[148:151], v[56:59]
    ds_read_b128 v[64:67], v7 offset:47104
    v_cvt_pk_bf16_f32 v146, v148, v149
    v_mfma_f32_16x16x32_bf16 v[56:59], v[76:79], a[156:159], v[56:59]
    v_cvt_pk_bf16_f32 v147, v150, v151
    v_cvt_pk_bf16_f32 v152, v152, v153
    v_mfma_f32_16x16x32_bf16 v[48:51], v[72:75], a[144:147], v[48:51]
    buffer_store_dwordx4 v[144:147], v4, s[8:11], s61 offen offset:0 sc1
    v_mfma_f32_16x16x32_bf16 v[48:51], v[76:79], a[152:155], v[48:51]
    v_cvt_pk_bf16_f32 v153, v154, v155
    v_cvt_pk_bf16_f32 v154, v156, v157
    v_mfma_f32_16x16x32_bf16 v[40:43], v[72:75], a[20:23], v[40:43]
    ds_read_b128 v[68:71], v7 offset:49152
    v_cvt_pk_bf16_f32 v155, v158, v159
    v_mfma_f32_16x16x32_bf16 v[40:43], v[76:79], a[28:31], v[40:43]
    buffer_store_dwordx4 v[152:155], v4, s[8:11], s61 offen offset:1024 sc1
    v_mfma_f32_16x16x32_bf16 v[32:35], v[72:75], a[16:19], v[32:35]
    v_cvt_pk_bf16_f32 v128, v128, v129
    v_cvt_pk_bf16_f32 v129, v130, v131
    v_mfma_f32_16x16x32_bf16 v[32:35], v[76:79], a[24:27], v[32:35]
    v_cvt_pk_bf16_f32 v130, v132, v133
    s_waitcnt lgkmcnt(1)
    v_mfma_f32_16x16x32_bf16 v[32:35], v[80:83], a[32:35], v[32:35]
    ds_read_b128 v[72:75], v7 offset:51200
    v_cvt_pk_bf16_f32 v131, v134, v135
    v_mfma_f32_16x16x32_bf16 v[32:35], v[84:87], a[40:43], v[32:35]
    buffer_store_dwordx4 v[128:131], v3, s[8:11], s60 offen offset:0 sc1
    v_mfma_f32_16x16x32_bf16 v[40:43], v[80:83], a[36:39], v[40:43]
    v_cvt_pk_bf16_f32 v136, v136, v137
    v_cvt_pk_bf16_f32 v137, v138, v139
    v_mfma_f32_16x16x32_bf16 v[40:43], v[84:87], a[44:47], v[40:43]
    v_cvt_pk_bf16_f32 v138, v140, v141
    v_cvt_pk_bf16_f32 v139, v142, v143
    v_mfma_f32_16x16x32_bf16 v[48:51], v[80:83], a[160:163], v[48:51]
    ds_read_b128 v[76:79], v7 offset:53248
    v_add_f32 v17, 1.0, v17
    v_mfma_f32_16x16x32_bf16 v[48:51], v[84:87], a[168:171], v[48:51]
    buffer_store_dwordx4 v[136:139], v3, s[8:11], s60 offen offset:1024 sc1
    v_mfma_f32_16x16x32_bf16 v[56:59], v[80:83], a[164:167], v[56:59]
    v_exp_f32 v18, v18
    v_mfma_f32_16x16x32_bf16 v[56:59], v[84:87], a[172:175], v[56:59]
    v_mul_f32 v19, v19, v211
    v_fma_f32 v20, v20, v9, v8
    v_mfma_f32_16x16x32_bf16 v[56:59], v[88:91], a[180:183], v[56:59]
    ds_read_b128 v[80:83], v7 offset:55296
    v_mul_f32 v21, v213, v213
    v_mfma_f32_16x16x32_bf16 v[56:59], v[64:67], a[188:191], v[56:59]
    v_mul_f32 v208, v208, v16
    v_add_f32 v18, 1.0, v18
    v_mfma_f32_16x16x32_bf16 v[48:51], v[88:91], a[176:179], v[48:51]
    v_rcp_f32 v17, v17
    v_mfma_f32_16x16x32_bf16 v[48:51], v[64:67], a[184:187], v[48:51]
    v_exp_f32 v19, v19
    s_waitcnt vmcnt(5)
    v_cmp_ne_u32 vcc, s75, v27
    s_cbranch_vccnz L_p3slow
L_p3ok:
    v_mfma_f32_16x16x32_bf16 v[40:43], v[88:91], a[52:55], v[40:43]
    ds_read_b128 v[84:87], v7 offset:57344
    v_mul_f32 v20, v20, v212
    v_mfma_f32_16x16x32_bf16 v[40:43], v[64:67], a[60:63], v[40:43]
    v_fma_f32 v21, v21, v9, v8
    v_mul_f32 v22, v214, v214
    v_mfma_f32_16x16x32_bf16 v[32:35], v[88:91], a[48:51], v[32:35]
    s_add_u32 s30, s65, 524288
    s_add_u32 m0, s33, 98304
    s_nop 0
    buffer_load_dwordx4 v1, s[8:11], s30 offen offset:0 sc1 lds
    v_mfma_f32_16x16x32_bf16 v[32:35], v[64:67], a[56:59], v[32:35]
    v_mul_f32 v209, v209, v17
    s_waitcnt lgkmcnt(1)
    v_mfma_f32_16x16x32_bf16 v[32:35], v[68:71], a[64:67], v[32:35]
    ds_read_b128 v[88:91], v7 offset:59392
    v_add_f32 v19, 1.0, v19
    v_mfma_f32_16x16x32_bf16 v[32:35], v[72:75], a[72:75], v[32:35]
    v_rcp_f32 v18, v18
    v_mfma_f32_16x16x32_bf16 v[40:43], v[68:71], a[68:71], v[40:43]
    buffer_load_dwordx4 v1, s[8:11], s30 offen offset:1024 sc1 lds
    v_mfma_f32_16x16x32_bf16 v[40:43], v[72:75], a[76:79], v[40:43]
    v_exp_f32 v20, v20
    v_mfma_f32_16x16x32_bf16 v[48:51], v[68:71], a[192:195], v[48:51]
    ds_read_b128 v[64:67], v7 offset:61440
    v_mul_f32 v21, v21, v213
    v_mfma_f32_16x16x32_bf16 v[48:51], v[72:75], a[200:203], v[48:51]
    v_fma_f32 v22, v22, v9, v8
    v_mul_f32 v23, v215, v215
    v_mfma_f32_16x16x32_bf16 v[56:59], v[68:71], a[196:199], v[56:59]
    buffer_load_dwordx4 v1, s[8:11], s30 offen offset:2048 sc1 lds
    v_mfma_f32_16x16x32_bf16 v[56:59], v[72:75], a[204:207], v[56:59]
    v_mul_f32 v210, v210, v18
    v_add_f32 v20, 1.0, v20
    v_mfma_f32_16x16x32_bf16 v[56:59], v[76:79], a[212:215], v[56:59]
    ds_read_b128 v[68:71], v7 offset:63488
    v_mul_f32 v22, v22, v214
    v_mfma_f32_16x16x32_bf16 v[56:59], v[80:83], a[220:223], v[56:59]
    v_rcp_f32 v19, v19
    v_mfma_f32_16x16x32_bf16 v[48:51], v[76:79], a[208:211], v[48:51]
    buffer_load_dwordx4 v1, s[8:11], s30 offen offset:3072 sc1 lds
    v_mfma_f32_16x16x32_bf16 v[48:51], v[80:83], a[216:219], v[48:51]
    v_exp_f32 v21, v21
    v_mfma_f32_16x16x32_bf16 v[40:43], v[76:79], a[84:87], v[40:43]
    ds_read_b128 v[72:75], v7 offset:33792
    v_fma_f32 v23, v23, v9, v8
    v_mfma_f32_16x16x32_bf16 v[40:43], v[80:83], a[92:95], v[40:43]
    v_mul_f32 v211, v211, v19
    v_add_f32 v21, 1.0, v21
    v_mfma_f32_16x16x32_bf16 v[32:35], v[76:79], a[80:83], v[32:35]
    s_add_u32 m0, s33, 102400
    s_nop 0
    buffer_load_dwordx4 v2, s[8:11], s30 offen offset:0 sc1 lds
    v_mfma_f32_16x16x32_bf16 v[32:35], v[80:83], a[88:91], v[32:35]
    v_mul_f32 v23, v23, v215
    s_waitcnt lgkmcnt(1)
    v_mfma_f32_16x16x32_bf16 v[32:35], v[84:87], a[96:99], v[32:35]
    ds_read_b128 v[76:79], v7 offset:35840
    v_mul_f32 v16, v216, v216
    v_mfma_f32_16x16x32_bf16 v[32:35], v[88:91], a[104:107], v[32:35]
    v_rcp_f32 v20, v20
    v_mfma_f32_16x16x32_bf16 v[40:43], v[84:87], a[100:103], v[40:43]
    buffer_load_dwordx4 v2, s[8:11], s30 offen offset:1024 sc1 lds
    v_mfma_f32_16x16x32_bf16 v[40:43], v[88:91], a[108:111], v[40:43]
    v_exp_f32 v22, v22
    s_lshr_b32 s63, s6, 1
    v_lshrrev_b32 v13, 3, v0
    s_sub_u32 s38, s63, 1
    v_add_u32 v11, s38, v13
    v_med3_i32 v11, v11, 0, 15
    s_lshr_b32 s38, s20, 15
    s_sub_u32 s38, s38, s37
    v_cmp_lt_u32 vcc, 2, v13
    v_and_b32 v13, 1, v13
    v_add_u32 v13, s38, v13
    v_lshrrev_b32 v13, 3, v13
    v_cndmask_b32 v11, v11, v13, vcc
    v_and_b32 v13, 7, v0
    v_lshl_add_u32 v11, v11, 3, v13
    v_lshlrev_b32 v11, 7, v11
    s_and_b32 s38, s32, 32
    s_lshl_b32 s38, s38, 9
    s_add_u32 s38, s38, 80773120
    buffer_load_dword v26, v11, s[8:11], s38 offen sc1
    v_mfma_f32_16x16x32_bf16 v[48:51], v[84:87], a[224:227], v[48:51]
    ds_read_b128 v[80:83], v7 offset:37888
    v_mul_f32 v212, v212, v20
    v_mfma_f32_16x16x32_bf16 v[48:51], v[88:91], a[232:235], v[48:51]
    v_rcp_f32 v21, v21
    v_mfma_f32_16x16x32_bf16 v[56:59], v[84:87], a[228:231], v[56:59]
    buffer_load_dwordx4 v2, s[8:11], s30 offen offset:2048 sc1 lds
    v_mfma_f32_16x16x32_bf16 v[56:59], v[88:91], a[236:239], v[56:59]
    v_add_f32 v22, 1.0, v22
    v_mul_f32 v213, v213, v21
    v_mfma_f32_16x16x32_bf16 v[56:59], v[64:67], a[244:247], v[56:59]
    ds_read_b128 v[84:87], v7 offset:39936
    v_fma_f32 v16, v16, v9, v8
    v_mfma_f32_16x16x32_bf16 v[56:59], v[68:71], a[252:255], v[56:59]
    v_exp_f32 v23, v23
    v_mfma_f32_16x16x32_bf16 v[48:51], v[64:67], a[240:243], v[48:51]
    buffer_load_dwordx4 v2, s[8:11], s30 offen offset:3072 sc1 lds
    v_mfma_f32_16x16x32_bf16 v[48:51], v[68:71], a[248:251], v[48:51]
    v_rcp_f32 v22, v22
    v_mfma_f32_16x16x32_bf16 v[40:43], v[64:67], a[116:119], v[40:43]
    ds_read_b128 v[88:91], v7 offset:41984
    v_add_f32 v23, 1.0, v23
    v_mfma_f32_16x16x32_bf16 v[40:43], v[68:71], a[124:127], v[40:43]
    v_mul_f32 v214, v214, v22
    v_mul_f32 v17, v217, v217
    v_mfma_f32_16x16x32_bf16 v[32:35], v[64:67], a[112:115], v[32:35]
    s_add_u32 s30, s65, 557056
    s_add_u32 m0, s33, 65536
    s_nop 0
    buffer_load_dwordx4 v1, s[8:11], s30 offen offset:0 sc1 lds
    v_mfma_f32_16x16x32_bf16 v[32:35], v[68:71], a[120:123], v[32:35]
    v_mul_f32 v16, v16, v216
    s_waitcnt lgkmcnt(1)
    v_mfma_f32_16x16x32_bf16 v[36:39], v[72:75], a[0:3], 0
    ds_read_b128 v[64:67], v7 offset:44032
    v_fma_f32 v17, v17, v9, v8
    v_mfma_f32_16x16x32_bf16 v[36:39], v[76:79], a[8:11], v[36:39]
    v_rcp_f32 v23, v23
    v_mfma_f32_16x16x32_bf16 v[44:47], v[72:75], a[4:7], 0
    buffer_load_dwordx4 v1, s[8:11], s30 offen offset:1024 sc1 lds
    v_mfma_f32_16x16x32_bf16 v[44:47], v[76:79], a[12:15], v[44:47]
    v_mul_f32 v215, v215, v23
    v_mul_f32 v18, v218, v218
    v_mfma_f32_16x16x32_bf16 v[52:55], v[72:75], a[128:131], 0
    ds_read_b128 v[68:71], v7 offset:46080
    v_mul_f32 v17, v17, v217
    v_mfma_f32_16x16x32_bf16 v[52:55], v[76:79], a[136:139], v[52:55]
    v_exp_f32 v16, v16
    v_mfma_f32_16x16x32_bf16 v[60:63], v[72:75], a[132:135], 0
    buffer_load_dwordx4 v1, s[8:11], s30 offen offset:2048 sc1 lds
    v_mfma_f32_16x16x32_bf16 v[60:63], v[76:79], a[140:143], v[60:63]
    v_fma_f32 v18, v18, v9, v8
    v_mul_f32 v19, v219, v219
    v_mfma_f32_16x16x32_bf16 v[60:63], v[80:83], a[148:151], v[60:63]
    ds_read_b128 v[72:75], v7 offset:48128
    v_add_f32 v16, 1.0, v16
    v_mfma_f32_16x16x32_bf16 v[60:63], v[84:87], a[156:159], v[60:63]
    v_exp_f32 v17, v17
    v_mfma_f32_16x16x32_bf16 v[52:55], v[80:83], a[144:147], v[52:55]
    buffer_load_dwordx4 v1, s[8:11], s30 offen offset:3072 sc1 lds
    v_mfma_f32_16x16x32_bf16 v[52:55], v[84:87], a[152:155], v[52:55]
    v_mul_f32 v18, v18, v218
    v_fma_f32 v19, v19, v9, v8
    v_mfma_f32_16x16x32_bf16 v[44:47], v[80:83], a[20:23], v[44:47]
    ds_read_b128 v[76:79], v7 offset:50176
    v_mul_f32 v20, v220, v220
    v_mfma_f32_16x16x32_bf16 v[44:47], v[84:87], a[28:31], v[44:47]
    v_rcp_f32 v16, v16
    v_mfma_f32_16x16x32_bf16 v[36:39], v[80:83], a[16:19], v[36:39]
    s_add_u32 m0, s33, 69632
    s_nop 0
    buffer_load_dwordx4 v2, s[8:11], s30 offen offset:0 sc1 lds
    v_mfma_f32_16x16x32_bf16 v[36:39], v[84:87], a[24:27], v[36:39]
    v_add_f32 v17, 1.0, v17
    s_waitcnt lgkmcnt(1)
    v_mfma_f32_16x16x32_bf16 v[36:39], v[88:91], a[32:35], v[36:39]
    ds_read_b128 v[80:83], v7 offset:52224
    v_mul_f32 v19, v19, v219
    v_mfma_f32_16x16x32_bf16 v[36:39], v[64:67], a[40:43], v[36:39]
    v_exp_f32 v18, v18
    v_mfma_f32_16x16x32_bf16 v[44:47], v[88:91], a[36:39], v[44:47]
    buffer_load_dwordx4 v2, s[8:11], s30 offen offset:1024 sc1 lds
    v_mfma_f32_16x16x32_bf16 v[44:47], v[64:67], a[44:47], v[44:47]
    v_fma_f32 v20, v20, v9, v8
    v_mul_f32 v21, v221, v221
    v_mfma_f32_16x16x32_bf16 v[52:55], v[88:91], a[160:163], v[52:55]
    ds_read_b128 v[84:87], v7 offset:54272
    v_mul_f32 v216, v216, v16
    v_mfma_f32_16x16x32_bf16 v[52:55], v[64:67], a[168:171], v[52:55]
    v_rcp_f32 v17, v17
    v_mfma_f32_16x16x32_bf16 v[60:63], v[88:91], a[164:167], v[60:63]
    buffer_load_dwordx4 v2, s[8:11], s30 offen offset:2048 sc1 lds
    v_mfma_f32_16x16x32_bf16 v[60:63], v[64:67], a[172:175], v[60:63]
    v_add_f32 v18, 1.0, v18
    v_mul_f32 v20, v20, v220
    v_mfma_f32_16x16x32_bf16 v[60:63], v[68:71], a[180:183], v[60:63]
    ds_read_b128 v[88:91], v7 offset:56320
    v_fma_f32 v21, v21, v9, v8
    v_mfma_f32_16x16x32_bf16 v[60:63], v[72:75], a[188:191], v[60:63]
    v_exp_f32 v19, v19
    v_mfma_f32_16x16x32_bf16 v[52:55], v[68:71], a[176:179], v[52:55]
    buffer_load_dwordx4 v2, s[8:11], s30 offen offset:3072 sc1 lds
    v_mfma_f32_16x16x32_bf16 v[52:55], v[72:75], a[184:187], v[52:55]
    v_mul_f32 v22, v222, v222
    v_mul_f32 v217, v217, v17
    v_mfma_f32_16x16x32_bf16 v[44:47], v[68:71], a[52:55], v[44:47]
    ds_read_b128 v[64:67], v7 offset:58368
    v_add_f32 v19, 1.0, v19
    v_mfma_f32_16x16x32_bf16 v[44:47], v[72:75], a[60:63], v[44:47]
    v_rcp_f32 v18, v18
    v_mfma_f32_16x16x32_bf16 v[36:39], v[68:71], a[48:51], v[36:39]
    v_exp_f32 v20, v20
    v_mfma_f32_16x16x32_bf16 v[36:39], v[72:75], a[56:59], v[36:39]
    v_mul_f32 v21, v21, v221
    s_waitcnt lgkmcnt(1)
    v_mfma_f32_16x16x32_bf16 v[36:39], v[76:79], a[64:67], v[36:39]
    ds_read_b128 v[68:71], v7 offset:60416
    v_fma_f32 v22, v22, v9, v8
    v_mfma_f32_16x16x32_bf16 v[36:39], v[80:83], a[72:75], v[36:39]
    v_mul_f32 v23, v223, v223
    v_mul_f32 v218, v218, v18
    v_mfma_f32_16x16x32_bf16 v[44:47], v[76:79], a[68:71], v[44:47]
    v_rcp_f32 v19, v19
    v_mfma_f32_16x16x32_bf16 v[44:47], v[80:83], a[76:79], v[44:47]
    v_add_f32 v20, 1.0, v20
    v_mul_f32 v22, v22, v222
    v_mfma_f32_16x16x32_bf16 v[52:55], v[76:79], a[192:195], v[52:55]
    ds_read_b128 v[72:75], v7 offset:62464
    v_fma_f32 v23, v23, v9, v8
    v_mfma_f32_16x16x32_bf16 v[52:55], v[80:83], a[200:203], v[52:55]
    v_exp_f32 v21, v21
    v_mfma_f32_16x16x32_bf16 v[60:63], v[76:79], a[196:199], v[60:63]
    v_mul_f32 v219, v219, v19
    v_add_f32 v21, 1.0, v21
    v_mfma_f32_16x16x32_bf16 v[60:63], v[80:83], a[204:207], v[60:63]
    v_rcp_f32 v20, v20
    v_mfma_f32_16x16x32_bf16 v[60:63], v[84:87], a[212:215], v[60:63]
    ds_read_b128 v[76:79], v7 offset:64512
    v_mul_f32 v23, v23, v223
    v_mfma_f32_16x16x32_bf16 v[60:63], v[88:91], a[220:223], v[60:63]
    v_exp_f32 v22, v22
    v_mfma_f32_16x16x32_bf16 v[52:55], v[84:87], a[208:211], v[52:55]
    v_mul_f32 v220, v220, v20
    v_add_f32 v22, 1.0, v22
    v_mfma_f32_16x16x32_bf16 v[52:55], v[88:91], a[216:219], v[52:55]
    v_rcp_f32 v21, v21
    s_waitcnt vmcnt(8)
    s_barrier
    v_mfma_f32_16x16x32_bf16 v[44:47], v[84:87], a[84:87], v[44:47]
    ds_read2st64_b64 v[80:83], v5 offset0:64 offset1:65
    v_mul_f32 v221, v221, v21
    v_mfma_f32_16x16x32_bf16 v[44:47], v[88:91], a[92:95], v[44:47]
    v_exp_f32 v23, v23
    v_mfma_f32_16x16x32_bf16 v[36:39], v[84:87], a[80:83], v[36:39]
    v_rcp_f32 v22, v22
    v_mfma_f32_16x16x32_bf16 v[36:39], v[88:91], a[88:91], v[36:39]
    v_add_f32 v23, 1.0, v23
    s_waitcnt lgkmcnt(1)
    v_mfma_f32_16x16x32_bf16 v[36:39], v[64:67], a[96:99], v[36:39]
    ds_read2st64_b64 v[84:87], v5 offset0:68 offset1:69
    v_mul_f32 v222, v222, v22
    v_mfma_f32_16x16x32_bf16 v[36:39], v[68:71], a[104:107], v[36:39]
    v_rcp_f32 v23, v23
    v_mfma_f32_16x16x32_bf16 v[44:47], v[64:67], a[100:103], v[44:47]
    v_mul_f32 v223, v223, v23
    v_mul_f32 v16, v224, v224
    v_mfma_f32_16x16x32_bf16 v[44:47], v[68:71], a[108:111], v[44:47]
    v_fma_f32 v16, v16, v9, v8
    v_mul_f32 v17, v225, v225
    v_mfma_f32_16x16x32_bf16 v[52:55], v[64:67], a[224:227], v[52:55]
    ds_read2st64_b64 v[88:91], v5 offset0:72 offset1:73
    v_mul_f32 v16, v16, v224
    v_mfma_f32_16x16x32_bf16 v[52:55], v[68:71], a[232:235], v[52:55]
    v_fma_f32 v17, v17, v9, v8
    v_mul_f32 v18, v226, v226
    v_mfma_f32_16x16x32_bf16 v[60:63], v[64:67], a[228:231], v[60:63]
    v_exp_f32 v16, v16
    v_mfma_f32_16x16x32_bf16 v[60:63], v[68:71], a[236:239], v[60:63]
    v_mul_f32 v17, v17, v225
    v_fma_f32 v18, v18, v9, v8
    v_mfma_f32_16x16x32_bf16 v[60:63], v[72:75], a[244:247], v[60:63]
    ds_read2st64_b64 v[64:67], v5 offset0:76 offset1:77
    v_mul_f32 v19, v227, v227
    v_mfma_f32_16x16x32_bf16 v[60:63], v[76:79], a[252:255], v[60:63]
    v_add_f32 v16, 1.0, v16
    v_mul_f32 v18, v18, v226
    v_mfma_f32_16x16x32_bf16 v[52:55], v[72:75], a[240:243], v[52:55]
    v_exp_f32 v17, v17
    v_mfma_f32_16x16x32_bf16 v[52:55], v[76:79], a[248:251], v[52:55]
    v_fma_f32 v19, v19, v9, v8
    v_mul_f32 v20, v228, v228
    v_mfma_f32_16x16x32_bf16 v[44:47], v[72:75], a[116:119], v[44:47]
    ds_read2st64_b64 v[68:71], v5 offset0:80 offset1:81
    v_add_f32 v17, 1.0, v17
    v_mfma_f32_16x16x32_bf16 v[44:47], v[76:79], a[124:127], v[44:47]
    v_rcp_f32 v16, v16
    v_mfma_f32_16x16x32_bf16 v[36:39], v[72:75], a[112:115], v[36:39]
    v_exp_f32 v18, v18
    v_mfma_f32_16x16x32_bf16 v[36:39], v[76:79], a[120:123], v[36:39]
    v_mul_f32 v19, v19, v227
    s_waitcnt lgkmcnt(1)
    v_mfma_f32_16x16x32_bf16 v[128:131], a[0:3], v[80:83], 0
    ds_read2st64_b64 v[72:75], v5 offset0:84 offset1:85
    v_fma_f32 v20, v20, v9, v8
    v_mfma_f32_16x16x32_bf16 v[128:131], a[8:11], v[84:87], v[128:131]
    v_mul_f32 v21, v229, v229
    v_mul_f32 v224, v224, v16
    v_mfma_f32_16x16x32_bf16 v[132:135], a[4:7], v[80:83], 0
    v_rcp_f32 v17, v17
    v_mfma_f32_16x16x32_bf16 v[132:135], a[12:15], v[84:87], v[132:135]
    v_add_f32 v18, 1.0, v18
    v_mul_f32 v20, v20, v228
    v_mfma_f32_16x16x32_bf16 v[144:147], a[128:131], v[80:83], 0
    ds_read2st64_b64 v[76:79], v5 offset0:88 offset1:89
    v_fma_f32 v21, v21, v9, v8
    v_mfma_f32_16x16x32_bf16 v[144:147], a[136:139], v[84:87], v[144:147]
    v_exp_f32 v19, v19
    v_mfma_f32_16x16x32_bf16 v[148:151], a[132:135], v[80:83], 0
    v_mul_f32 v22, v230, v230
    v_mul_f32 v225, v225, v17
    v_mfma_f32_16x16x32_bf16 v[148:151], a[140:143], v[84:87], v[148:151]
    v_cvt_pk_bf16_f32 v48, v48, v49
    v_cvt_pk_bf16_f32 v49, v50, v51
    v_mfma_f32_16x16x32_bf16 v[148:151], a[148:151], v[88:91], v[148:151]
    ds_read2st64_b64 v[80:83], v5 offset0:92 offset1:93
    v_cvt_pk_bf16_f32 v50, v52, v53
    v_mfma_f32_16x16x32_bf16 v[148:151], a[156:159], v[64:67], v[148:151]
    v_cvt_pk_bf16_f32 v51, v54, v55
    v_cvt_pk_bf16_f32 v56, v56, v57
    v_mfma_f32_16x16x32_bf16 v[144:147], a[144:147], v[88:91], v[144:147]
    buffer_store_dwordx4 v[48:51], v4, s[8:11], s61 offen offset:2048 sc1
    v_mfma_f32_16x16x32_bf16 v[144:147], a[152:155], v[64:67], v[144:147]
    v_cvt_pk_bf16_f32 v57, v58, v59
    v_cvt_pk_bf16_f32 v58, v60, v61
    s_waitcnt vmcnt(11)
    v_cmp_ne_u32 vcc, s75, v26
    s_cbranch_vccnz L_f1s
L_f1k:
    v_mfma_f32_16x16x32_bf16 v[132:135], a[20:23], v[88:91], v[132:135]
    ds_read2st64_b64 v[84:87], v5 offset0:96 offset1:97
    v_cvt_pk_bf16_f32 v59, v62, v63
    v_mfma_f32_16x16x32_bf16 v[132:135], a[28:31], v[64:67], v[132:135]
    buffer_store_dwordx4 v[56:59], v4, s[8:11], s61 offen offset:3072 sc1
    v_mfma_f32_16x16x32_bf16 v[128:131], a[16:19], v[88:91], v[128:131]
    s_mov_b32 s22, s33
    s_mov_b32 m0, s22
    s_nop 0
    buffer_load_dwordx4 v1, s[8:11], s20 offen offset:0 sc1 lds
    v_mfma_f32_16x16x32_bf16 v[128:131], a[24:27], v[64:67], v[128:131]
    v_cvt_pk_bf16_f32 v32, v32, v33
    s_waitcnt lgkmcnt(1)
    v_mfma_f32_16x16x32_bf16 v[128:131], a[32:35], v[68:71], v[128:131]
    ds_read2st64_b64 v[88:91], v5 offset0:100 offset1:101
    v_cvt_pk_bf16_f32 v33, v34, v35
    v_mfma_f32_16x16x32_bf16 v[128:131], a[40:43], v[72:75], v[128:131]
    v_cvt_pk_bf16_f32 v34, v36, v37
    v_cvt_pk_bf16_f32 v35, v38, v39
    v_mfma_f32_16x16x32_bf16 v[132:135], a[36:39], v[68:71], v[132:135]
    buffer_load_dwordx4 v1, s[8:11], s20 offen offset:1024 sc1 lds
    v_mfma_f32_16x16x32_bf16 v[132:135], a[44:47], v[72:75], v[132:135]
    buffer_store_dwordx4 v[32:35], v3, s[8:11], s60 offen offset:2048 sc1
    v_mfma_f32_16x16x32_bf16 v[144:147], a[160:163], v[68:71], v[144:147]
    ds_read2st64_b64 v[64:67], v5 offset0:104 offset1:105
    v_cvt_pk_bf16_f32 v40, v40, v41
    v_mfma_f32_16x16x32_bf16 v[144:147], a[168:171], v[72:75], v[144:147]
    v_cvt_pk_bf16_f32 v41, v42, v43
    v_cvt_pk_bf16_f32 v42, v44, v45
    v_mfma_f32_16x16x32_bf16 v[148:151], a[164:167], v[68:71], v[148:151]
    buffer_load_dwordx4 v1, s[8:11], s20 offen offset:2048 sc1 lds
    v_mfma_f32_16x16x32_bf16 v[148:151], a[172:175], v[72:75], v[148:151]
    v_cvt_pk_bf16_f32 v43, v46, v47
    v_add_f32 v19, 1.0, v19
    v_mfma_f32_16x16x32_bf16 v[148:151], a[180:183], v[76:79], v[148:151]
    ds_read2st64_b64 v[68:71], v5 offset0:108 offset1:109
    v_mul_f32 v21, v21, v229
    v_mfma_f32_16x16x32_bf16 v[148:151], a[188:191], v[80:83], v[148:151]
    buffer_store_dwordx4 v[40:43], v3, s[8:11], s60 offen offset:3072 sc1
    v_mfma_f32_16x16x32_bf16 v[144:147], a[176:179], v[76:79], v[144:147]
    buffer_load_dwordx4 v1, s[8:11], s20 offen offset:3072 sc1 lds
    v_mfma_f32_16x16x32_bf16 v[144:147], a[184:187], v[80:83], v[144:147]
    v_rcp_f32 v18, v18
    v_mfma_f32_16x16x32_bf16 v[132:135], a[52:55], v[76:79], v[132:135]
    ds_read2st64_b64 v[72:75], v5 offset0:112 offset1:113
    v_fma_f32 v22, v22, v9, v8
    v_mfma_f32_16x16x32_bf16 v[132:135], a[60:63], v[80:83], v[132:135]
    v_exp_f32 v20, v20
    v_mfma_f32_16x16x32_bf16 v[128:131], a[48:51], v[76:79], v[128:131]
    s_add_u32 m0, s22, 4096
    s_nop 0
    buffer_load_dwordx4 v2, s[8:11], s20 offen offset:0 sc1 lds
    v_mfma_f32_16x16x32_bf16 v[128:131], a[56:59], v[80:83], v[128:131]
    v_mul_f32 v23, v231, v231
    s_waitcnt lgkmcnt(1)
    v_mfma_f32_16x16x32_bf16 v[128:131], a[64:67], v[84:87], v[128:131]
    ds_read2st64_b64 v[76:79], v5 offset0:116 offset1:117
    v_mul_f32 v226, v226, v18
    v_mfma_f32_16x16x32_bf16 v[128:131], a[72:75], v[88:91], v[128:131]
    v_rcp_f32 v19, v19
    v_mfma_f32_16x16x32_bf16 v[132:135], a[68:71], v[84:87], v[132:135]
    buffer_load_dwordx4 v2, s[8:11], s20 offen offset:1024 sc1 lds
    v_mfma_f32_16x16x32_bf16 v[132:135], a[76:79], v[88:91], v[132:135]
    v_add_f32 v20, 1.0, v20
    v_mul_f32 v22, v22, v230
    v_mfma_f32_16x16x32_bf16 v[144:147], a[192:195], v[84:87], v[144:147]
    ds_read2st64_b64 v[80:83], v5 offset0:120 offset1:121
    v_fma_f32 v23, v23, v9, v8
    v_mfma_f32_16x16x32_bf16 v[144:147], a[200:203], v[88:91], v[144:147]
    v_exp_f32 v21, v21
    v_mfma_f32_16x16x32_bf16 v[148:151], a[196:199], v[84:87], v[148:151]
    buffer_load_dwordx4 v2, s[8:11], s20 offen offset:2048 sc1 lds
    v_mfma_f32_16x16x32_bf16 v[148:151], a[204:207], v[88:91], v[148:151]
    v_mul_f32 v227, v227, v19
    v_add_f32 v21, 1.0, v21
    v_mfma_f32_16x16x32_bf16 v[148:151], a[212:215], v[64:67], v[148:151]
    ds_read2st64_b64 v[84:87], v5 offset0:124 offset1:125
    v_mul_f32 v23, v23, v231
    v_mfma_f32_16x16x32_bf16 v[148:151], a[220:223], v[68:71], v[148:151]
    v_rcp_f32 v20, v20
    v_mfma_f32_16x16x32_bf16 v[144:147], a[208:211], v[64:67], v[144:147]
    buffer_load_dwordx4 v2, s[8:11], s20 offen offset:3072 sc1 lds
    v_mfma_f32_16x16x32_bf16 v[144:147], a[216:219], v[68:71], v[144:147]
    v_exp_f32 v22, v22
    v_mfma_f32_16x16x32_bf16 v[132:135], a[84:87], v[64:67], v[132:135]
    ds_read2st64_b64 v[88:91], v5 offset0:66 offset1:67
    v_mul_f32 v228, v228, v20
    v_mfma_f32_16x16x32_bf16 v[132:135], a[92:95], v[68:71], v[132:135]
    v_rcp_f32 v21, v21
    v_mfma_f32_16x16x32_bf16 v[128:131], a[80:83], v[64:67], v[128:131]
    s_mul_i32 s39, s64, 20480
    s_mul_i32 s47, s26, 5120
    s_add_u32 s39, s39, s47
    s_add_u32 s39, s39, 81264640
    s_add_u32 m0, s47, 135680
    s_nop 0
    buffer_load_dwordx4 v7, s[8:11], s39 offen offset:0 sc1 lds
    v_mfma_f32_16x16x32_bf16 v[128:131], a[88:91], v[68:71], v[128:131]
    v_add_f32 v22, 1.0, v22
    s_waitcnt lgkmcnt(1)
    v_mfma_f32_16x16x32_bf16 v[128:131], a[96:99], v[72:75], v[128:131]
    ds_read2st64_b64 v[64:67], v5 offset0:70 offset1:71
    v_mul_f32 v229, v229, v21
    v_mfma_f32_16x16x32_bf16 v[128:131], a[104:107], v[76:79], v[128:131]
    v_exp_f32 v23, v23
    v_mfma_f32_16x16x32_bf16 v[132:135], a[100:103], v[72:75], v[132:135]
    buffer_load_dwordx4 v7, s[8:11], s39 offen offset:1024 sc1 lds
    v_mfma_f32_16x16x32_bf16 v[132:135], a[108:111], v[76:79], v[132:135]
    v_rcp_f32 v22, v22
    v_mfma_f32_16x16x32_bf16 v[144:147], a[224:227], v[72:75], v[144:147]
    ds_read2st64_b64 v[68:71], v5 offset0:74 offset1:75
    v_add_f32 v23, 1.0, v23
    v_mfma_f32_16x16x32_bf16 v[144:147], a[232:235], v[76:79], v[144:147]
    v_mul_f32 v230, v230, v22
    v_mul_f32 v16, v232, v232
    v_mfma_f32_16x16x32_bf16 v[148:151], a[228:231], v[72:75], v[148:151]
    buffer_load_dwordx4 v7, s[8:11], s39 offen offset:2048 sc1 lds
    v_mfma_f32_16x16x32_bf16 v[148:151], a[236:239], v[76:79], v[148:151]
    v_rcp_f32 v23, v23
    v_mfma_f32_16x16x32_bf16 v[148:151], a[244:247], v[80:83], v[148:151]
    ds_read2st64_b64 v[72:75], v5 offset0:78 offset1:79
    v_mul_f32 v231, v231, v23
    v_mfma_f32_16x16x32_bf16 v[148:151], a[252:255], v[84:87], v[148:151]
    v_fma_f32 v16, v16, v9, v8
    v_mul_f32 v17, v233, v233
    v_mfma_f32_16x16x32_bf16 v[144:147], a[240:243], v[80:83], v[144:147]
    buffer_load_dwordx4 v7, s[8:11], s39 offen offset:3072 sc1 lds
    v_mfma_f32_16x16x32_bf16 v[144:147], a[248:251], v[84:87], v[144:147]
    v_mul_f32 v16, v16, v232
    v_fma_f32 v17, v17, v9, v8
    v_mfma_f32_16x16x32_bf16 v[132:135], a[116:119], v[80:83], v[132:135]
    ds_read2st64_b64 v[76:79], v5 offset0:82 offset1:83
    v_mul_f32 v18, v234, v234
    v_mfma_f32_16x16x32_bf16 v[132:135], a[124:127], v[84:87], v[132:135]
    v_exp_f32 v16, v16
    v_mfma_f32_16x16x32_bf16 v[128:131], a[112:115], v[80:83], v[128:131]
    s_add_u32 s39, s39, 4096
    s_add_u32 m0, s47, 139776
    s_nop 0
    buffer_load_dwordx4 v7, s[8:11], s39 offen offset:0 sc1 lds
    v_mfma_f32_16x16x32_bf16 v[128:131], a[120:123], v[84:87], v[128:131]
    v_mul_f32 v17, v17, v233
    s_waitcnt lgkmcnt(1)
    v_mfma_f32_16x16x32_bf16 v[136:139], a[0:3], v[88:91], 0
    ds_read2st64_b64 v[80:83], v5 offset0:86 offset1:87
    v_fma_f32 v18, v18, v9, v8
    v_mfma_f32_16x16x32_bf16 v[136:139], a[8:11], v[64:67], v[136:139]
    v_mul_f32 v19, v235, v235
    v_add_f32 v16, 1.0, v16
    v_mfma_f32_16x16x32_bf16 v[140:143], a[4:7], v[88:91], 0
    s_lshl_b32 s39, s63, 3
    s_add_u32 s50, s26, 0
    s_add_u32 s38, s39, s50
    s_sub_u32 s38, s38, 1
    s_cmp_lt_u32 s38, 125
    s_cselect_b32 s42, 1.0, 0
    s_cselect_b32 s38, s38, s39
    s_add_u32 s38, s38, s37
    s_lshl_b32 s38, s38, 11
    s_add_u32 s38, s38, 41943040
    buffer_load_dwordx4 v[112:115], v7, s[8:11], s38 offen offset:0 sc1
    v_mfma_f32_16x16x32_bf16 v[140:143], a[12:15], v[64:67], v[140:143]
    v_exp_f32 v17, v17
    v_mfma_f32_16x16x32_bf16 v[152:155], a[128:131], v[88:91], 0
    ds_read2st64_b64 v[84:87], v5 offset0:90 offset1:91
    v_mul_f32 v18, v18, v234
    v_mfma_f32_16x16x32_bf16 v[152:155], a[136:139], v[64:67], v[152:155]
    v_fma_f32 v19, v19, v9, v8
    v_mul_f32 v20, v236, v236
    v_mfma_f32_16x16x32_bf16 v[156:159], a[132:135], v[88:91], 0
    buffer_load_dwordx4 v[116:119], v7, s[8:11], s38 offen offset:1024 sc1
    v_mfma_f32_16x16x32_bf16 v[156:159], a[140:143], v[64:67], v[156:159]
    v_rcp_f32 v16, v16
    v_mfma_f32_16x16x32_bf16 v[156:159], a[148:151], v[68:71], v[156:159]
    ds_read2st64_b64 v[88:91], v5 offset0:94 offset1:95
    v_add_f32 v17, 1.0, v17
    v_mfma_f32_16x16x32_bf16 v[156:159], a[156:159], v[72:75], v[156:159]
    v_exp_f32 v18, v18
    v_mfma_f32_16x16x32_bf16 v[152:155], a[144:147], v[68:71], v[152:155]
    s_lshl_b32 s39, s63, 3
    s_add_u32 s51, s26, 4
    s_add_u32 s38, s39, s51
    s_sub_u32 s38, s38, 1
    s_cmp_lt_u32 s38, 125
    s_cselect_b32 s43, 1.0, 0
    s_cselect_b32 s38, s38, s39
    s_add_u32 s38, s38, s37
    s_lshl_b32 s38, s38, 11
    s_add_u32 s38, s38, 41943040
    buffer_load_dwordx4 v[120:123], v7, s[8:11], s38 offen offset:0 sc1
    v_mfma_f32_16x16x32_bf16 v[152:155], a[152:155], v[72:75], v[152:155]
    v_mul_f32 v19, v19, v235
    v_fma_f32 v20, v20, v9, v8
    v_mfma_f32_16x16x32_bf16 v[140:143], a[20:23], v[68:71], v[140:143]
    ds_read2st64_b64 v[64:67], v5 offset0:98 offset1:99
    v_mul_f32 v21, v237, v237
    v_mfma_f32_16x16x32_bf16 v[140:143], a[28:31], v[72:75], v[140:143]
    v_mul_f32 v232, v232, v16
    v_add_f32 v18, 1.0, v18
    v_mfma_f32_16x16x32_bf16 v[136:139], a[16:19], v[68:71], v[136:139]
    buffer_load_dwordx4 v[124:127], v7, s[8:11], s38 offen offset:1024 sc1
    v_mfma_f32_16x16x32_bf16 v[136:139], a[24:27], v[72:75], v[136:139]
    v_mul_f32 v20, v20, v236
    s_waitcnt lgkmcnt(1)
    v_mfma_f32_16x16x32_bf16 v[136:139], a[32:35], v[76:79], v[136:139]
    ds_read2st64_b64 v[68:71], v5 offset0:102 offset1:103
    v_fma_f32 v21, v21, v9, v8
    v_mfma_f32_16x16x32_bf16 v[136:139], a[40:43], v[80:83], v[136:139]
    v_rcp_f32 v17, v17
    v_mfma_f32_16x16x32_bf16 v[140:143], a[36:39], v[76:79], v[140:143]
    s_lshl_b32 s39, s63, 3
    s_cmp_lt_u32 s26, 2
    s_cselect_b32 s38, 8, 4
    s_add_u32 s45, s26, s38
    s_add_u32 s38, s39, s45
    s_sub_u32 s38, s38, 1
    s_cmp_lt_u32 s38, 125
    s_cselect_b32 s49, 1.0, 0
    s_cselect_b32 s38, s38, s39
    s_add_u32 s38, s38, s37
    s_lshl_b32 s38, s38, 11
    s_add_u32 s38, s38, 41943040
    buffer_load_dwordx4 v[164:167], v7, s[8:11], s38 offen offset:0 sc1
    v_mfma_f32_16x16x32_bf16 v[140:143], a[44:47], v[80:83], v[140:143]
    v_exp_f32 v19, v19
    s_waitcnt vmcnt(15)
    s_barrier
    s_lshl_b32 s35, s72, 7
    s_add_u32 s35, s35, 80805888
    v_mov_b32 v14, s75
    buffer_store_dword v14, v10, s[8:11], s35 offen sc1
    v_mfma_f32_16x16x32_bf16 v[152:155], a[160:163], v[76:79], v[152:155]
    ds_read2st64_b64 v[72:75], v5 offset0:106 offset1:107
    v_mul_f32 v22, v238, v238
    v_mfma_f32_16x16x32_bf16 v[152:155], a[168:171], v[80:83], v[152:155]
    v_mul_f32 v233, v233, v17
    v_add_f32 v19, 1.0, v19
    v_mfma_f32_16x16x32_bf16 v[156:159], a[164:167], v[76:79], v[156:159]
    buffer_load_dwordx4 v[172:175], v7, s[8:11], s38 offen offset:1024 sc1
    v_mfma_f32_16x16x32_bf16 v[156:159], a[172:175], v[80:83], v[156:159]
    v_rcp_f32 v18, v18
    v_mfma_f32_16x16x32_bf16 v[156:159], a[180:183], v[84:87], v[156:159]
    ds_read2st64_b64 v[76:79], v5 offset0:110 offset1:111
    v_mul_f32 v21, v21, v237
    v_mfma_f32_16x16x32_bf16 v[156:159], a[188:191], v[88:91], v[156:159]
    v_exp_f32 v20, v20
    v_mfma_f32_16x16x32_bf16 v[152:155], a[176:179], v[84:87], v[152:155]
    s_and_b32 s46, s26, 1
    s_mul_i32 s38, s46, 9
    s_add_u32 s38, s38, s39
    s_sub_u32 s38, s38, 1
    s_cmp_lt_u32 s38, 125
    s_cselect_b32 s38, s38, s39
    s_add_u32 s38, s38, s37
    s_lshl_b32 s38, s38, 15
    s_lshr_b32 s47, s26, 1
    s_lshl1_add_u32 s47, s64, s47
    s_lshl_b32 s47, s47, 11
    s_add_u32 s38, s38, s47
    s_xor_b32 s47, s46, 1
    s_lshl_b32 s47, s47, 3
    s_add_u32 s38, s38, s47
    s_add_u32 s38, s38, 33554432
    buffer_load_dwordx2 v[28:29], v7, s[8:11], s38 offen offset:0 sc1
    v_mfma_f32_16x16x32_bf16 v[152:155], a[184:187], v[88:91], v[152:155]
    v_fma_f32 v22, v22, v9, v8
    v_mul_f32 v23, v239, v239
    v_mfma_f32_16x16x32_bf16 v[140:143], a[52:55], v[84:87], v[140:143]
    ds_read2st64_b64 v[80:83], v5 offset0:114 offset1:115
    v_mul_f32 v234, v234, v18
    v_mfma_f32_16x16x32_bf16 v[140:143], a[60:63], v[88:91], v[140:143]
    v_rcp_f32 v19, v19
    v_mfma_f32_16x16x32_bf16 v[136:139], a[48:51], v[84:87], v[136:139]
    buffer_load_dwordx2 v[30:31], v7, s[8:11], s38 offen offset:1024 sc1
    v_mfma_f32_16x16x32_bf16 v[136:139], a[56:59], v[88:91], v[136:139]
    v_add_f32 v20, 1.0, v20
    s_waitcnt lgkmcnt(1)
    v_mfma_f32_16x16x32_bf16 v[136:139], a[64:67], v[64:67], v[136:139]
    ds_read2st64_b64 v[84:87], v5 offset0:118 offset1:119
    v_mul_f32 v22, v22, v238
    v_mfma_f32_16x16x32_bf16 v[136:139], a[72:75], v[68:71], v[136:139]
    v_exp_f32 v21, v21
    v_mfma_f32_16x16x32_bf16 v[140:143], a[68:71], v[64:67], v[140:143]
    v_fma_f32 v23, v23, v9, v8
    v_mul_f32 v235, v235, v19
    v_mfma_f32_16x16x32_bf16 v[140:143], a[76:79], v[68:71], v[140:143]
    v_rcp_f32 v20, v20
    s_waitcnt vmcnt(26)
    s_barrier
    v_mfma_f32_16x16x32_bf16 v[152:155], a[192:195], v[64:67], v[152:155]
    ds_read2st64_b64 v[88:91], v5 offset0:122 offset1:123
    v_add_f32 v21, 1.0, v21
    v_mfma_f32_16x16x32_bf16 v[152:155], a[200:203], v[68:71], v[152:155]
    v_exp_f32 v22, v22
    v_mfma_f32_16x16x32_bf16 v[156:159], a[196:199], v[64:67], v[156:159]
    v_mul_f32 v23, v23, v239
    v_mul_f32 v236, v236, v20
    v_mfma_f32_16x16x32_bf16 v[156:159], a[204:207], v[68:71], v[156:159]
    v_rcp_f32 v21, v21
    v_mfma_f32_16x16x32_bf16 v[156:159], a[212:215], v[72:75], v[156:159]
    ds_read2st64_b64 v[64:67], v5 offset0:126 offset1:127
    v_add_f32 v22, 1.0, v22
    v_mfma_f32_16x16x32_bf16 v[156:159], a[220:223], v[76:79], v[156:159]
    v_exp_f32 v23, v23
    v_mfma_f32_16x16x32_bf16 v[152:155], a[208:211], v[72:75], v[152:155]
    s_add_u32 s20, s20, 32768
    s_add_u32 s22, s22, 32768
    s_mov_b32 m0, s22
    s_nop 0
    buffer_load_dwordx4 v1, s[8:11], s20 offen offset:0 sc1 lds
    v_mfma_f32_16x16x32_bf16 v[152:155], a[216:219], v[76:79], v[152:155]
    v_mul_f32 v237, v237, v21
    v_add_f32 v23, 1.0, v23
    v_mfma_f32_16x16x32_bf16 v[140:143], a[84:87], v[72:75], v[140:143]
    ds_read2st64_b64 v[68:71], v5 offset0:0 offset1:1
    v_mul_f32 v16, v240, v240
    v_mfma_f32_16x16x32_bf16 v[140:143], a[92:95], v[76:79], v[140:143]
    v_rcp_f32 v22, v22
    v_mfma_f32_16x16x32_bf16 v[136:139], a[80:83], v[72:75], v[136:139]
    buffer_load_dwordx4 v1, s[8:11], s20 offen offset:1024 sc1 lds
    v_mfma_f32_16x16x32_bf16 v[136:139], a[88:91], v[76:79], v[136:139]
    v_mul_f32 v238, v238, v22
    s_waitcnt lgkmcnt(1)
    v_mfma_f32_16x16x32_bf16 v[136:139], a[96:99], v[80:83], v[136:139]
    ds_read2st64_b64 v[72:75], v5 offset0:4 offset1:5
    v_fma_f32 v16, v16, v9, v8
    v_mfma_f32_16x16x32_bf16 v[136:139], a[104:107], v[84:87], v[136:139]
    v_rcp_f32 v23, v23
    v_mfma_f32_16x16x32_bf16 v[140:143], a[100:103], v[80:83], v[140:143]
    buffer_load_dwordx4 v1, s[8:11], s20 offen offset:2048 sc1 lds
    v_mfma_f32_16x16x32_bf16 v[140:143], a[108:111], v[84:87], v[140:143]
    v_mul_f32 v239, v239, v23
    v_mul_f32 v17, v241, v241
    v_mfma_f32_16x16x32_bf16 v[152:155], a[224:227], v[80:83], v[152:155]
    ds_read2st64_b64 v[76:79], v5 offset0:8 offset1:9
    v_mul_f32 v16, v16, v240
    v_mfma_f32_16x16x32_bf16 v[152:155], a[232:235], v[84:87], v[152:155]
    v_fma_f32 v17, v17, v9, v8
    v_mul_f32 v18, v242, v242
    v_mfma_f32_16x16x32_bf16 v[156:159], a[228:231], v[80:83], v[156:159]
    buffer_load_dwordx4 v1, s[8:11], s20 offen offset:3072 sc1 lds
    v_mfma_f32_16x16x32_bf16 v[156:159], a[236:239], v[84:87], v[156:159]
    v_exp_f32 v16, v16
    v_mfma_f32_16x16x32_bf16 v[156:159], a[244:247], v[88:91], v[156:159]
    ds_read2st64_b64 v[80:83], v5 offset0:12 offset1:13
    v_mul_f32 v17, v17, v241
    v_mfma_f32_16x16x32_bf16 v[156:159], a[252:255], v[64:67], v[156:159]
    v_fma_f32 v18, v18, v9, v8
    v_mul_f32 v19, v243, v243
    v_mfma_f32_16x16x32_bf16 v[152:155], a[240:243], v[88:91], v[152:155]
    s_add_u32 m0, s22, 4096
    s_nop 0
    buffer_load_dwordx4 v2, s[8:11], s20 offen offset:0 sc1 lds
    v_mfma_f32_16x16x32_bf16 v[152:155], a[248:251], v[64:67], v[152:155]
    v_add_f32 v16, 1.0, v16
    v_mul_f32 v18, v18, v242
    v_mfma_f32_16x16x32_bf16 v[140:143], a[116:119], v[88:91], v[140:143]
    ds_read2st64_b64 v[84:87], v5 offset0:16 offset1:17
    v_fma_f32 v19, v19, v9, v8
    v_mfma_f32_16x16x32_bf16 v[140:143], a[124:127], v[64:67], v[140:143]
    v_exp_f32 v17, v17
    v_mfma_f32_16x16x32_bf16 v[136:139], a[112:115], v[88:91], v[136:139]
    buffer_load_dwordx4 v2, s[8:11], s20 offen offset:1024 sc1 lds
    v_mfma_f32_16x16x32_bf16 v[136:139], a[120:123], v[64:67], v[136:139]
    v_mul_f32 v20, v244, v244
    s_waitcnt lgkmcnt(1)
    v_mfma_f32_16x16x32_bf16 v[32:35], a[0:3], v[68:71], 0
    ds_read2st64_b64 v[88:91], v5 offset0:20 offset1:21
    v_add_f32 v17, 1.0, v17
    v_mfma_f32_16x16x32_bf16 v[32:35], a[8:11], v[72:75], v[32:35]
    v_rcp_f32 v16, v16
    v_mfma_f32_16x16x32_bf16 v[36:39], a[4:7], v[68:71], 0
    buffer_load_dwordx4 v2, s[8:11], s20 offen offset:2048 sc1 lds
    v_mfma_f32_16x16x32_bf16 v[36:39], a[12:15], v[72:75], v[36:39]
    v_exp_f32 v18, v18
    v_mfma_f32_16x16x32_bf16 v[48:51], a[128:131], v[68:71], 0
    ds_read2st64_b64 v[64:67], v5 offset0:24 offset1:25
    v_mul_f32 v19, v19, v243
    v_mfma_f32_16x16x32_bf16 v[48:51], a[136:139], v[72:75], v[48:51]
    v_fma_f32 v20, v20, v9, v8
    v_mul_f32 v21, v245, v245
    v_mfma_f32_16x16x32_bf16 v[52:55], a[132:135], v[68:71], 0
    buffer_load_dwordx4 v2, s[8:11], s20 offen offset:3072 sc1 lds
    s_add_u32 s20, s20, 32768
    v_mfma_f32_16x16x32_bf16 v[52:55], a[140:143], v[72:75], v[52:55]
    v_cvt_pk_bf16_f32 v144, v144, v145
    v_cvt_pk_bf16_f32 v145, v146, v147
    v_mfma_f32_16x16x32_bf16 v[52:55], a[148:151], v[76:79], v[52:55]
    ds_read2st64_b64 v[68:71], v5 offset0:28 offset1:29
    v_cvt_pk_bf16_f32 v146, v148, v149
    v_mfma_f32_16x16x32_bf16 v[52:55], a[156:159], v[80:83], v[52:55]
    v_cvt_pk_bf16_f32 v147, v150, v151
    v_cvt_pk_bf16_f32 v152, v152, v153
    v_mfma_f32_16x16x32_bf16 v[48:51], a[144:147], v[76:79], v[48:51]
    buffer_store_dwordx4 v[144:147], v4, s[8:11], s53 offen offset:0 sc1
    v_mfma_f32_16x16x32_bf16 v[48:51], a[152:155], v[80:83], v[48:51]
    v_cvt_pk_bf16_f32 v153, v154, v155
    v_cvt_pk_bf16_f32 v154, v156, v157
    s_lshr_b32 s63, s6, 1
    s_lshr_b32 s55, s32, 1
    s_mov_b32 s44, 0x3b000000
    v_and_b32 v11, 7, v0
    v_lshlrev_b32 v11, 7, v11
    s_lshl_b32 s48, s55, 10
    s_add_u32 s48, s48, 80805888
    buffer_load_dword v27, v11, s[8:11], s48 offen sc1
    v_mfma_f32_16x16x32_bf16 v[36:39], a[20:23], v[76:79], v[36:39]
    ds_read2st64_b64 v[72:75], v5 offset0:32 offset1:33
    v_cvt_pk_bf16_f32 v155, v158, v159
    v_mfma_f32_16x16x32_bf16 v[36:39], a[28:31], v[80:83], v[36:39]
    buffer_store_dwordx4 v[152:155], v4, s[8:11], s53 offen offset:1024 sc1
    v_mfma_f32_16x16x32_bf16 v[32:35], a[16:19], v[76:79], v[32:35]
    v_cvt_pk_bf16_f32 v128, v128, v129
    v_cvt_pk_bf16_f32 v129, v130, v131
    v_mfma_f32_16x16x32_bf16 v[32:35], a[24:27], v[80:83], v[32:35]
    v_cvt_pk_bf16_f32 v130, v132, v133
    s_waitcnt lgkmcnt(1)
    v_mfma_f32_16x16x32_bf16 v[32:35], a[32:35], v[84:87], v[32:35]
    ds_read2st64_b64 v[76:79], v5 offset0:36 offset1:37
    v_cvt_pk_bf16_f32 v131, v134, v135
    v_mfma_f32_16x16x32_bf16 v[32:35], a[40:43], v[88:91], v[32:35]
    buffer_store_dwordx4 v[128:131], v3, s[8:11], s52 offen offset:0 sc1
    v_mfma_f32_16x16x32_bf16 v[36:39], a[36:39], v[84:87], v[36:39]
    v_cvt_pk_bf16_f32 v136, v136, v137
    v_cvt_pk_bf16_f32 v137, v138, v139
    v_mfma_f32_16x16x32_bf16 v[36:39], a[44:47], v[88:91], v[36:39]
    v_cvt_pk_bf16_f32 v138, v140, v141
    v_cvt_pk_bf16_f32 v139, v142, v143
    v_mfma_f32_16x16x32_bf16 v[48:51], a[160:163], v[84:87], v[48:51]
    ds_read2st64_b64 v[80:83], v5 offset0:40 offset1:41
    v_mul_f32 v240, v240, v16
    v_mfma_f32_16x16x32_bf16 v[48:51], a[168:171], v[88:91], v[48:51]
    buffer_store_dwordx4 v[136:139], v3, s[8:11], s52 offen offset:1024 sc1
    v_mfma_f32_16x16x32_bf16 v[52:55], a[164:167], v[84:87], v[52:55]
    v_rcp_f32 v17, v17
    v_mfma_f32_16x16x32_bf16 v[52:55], a[172:175], v[88:91], v[52:55]
    v_add_f32 v18, 1.0, v18
    v_mul_f32 v20, v20, v244
    v_mfma_f32_16x16x32_bf16 v[52:55], a[180:183], v[64:67], v[52:55]
    ds_read2st64_b64 v[84:87], v5 offset0:44 offset1:45
    v_fma_f32 v21, v21, v9, v8
    v_mfma_f32_16x16x32_bf16 v[52:55], a[188:191], v[68:71], v[52:55]
    v_exp_f32 v19, v19
    v_mfma_f32_16x16x32_bf16 v[48:51], a[176:179], v[64:67], v[48:51]
    v_mul_f32 v22, v246, v246
    v_mul_f32 v241, v241, v17
    v_mfma_f32_16x16x32_bf16 v[48:51], a[184:187], v[68:71], v[48:51]
    v_rcp_f32 v18, v18
    v_mfma_f32_16x16x32_bf16 v[36:39], a[52:55], v[64:67], v[36:39]
    ds_read2st64_b64 v[88:91], v5 offset0:48 offset1:49
    v_add_f32 v19, 1.0, v19
    v_mfma_f32_16x16x32_bf16 v[36:39], a[60:63], v[68:71], v[36:39]
    v_exp_f32 v20, v20
    v_mfma_f32_16x16x32_bf16 v[32:35], a[48:51], v[64:67], v[32:35]
    v_mul_f32 v21, v21, v245
    v_fma_f32 v22, v22, v9, v8
    v_mfma_f32_16x16x32_bf16 v[32:35], a[56:59], v[68:71], v[32:35]
    v_mul_f32 v23, v247, v247
    s_waitcnt lgkmcnt(1)
    v_mfma_f32_16x16x32_bf16 v[32:35], a[64:67], v[72:75], v[32:35]
    ds_read2st64_b64 v[64:67], v5 offset0:52 offset1:53
    v_mul_f32 v242, v242, v18
    v_mfma_f32_16x16x32_bf16 v[32:35], a[72:75], v[76:79], v[32:35]
    v_rcp_f32 v19, v19
    v_mfma_f32_16x16x32_bf16 v[36:39], a[68:71], v[72:75], v[36:39]
    v_add_f32 v20, 1.0, v20
    v_mul_f32 v22, v22, v246
    v_mfma_f32_16x16x32_bf16 v[36:39], a[76:79], v[76:79], v[36:39]
    v_exp_f32 v21, v21
    v_mfma_f32_16x16x32_bf16 v[48:51], a[192:195], v[72:75], v[48:51]
    ds_read2st64_b64 v[68:71], v5 offset0:56 offset1:57
    v_fma_f32 v23, v23, v9, v8
    v_mfma_f32_16x16x32_bf16 v[48:51], a[200:203], v[76:79], v[48:51]
    v_mul_f32 v243, v243, v19
    v_add_f32 v21, 1.0, v21
    v_mfma_f32_16x16x32_bf16 v[52:55], a[196:199], v[72:75], v[52:55]
    v_rcp_f32 v20, v20
    v_mfma_f32_16x16x32_bf16 v[52:55], a[204:207], v[76:79], v[52:55]
    v_exp_f32 v22, v22
    v_mfma_f32_16x16x32_bf16 v[52:55], a[212:215], v[80:83], v[52:55]
    ds_read2st64_b64 v[72:75], v5 offset0:60 offset1:61
    v_mul_f32 v23, v23, v247
    v_mfma_f32_16x16x32_bf16 v[52:55], a[220:223], v[84:87], v[52:55]
    v_mul_f32 v244, v244, v20
    v_add_f32 v22, 1.0, v22
    v_mfma_f32_16x16x32_bf16 v[48:51], a[208:211], v[80:83], v[48:51]
    v_rcp_f32 v21, v21
    v_mfma_f32_16x16x32_bf16 v[48:51], a[216:219], v[84:87], v[48:51]
    v_exp_f32 v23, v23
    v_mfma_f32_16x16x32_bf16 v[36:39], a[84:87], v[80:83], v[36:39]
    ds_read2st64_b64 v[76:79], v5 offset0:2 offset1:3
    v_mul_f32 v245, v245, v21
    v_mfma_f32_16x16x32_bf16 v[36:39], a[92:95], v[84:87], v[36:39]
    v_rcp_f32 v22, v22
    v_mfma_f32_16x16x32_bf16 v[32:35], a[80:83], v[80:83], v[32:35]
    v_add_f32 v23, 1.0, v23
    v_mul_f32 v246, v246, v22
    v_mfma_f32_16x16x32_bf16 v[32:35], a[88:91], v[84:87], v[32:35]
    v_mul_f32 v16, v248, v248
    s_waitcnt lgkmcnt(1)
    v_mfma_f32_16x16x32_bf16 v[32:35], a[96:99], v[88:91], v[32:35]
    ds_read2st64_b64 v[80:83], v5 offset0:6 offset1:7
    v_fma_f32 v16, v16, v9, v8
    v_mfma_f32_16x16x32_bf16 v[32:35], a[104:107], v[64:67], v[32:35]
    v_rcp_f32 v23, v23
    v_mfma_f32_16x16x32_bf16 v[36:39], a[100:103], v[88:91], v[36:39]
    v_mul_f32 v247, v247, v23
    v_mul_f32 v17, v249, v249
    v_mfma_f32_16x16x32_bf16 v[36:39], a[108:111], v[64:67], v[36:39]
    v_mul_f32 v16, v16, v248
    v_fma_f32 v17, v17, v9, v8
    v_mfma_f32_16x16x32_bf16 v[48:51], a[224:227], v[88:91], v[48:51]
    ds_read2st64_b64 v[84:87], v5 offset0:10 offset1:11
    v_mul_f32 v18, v250, v250
    v_mfma_f32_16x16x32_bf16 v[48:51], a[232:235], v[64:67], v[48:51]
    v_exp_f32 v16, v16
    v_mfma_f32_16x16x32_bf16 v[52:55], a[228:231], v[88:91], v[52:55]
    v_mul_f32 v17, v17, v249
    v_fma_f32 v18, v18, v9, v8
    v_mfma_f32_16x16x32_bf16 v[52:55], a[236:239], v[64:67], v[52:55]
    v_mul_f32 v19, v251, v251
    v_add_f32 v16, 1.0, v16
    v_mfma_f32_16x16x32_bf16 v[52:55], a[244:247], v[68:71], v[52:55]
    ds_read2st64_b64 v[88:91], v5 offset0:14 offset1:15
    v_mul_f32 v18, v18, v250
    v_mfma_f32_16x16x32_bf16 v[52:55], a[252:255], v[72:75], v[52:55]
    v_exp_f32 v17, v17
    v_mfma_f32_16x16x32_bf16 v[48:51], a[240:243], v[68:71], v[48:51]
    v_fma_f32 v19, v19, v9, v8
    v_mul_f32 v20, v252, v252
    v_mfma_f32_16x16x32_bf16 v[48:51], a[248:251], v[72:75], v[48:51]
    v_rcp_f32 v16, v16
    v_mfma_f32_16x16x32_bf16 v[36:39], a[116:119], v[68:71], v[36:39]
    ds_read2st64_b64 v[64:67], v5 offset0:18 offset1:19
    v_add_f32 v17, 1.0, v17
    v_mfma_f32_16x16x32_bf16 v[36:39], a[124:127], v[72:75], v[36:39]
    v_exp_f32 v18, v18
    v_mfma_f32_16x16x32_bf16 v[32:35], a[112:115], v[68:71], v[32:35]
    v_mul_f32 v19, v19, v251
    v_fma_f32 v20, v20, v9, v8
    v_mfma_f32_16x16x32_bf16 v[32:35], a[120:123], v[72:75], v[32:35]
    v_mul_f32 v21, v253, v253
    s_waitcnt lgkmcnt(1)
    v_mfma_f32_16x16x32_bf16 v[40:43], a[0:3], v[76:79], 0
    ds_read2st64_b64 v[68:71], v5 offset0:22 offset1:23
    v_mul_f32 v248, v248, v16
    v_mfma_f32_16x16x32_bf16 v[40:43], a[8:11], v[80:83], v[40:43]
    v_rcp_f32 v17, v17
    v_mfma_f32_16x16x32_bf16 v[44:47], a[4:7], v[76:79], 0
    v_add_f32 v18, 1.0, v18
    v_mul_f32 v20, v20, v252
    v_mfma_f32_16x16x32_bf16 v[44:47], a[12:15], v[80:83], v[44:47]
    v_exp_f32 v19, v19
    v_mfma_f32_16x16x32_bf16 v[56:59], a[128:131], v[76:79], 0
    ds_read2st64_b64 v[72:75], v5 offset0:26 offset1:27
    v_fma_f32 v21, v21, v9, v8
    v_mfma_f32_16x16x32_bf16 v[56:59], a[136:139], v[80:83], v[56:59]
    v_mul_f32 v22, v254, v254
    v_mul_f32 v249, v249, v17
    v_mfma_f32_16x16x32_bf16 v[60:63], a[132:135], v[76:79], 0
    v_rcp_f32 v18, v18
    v_mfma_f32_16x16x32_bf16 v[60:63], a[140:143], v[80:83], v[60:63]
    v_add_f32 v19, 1.0, v19
    v_mul_f32 v21, v21, v253
    s_waitcnt vmcnt(3)
    v_cmp_ne_u32 vcc, s75, v27
    s_cbranch_vccnz L_fqs
L_fqk:
    s_mov_b32 s76, s40
    s_mov_b32 s77, s41
    s_cmp_eq_u32 s31, 0
    s_cselect_b32 s78, 117440512, 0
    v_mfma_f32_16x16x32_bf16 v[60:63], a[148:151], v[84:87], v[60:63]
    ds_read2st64_b64 v[76:79], v5 offset0:30 offset1:31
    v_fma_f32 v22, v22, v9, v8
    v_mfma_f32_16x16x32_bf16 v[60:63], a[156:159], v[88:91], v[60:63]
    v_exp_f32 v20, v20
    v_mfma_f32_16x16x32_bf16 v[56:59], a[144:147], v[84:87], v[56:59]
    s_lshl_b32 s39, s27, 15
    s_add_u32 s39, s39, 16777216
    buffer_load_dwordx4 a[0:3], v7, s[76:79], s39 offen offset:0 sc1
    v_mfma_f32_16x16x32_bf16 v[56:59], a[152:155], v[88:91], v[56:59]
    v_mul_f32 v23, v255, v255
    v_mul_f32 v250, v250, v18
    v_mfma_f32_16x16x32_bf16 v[44:47], a[20:23], v[84:87], v[44:47]
    ds_read2st64_b64 v[80:83], v5 offset0:34 offset1:35
    v_add_f32 v20, 1.0, v20
    v_mfma_f32_16x16x32_bf16 v[44:47], a[28:31], v[88:91], v[44:47]
    v_rcp_f32 v19, v19
    v_mfma_f32_16x16x32_bf16 v[40:43], a[16:19], v[84:87], v[40:43]
    buffer_load_dwordx4 a[4:7], v7, s[76:79], s39 offen offset:1024 sc1
    v_mfma_f32_16x16x32_bf16 v[40:43], a[24:27], v[88:91], v[40:43]
    v_mul_f32 v22, v22, v254
    s_waitcnt lgkmcnt(1)
    v_mfma_f32_16x16x32_bf16 v[40:43], a[32:35], v[64:67], v[40:43]
    ds_read2st64_b64 v[84:87], v5 offset0:38 offset1:39
    v_fma_f32 v23, v23, v9, v8
    v_mfma_f32_16x16x32_bf16 v[40:43], a[40:43], v[68:71], v[40:43]
    v_exp_f32 v21, v21
    v_mfma_f32_16x16x32_bf16 v[44:47], a[36:39], v[64:67], v[44:47]
    buffer_load_dwordx4 a[8:11], v7, s[76:79], s39 offen offset:2048 sc1
    v_mfma_f32_16x16x32_bf16 v[44:47], a[44:47], v[68:71], v[44:47]
    v_mul_f32 v251, v251, v19
    v_add_f32 v21, 1.0, v21
    v_mfma_f32_16x16x32_bf16 v[56:59], a[160:163], v[64:67], v[56:59]
    ds_read2st64_b64 v[88:91], v5 offset0:42 offset1:43
    v_mul_f32 v23, v23, v255
    v_mfma_f32_16x16x32_bf16 v[56:59], a[168:171], v[68:71], v[56:59]
    v_rcp_f32 v20, v20
    v_mfma_f32_16x16x32_bf16 v[60:63], a[164:167], v[64:67], v[60:63]
    buffer_load_dwordx4 a[12:15], v7, s[76:79], s39 offen offset:3072 sc1
    v_mfma_f32_16x16x32_bf16 v[60:63], a[172:175], v[68:71], v[60:63]
    v_exp_f32 v22, v22
    v_mfma_f32_16x16x32_bf16 v[60:63], a[180:183], v[72:75], v[60:63]
    ds_read2st64_b64 v[64:67], v5 offset0:46 offset1:47
    v_mul_f32 v252, v252, v20
    v_mfma_f32_16x16x32_bf16 v[60:63], a[188:191], v[76:79], v[60:63]
    v_rcp_f32 v21, v21
    v_mfma_f32_16x16x32_bf16 v[56:59], a[176:179], v[72:75], v[56:59]
    s_add_u32 s39, s39, 4096
    buffer_load_dwordx4 a[16:19], v7, s[76:79], s39 offen offset:0 sc1
    v_mfma_f32_16x16x32_bf16 v[56:59], a[184:187], v[76:79], v[56:59]
    v_add_f32 v22, 1.0, v22
    v_mul_f32 v253, v253, v21
    v_mfma_f32_16x16x32_bf16 v[44:47], a[52:55], v[72:75], v[44:47]
    ds_read2st64_b64 v[68:71], v5 offset0:50 offset1:51
    v_mfma_f32_16x16x32_bf16 v[44:47], a[60:63], v[76:79], v[44:47]
    v_exp_f32 v23, v23
    v_mfma_f32_16x16x32_bf16 v[40:43], a[48:51], v[72:75], v[40:43]
    buffer_load_dwordx4 a[20:23], v7, s[76:79], s39 offen offset:1024 sc1
    v_mfma_f32_16x16x32_bf16 v[40:43], a[56:59], v[76:79], v[40:43]
    v_add_f32 v23, 1.0, v23
    s_waitcnt lgkmcnt(1)
    v_mfma_f32_16x16x32_bf16 v[40:43], a[64:67], v[80:83], v[40:43]
    ds_read2st64_b64 v[72:75], v5 offset0:54 offset1:55
    v_mfma_f32_16x16x32_bf16 v[40:43], a[72:75], v[84:87], v[40:43]
    v_rcp_f32 v22, v22
    v_mfma_f32_16x16x32_bf16 v[44:47], a[68:71], v[80:83], v[44:47]
    buffer_load_dwordx4 a[24:27], v7, s[76:79], s39 offen offset:2048 sc1
    v_mfma_f32_16x16x32_bf16 v[44:47], a[76:79], v[84:87], v[44:47]
    v_mul_f32 v254, v254, v22
    v_mfma_f32_16x16x32_bf16 v[56:59], a[192:195], v[80:83], v[56:59]
    ds_read2st64_b64 v[76:79], v5 offset0:58 offset1:59
    v_mfma_f32_16x16x32_bf16 v[56:59], a[200:203], v[84:87], v[56:59]
    v_rcp_f32 v23, v23
    v_mfma_f32_16x16x32_bf16 v[60:63], a[196:199], v[80:83], v[60:63]
    buffer_load_dwordx4 a[28:31], v7, s[76:79], s39 offen offset:3072 sc1
    v_mfma_f32_16x16x32_bf16 v[60:63], a[204:207], v[84:87], v[60:63]
    v_mul_f32 v255, v255, v23
    v_mfma_f32_16x16x32_bf16 v[60:63], a[212:215], v[88:91], v[60:63]
    ds_read2st64_b64 v[80:83], v5 offset0:62 offset1:63
    v_mfma_f32_16x16x32_bf16 v[60:63], a[220:223], v[64:67], v[60:63]
    v_mfma_f32_16x16x32_bf16 v[56:59], a[208:211], v[88:91], v[56:59]
    s_add_u32 s39, s39, 4096
    buffer_load_dwordx4 a[32:35], v7, s[76:79], s39 offen offset:0 sc1
    v_mfma_f32_16x16x32_bf16 v[56:59], a[216:219], v[64:67], v[56:59]
    v_mfma_f32_16x16x32_bf16 v[44:47], a[84:87], v[88:91], v[44:47]
    v_mfma_f32_16x16x32_bf16 v[44:47], a[92:95], v[64:67], v[44:47]
    v_mfma_f32_16x16x32_bf16 v[40:43], a[80:83], v[88:91], v[40:43]
    buffer_load_dwordx4 a[36:39], v7, s[76:79], s39 offen offset:1024 sc1
    v_mfma_f32_16x16x32_bf16 v[40:43], a[88:91], v[64:67], v[40:43]
    s_waitcnt lgkmcnt(0)
    v_mfma_f32_16x16x32_bf16 v[40:43], a[96:99], v[68:71], v[40:43]
    v_mfma_f32_16x16x32_bf16 v[40:43], a[104:107], v[72:75], v[40:43]
    v_mfma_f32_16x16x32_bf16 v[44:47], a[100:103], v[68:71], v[44:47]
    buffer_load_dwordx4 a[40:43], v7, s[76:79], s39 offen offset:2048 sc1
    v_mfma_f32_16x16x32_bf16 v[44:47], a[108:111], v[72:75], v[44:47]
    v_mfma_f32_16x16x32_bf16 v[56:59], a[224:227], v[68:71], v[56:59]
    v_mfma_f32_16x16x32_bf16 v[56:59], a[232:235], v[72:75], v[56:59]
    v_mfma_f32_16x16x32_bf16 v[60:63], a[228:231], v[68:71], v[60:63]
    buffer_load_dwordx4 a[44:47], v7, s[76:79], s39 offen offset:3072 sc1
    v_mfma_f32_16x16x32_bf16 v[60:63], a[236:239], v[72:75], v[60:63]
    v_mfma_f32_16x16x32_bf16 v[60:63], a[244:247], v[76:79], v[60:63]
    v_mfma_f32_16x16x32_bf16 v[60:63], a[252:255], v[80:83], v[60:63]
    v_mfma_f32_16x16x32_bf16 v[56:59], a[240:243], v[76:79], v[56:59]
    s_add_u32 s39, s39, 4096
    buffer_load_dwordx4 a[48:51], v7, s[76:79], s39 offen offset:0 sc1
    v_mfma_f32_16x16x32_bf16 v[56:59], a[248:251], v[80:83], v[56:59]
    v_mfma_f32_16x16x32_bf16 v[44:47], a[116:119], v[76:79], v[44:47]
    v_mfma_f32_16x16x32_bf16 v[44:47], a[124:127], v[80:83], v[44:47]
    v_mfma_f32_16x16x32_bf16 v[40:43], a[112:115], v[76:79], v[40:43]
    buffer_load_dwordx4 a[52:55], v7, s[76:79], s39 offen offset:1024 sc1
    v_mfma_f32_16x16x32_bf16 v[40:43], a[120:123], v[80:83], v[40:43]
    s_nop 7
    v_cvt_pk_bf16_f32 v48, v48, v49
    v_cvt_pk_bf16_f32 v49, v50, v51
    v_cvt_pk_bf16_f32 v50, v52, v53
    v_cvt_pk_bf16_f32 v51, v54, v55
    buffer_store_dwordx4 v[48:51], v4, s[8:11], s53 offen offset:2048 sc1
    v_cvt_pk_bf16_f32 v56, v56, v57
    v_cvt_pk_bf16_f32 v57, v58, v59
    v_cvt_pk_bf16_f32 v58, v60, v61
    v_cvt_pk_bf16_f32 v59, v62, v63
    buffer_store_dwordx4 v[56:59], v4, s[8:11], s53 offen offset:3072 sc1
    v_cvt_pk_bf16_f32 v32, v32, v33
    v_cvt_pk_bf16_f32 v33, v34, v35
    v_cvt_pk_bf16_f32 v34, v36, v37
    v_cvt_pk_bf16_f32 v35, v38, v39
    buffer_store_dwordx4 v[32:35], v3, s[8:11], s52 offen offset:2048 sc1
    v_cvt_pk_bf16_f32 v40, v40, v41
    v_cvt_pk_bf16_f32 v41, v42, v43
    v_cvt_pk_bf16_f32 v42, v44, v45
    v_cvt_pk_bf16_f32 v43, v46, v47
    buffer_store_dwordx4 v[40:43], v3, s[8:11], s52 offen offset:3072 sc1
    buffer_load_dwordx4 a[56:59], v7, s[76:79], s39 offen offset:2048 sc1
    buffer_load_dwordx4 a[60:63], v7, s[76:79], s39 offen offset:3072 sc1
    s_add_u32 s39, s39, 4096
    buffer_load_dwordx4 a[64:67], v7, s[76:79], s39 offen offset:0 sc1
    buffer_load_dwordx4 a[68:71], v7, s[76:79], s39 offen offset:1024 sc1
    s_waitcnt vmcnt(35)
    v_add_f32 v112, v112, v116
    v_add_f32 v113, v113, v117
    v_add_f32 v114, v114, v118
    v_add_f32 v115, v115, v119
    v_add_f32 v120, v120, v124
    v_add_f32 v121, v121, v125
    v_add_f32 v122, v122, v126
    v_add_f32 v123, v123, v127
    v_add_f32 v164, v164, v172
    v_add_f32 v165, v165, v173
    v_add_f32 v166, v166, v174
    v_add_f32 v167, v167, v175
    v_lshrrev_b32 v13, 5, v0
    v_bfe_u32 v14, v0, 4, 1
    v_permlane32_swap_b32 v112, v113
    v_permlane32_swap_b32 v114, v115
    v_permlane32_swap_b32 v120, v121
    v_permlane32_swap_b32 v122, v123
    v_permlane32_swap_b32 v164, v165
    v_permlane32_swap_b32 v166, v167
    v_add_f32 v112, v112, v113
    v_add_f32 v114, v114, v115
    v_add_f32 v120, v120, v121
    v_add_f32 v122, v122, v123
    v_add_f32 v164, v164, v165
    v_add_f32 v166, v166, v167
    v_lshl_add_u32 v13, v14, 1, v13
    v_and_b32 v14, 7, v0
    v_permlane16_swap_b32 v112, v114
    v_permlane16_swap_b32 v120, v122
    v_permlane16_swap_b32 v164, v166
    v_add_f32 v112, v112, v114
    v_add_f32 v120, v120, v122
    v_add_f32 v164, v164, v166
    v_lshlrev_b32 v13, 2, v13
    v_lshl_add_u32 v13, v14, 4, v13
    v_mov_b32_dpp v113, v112 row_ror:8 row_mask:0xf bank_mask:0xf
    v_mov_b32_dpp v121, v120 row_ror:8 row_mask:0xf bank_mask:0xf
    v_mov_b32_dpp v165, v164 row_ror:8 row_mask:0xf bank_mask:0xf
    v_mul_f32 v112, 0x3b000000, v112
    v_mul_f32 v120, 0x3b000000, v120
    buffer_load_dwordx4 a[72:75], v7, s[76:79], s39 offen offset:2048 sc1
    v_mul_f32 v164, 0x3b000000, v164
    v_mul_f32 v114, v112, v112
    v_mul_f32 v122, v120, v120
    v_mul_f32 v166, v164, v164
    v_fma_f32 v113, v113, s44, -v114
    v_fma_f32 v121, v121, s44, -v122
    v_fma_f32 v165, v165, s44, -v166
    v_max_f32 v113, 0, v113
    v_max_f32 v121, 0, v121
    v_max_f32 v165, 0, v165
    v_add_f32 v113, 0x3727c5ac, v113
    v_add_f32 v121, 0x3727c5ac, v121
    v_add_f32 v165, 0x3727c5ac, v165
    v_rsq_f32 v113, v113
    buffer_load_dwordx4 a[76:79], v7, s[76:79], s39 offen offset:3072 sc1
    v_rsq_f32 v121, v121
    v_rsq_f32 v165, v165
    s_lshl_b32 s29, s50, 8
    s_add_u32 s29, s29, 156160
    v_add_u32 v115, s29, v13
    s_lshl_b32 s29, s51, 8
    s_add_u32 s29, s29, 156160
    v_add_u32 v123, s29, v13
    s_lshl_b32 s29, s45, 8
    s_add_u32 s29, s29, 156160
    v_add_u32 v167, s29, v13
    v_mul_f32 v113, s42, v113
    v_mul_f32 v121, s43, v121
    v_mul_f32 v165, s49, v165
    v_mul_f32 v112, -v112, v113
    v_mul_f32 v120, -v120, v121
    v_mul_f32 v164, -v164, v165
    s_mov_b32 exec_lo, 0x00ff00ff
    s_mov_b32 exec_hi, 0x00ff00ff
    ds_write_b32 v115, v113
    ds_write_b32 v115, v112 offset:128
    ds_write_b32 v123, v121
    ds_write_b32 v123, v120 offset:128
    ds_write_b32 v167, v165
    ds_write_b32 v167, v164 offset:128
    s_mov_b64 exec, -1
    v_and_b32 v13, 15, v0
    v_lshrrev_b32 v14, 4, v0
    v_mul_u32_u24 v8, 584, v13
    v_lshl_add_u32 v8, v14, 3, v8
    s_lshl_b32 s29, s26, 7
    s_add_u32 s29, s29, 98304
    v_add_u32 v5, s29, v8
    s_lshr_b32 s35, s26, 1
    s_mul_i32 s35, s35, 18688
    s_mul_i32 s38, s46, 544
    s_add_u32 s35, s35, s38
    s_add_u32 s35, s35, 98304
    v_add_u32 v8, s35, v8
    v_lshlrev_b32 v9, 4, v14
    s_lshl_b32 s35, s26, 9
    s_add_u32 s35, s35, 156416
    v_add_u32 v6, s35, v9
    s_mul_i32 s35, s46, 2240
    s_add_u32 s35, s35, 156224
    v_add_u32 v9, s35, v9
    v_lshrrev_b32 v12, 2, v0
    v_and_b32 v13, 3, v0
    v_mul_u32_u24 v11, 584, v12
    v_lshl_add_u32 v11, v13, 5, v11
    v_add_u32 v11, s29, v11
    v_and_b32 v12, 3, v12
    v_lshl_add_u32 v12, v14, 3, v12
    v_mul_u32_u24 v12, 144, v12
    s_mul_i32 s35, s26, 4608
    s_add_u32 s35, s35, 135680
    v_add_u32 v12, s35, v12
    v_lshl_add_u32 v15, v13, 3, v12
    v_lshl_add_u32 v12, v13, 5, v12
    s_waitcnt lgkmcnt(0)
    s_barrier
    v_add_u32 v13, 135680, v7
    ds_read_b128 v[112:115], v9 offset:0
    ds_read_b128 v[116:119], v9 offset:128
    ds_read_b128 v[120:123], v6 offset:0
    ds_read_b128 v[124:127], v6 offset:128
    s_waitcnt lgkmcnt(2)
    ds_read_b128 v[64:67], v13 offset:0
    ds_read_b128 v[68:71], v13 offset:1024
    ds_read_b128 v[72:75], v13 offset:2048
    ds_read_b128 v[76:79], v13 offset:3072
    v_lshlrev_b32 v56, 16, v28
    v_and_b32 v57, 0xffff0000, v28
    v_lshlrev_b32 v58, 16, v29
    v_and_b32 v59, 0xffff0000, v29
    v_lshlrev_b32 v60, 16, v30
    v_and_b32 v61, 0xffff0000, v30
    s_add_u32 s39, s39, 4096
    buffer_load_dwordx4 a[80:83], v7, s[76:79], s39 offen offset:0 sc1
    v_lshlrev_b32 v62, 16, v31
    v_and_b32 v63, 0xffff0000, v31
    v_pk_fma_f32 v[56:57], v[56:57], v[112:113], v[116:117]
    v_pk_fma_f32 v[58:59], v[58:59], v[114:115], v[118:119]
    v_pk_fma_f32 v[60:61], v[60:61], v[112:113], v[116:117]
    v_pk_fma_f32 v[62:63], v[62:63], v[114:115], v[118:119]
    v_cvt_pk_bf16_f32 v28, v56, v57
    v_cvt_pk_bf16_f32 v29, v58, v59
    ds_write_b64 v8, v[28:29] offset:0
    v_cvt_pk_bf16_f32 v30, v60, v61
    v_cvt_pk_bf16_f32 v31, v62, v63
    ds_write_b64 v8, v[30:31] offset:9344
    ds_read_b128 v[112:115], v6 offset:64
    ds_read_b128 v[116:119], v6 offset:192
    s_waitcnt lgkmcnt(8)
    ds_read_b128 v[80:83], v13 offset:4096
    ds_read_b128 v[84:87], v13 offset:5120
    ds_read_b128 v[88:91], v13 offset:6144
    ds_read_b128 v[92:95], v13 offset:7168
    v_lshlrev_b32 v56, 16, v96
    v_and_b32 v57, 0xffff0000, v96
    v_lshlrev_b32 v58, 16, v97
    v_and_b32 v59, 0xffff0000, v97
    buffer_load_dwordx4 a[84:87], v7, s[76:79], s39 offen offset:1024 sc1
    v_lshlrev_b32 v60, 16, v100
    v_and_b32 v61, 0xffff0000, v100
    v_lshlrev_b32 v62, 16, v101
    v_and_b32 v63, 0xffff0000, v101
    v_pk_fma_f32 v[56:57], v[56:57], v[120:121], v[124:125]
    v_pk_fma_f32 v[58:59], v[58:59], v[122:123], v[126:127]
    v_pk_fma_f32 v[60:61], v[60:61], v[120:121], v[124:125]
    v_pk_fma_f32 v[62:63], v[62:63], v[122:123], v[126:127]
    v_cvt_pk_bf16_f32 v96, v56, v57
    v_cvt_pk_bf16_f32 v97, v58, v59
    ds_write_b64 v5, v[96:97] offset:32
    v_cvt_pk_bf16_f32 v100, v60, v61
    v_cvt_pk_bf16_f32 v101, v62, v63
    ds_write_b64 v5, v[100:101] offset:9376
    v_lshlrev_b32 v56, 16, v160
    v_and_b32 v57, 0xffff0000, v160
    buffer_load_dwordx4 a[88:91], v7, s[76:79], s39 offen offset:2048 sc1
    v_lshlrev_b32 v58, 16, v161
    v_and_b32 v59, 0xffff0000, v161
    v_lshlrev_b32 v60, 16, v168
    v_and_b32 v61, 0xffff0000, v168
    v_lshlrev_b32 v62, 16, v169
    v_and_b32 v63, 0xffff0000, v169
    v_pk_fma_f32 v[56:57], v[56:57], v[120:121], v[124:125]
    v_pk_fma_f32 v[58:59], v[58:59], v[122:123], v[126:127]
    v_pk_fma_f32 v[60:61], v[60:61], v[120:121], v[124:125]
    v_pk_fma_f32 v[62:63], v[62:63], v[122:123], v[126:127]
    v_cvt_pk_bf16_f32 v160, v56, v57
    v_cvt_pk_bf16_f32 v161, v58, v59
    ds_write_b64 v5, v[160:161] offset:18720
    v_cvt_pk_bf16_f32 v168, v60, v61
    v_cvt_pk_bf16_f32 v169, v62, v63
    buffer_load_dwordx4 a[92:95], v7, s[76:79], s39 offen offset:3072 sc1
    s_waitcnt lgkmcnt(13)
    ds_write_b64 v5, v[168:169] offset:28064
    ds_read_b128 v[120:123], v6 offset:256
    s_waitcnt lgkmcnt(13)
    ds_read_b128 v[124:127], v6 offset:384
    s_waitcnt lgkmcnt(10)
    ds_read_b128 v[16:19], v13 offset:8192
    ds_read_b128 v[20:23], v13 offset:9216
    ds_read_b128 v[128:131], v13 offset:10240
    ds_read_b128 v[132:135], v13 offset:11264
    v_lshlrev_b32 v56, 16, v98
    v_and_b32 v57, 0xffff0000, v98
    v_lshlrev_b32 v58, 16, v99
    v_and_b32 v59, 0xffff0000, v99
    v_lshlrev_b32 v60, 16, v102
    v_and_b32 v61, 0xffff0000, v102
    v_lshlrev_b32 v62, 16, v103
    v_and_b32 v63, 0xffff0000, v103
    v_pk_fma_f32 v[56:57], v[56:57], v[112:113], v[116:117]
    v_pk_fma_f32 v[58:59], v[58:59], v[114:115], v[118:119]
    v_pk_fma_f32 v[60:61], v[60:61], v[112:113], v[116:117]
    v_pk_fma_f32 v[62:63], v[62:63], v[114:115], v[118:119]
    v_cvt_pk_bf16_f32 v98, v56, v57
    v_cvt_pk_bf16_f32 v99, v58, v59
    s_add_u32 s39, s39, 4096
    buffer_load_dwordx4 a[96:99], v7, s[76:79], s39 offen offset:0 sc1
    ds_write_b64 v5, v[98:99] offset:64
    v_cvt_pk_bf16_f32 v102, v60, v61
    v_cvt_pk_bf16_f32 v103, v62, v63
    s_waitcnt lgkmcnt(13)
    ds_write_b64 v5, v[102:103] offset:9408
    v_lshlrev_b32 v56, 16, v162
    v_and_b32 v57, 0xffff0000, v162
    v_lshlrev_b32 v58, 16, v163
    v_and_b32 v59, 0xffff0000, v163
    v_lshlrev_b32 v60, 16, v170
    v_and_b32 v61, 0xffff0000, v170
    v_lshlrev_b32 v62, 16, v171
    v_and_b32 v63, 0xffff0000, v171
    v_pk_fma_f32 v[56:57], v[56:57], v[112:113], v[116:117]
    v_pk_fma_f32 v[58:59], v[58:59], v[114:115], v[118:119]
    v_pk_fma_f32 v[60:61], v[60:61], v[112:113], v[116:117]
    v_pk_fma_f32 v[62:63], v[62:63], v[114:115], v[118:119]
    buffer_load_dwordx4 a[100:103], v7, s[76:79], s39 offen offset:1024 sc1
    v_cvt_pk_bf16_f32 v162, v56, v57
    v_cvt_pk_bf16_f32 v163, v58, v59
    ds_write_b64 v5, v[162:163] offset:18752
    v_cvt_pk_bf16_f32 v170, v60, v61
    v_cvt_pk_bf16_f32 v171, v62, v63
    s_waitcnt lgkmcnt(13)
    ds_write_b64 v5, v[170:171] offset:28096
    ds_read_b128 v[112:115], v6 offset:320
    s_waitcnt lgkmcnt(13)
    ds_read_b128 v[116:119], v6 offset:448
    s_waitcnt lgkmcnt(10)
    ds_read_b128 v[136:139], v13 offset:12288
    ds_read_b128 v[140:143], v13 offset:13312
    ds_read_b128 v[144:147], v13 offset:14336
    ds_read_b128 v[148:151], v13 offset:15360
    v_lshlrev_b32 v56, 16, v104
    v_and_b32 v57, 0xffff0000, v104
    v_lshlrev_b32 v58, 16, v105
    v_and_b32 v59, 0xffff0000, v105
    v_lshlrev_b32 v60, 16, v108
    v_and_b32 v61, 0xffff0000, v108
    v_lshlrev_b32 v62, 16, v109
    v_and_b32 v63, 0xffff0000, v109
    v_pk_fma_f32 v[56:57], v[56:57], v[120:121], v[124:125]
    v_pk_fma_f32 v[58:59], v[58:59], v[122:123], v[126:127]
    buffer_load_dwordx4 a[104:107], v7, s[76:79], s39 offen offset:2048 sc1
    v_pk_fma_f32 v[60:61], v[60:61], v[120:121], v[124:125]
    v_pk_fma_f32 v[62:63], v[62:63], v[122:123], v[126:127]
    v_cvt_pk_bf16_f32 v104, v56, v57
    v_cvt_pk_bf16_f32 v105, v58, v59
    ds_write_b64 v5, v[104:105] offset:96
    v_cvt_pk_bf16_f32 v108, v60, v61
    v_cvt_pk_bf16_f32 v109, v62, v63
    s_waitcnt lgkmcnt(13)
    ds_write_b64 v5, v[108:109] offset:9440
    v_lshlrev_b32 v56, 16, v176
    v_and_b32 v57, 0xffff0000, v176
    v_lshlrev_b32 v58, 16, v177
    v_and_b32 v59, 0xffff0000, v177
    v_lshlrev_b32 v60, 16, v184
    v_and_b32 v61, 0xffff0000, v184
    v_lshlrev_b32 v62, 16, v185
    v_and_b32 v63, 0xffff0000, v185
    buffer_load_dwordx4 a[108:111], v7, s[76:79], s39 offen offset:3072 sc1
    v_pk_fma_f32 v[56:57], v[56:57], v[120:121], v[124:125]
    v_pk_fma_f32 v[58:59], v[58:59], v[122:123], v[126:127]
    v_pk_fma_f32 v[60:61], v[60:61], v[120:121], v[124:125]
    v_pk_fma_f32 v[62:63], v[62:63], v[122:123], v[126:127]
    v_cvt_pk_bf16_f32 v176, v56, v57
    v_cvt_pk_bf16_f32 v177, v58, v59
    ds_write_b64 v5, v[176:177] offset:18784
    v_cvt_pk_bf16_f32 v184, v60, v61
    v_cvt_pk_bf16_f32 v185, v62, v63
    s_waitcnt lgkmcnt(13)
    ds_write_b64 v5, v[184:185] offset:28128
    s_waitcnt lgkmcnt(8)
    ds_read_b128 v[152:155], v13 offset:16384
    ds_read_b128 v[156:159], v13 offset:17408
    ds_read_b128 v[180:183], v13 offset:18432
    ds_read_b128 v[188:191], v13 offset:19456
    v_lshlrev_b32 v56, 16, v106
    v_and_b32 v57, 0xffff0000, v106
    v_lshlrev_b32 v58, 16, v107
    v_and_b32 v59, 0xffff0000, v107
    v_lshlrev_b32 v60, 16, v110
    v_and_b32 v61, 0xffff0000, v110
    s_add_u32 s39, s39, 4096
    buffer_load_dwordx4 a[112:115], v7, s[76:79], s39 offen offset:0 sc1
    v_lshlrev_b32 v62, 16, v111
    v_and_b32 v63, 0xffff0000, v111
    v_pk_fma_f32 v[56:57], v[56:57], v[112:113], v[116:117]
    v_pk_fma_f32 v[58:59], v[58:59], v[114:115], v[118:119]
    v_pk_fma_f32 v[60:61], v[60:61], v[112:113], v[116:117]
    v_pk_fma_f32 v[62:63], v[62:63], v[114:115], v[118:119]
    v_cvt_pk_bf16_f32 v106, v56, v57
    v_cvt_pk_bf16_f32 v107, v58, v59
    ds_write_b64 v5, v[106:107] offset:128
    v_cvt_pk_bf16_f32 v110, v60, v61
    v_cvt_pk_bf16_f32 v111, v62, v63
    ds_write_b64 v5, v[110:111] offset:9472
    v_lshlrev_b32 v56, 16, v178
    v_and_b32 v57, 0xffff0000, v178
    v_lshlrev_b32 v58, 16, v179
    v_and_b32 v59, 0xffff0000, v179
    buffer_load_dwordx4 a[116:119], v7, s[76:79], s39 offen offset:1024 sc1
    v_lshlrev_b32 v60, 16, v186
    v_and_b32 v61, 0xffff0000, v186
    v_lshlrev_b32 v62, 16, v187
    v_and_b32 v63, 0xffff0000, v187
    v_pk_fma_f32 v[56:57], v[56:57], v[112:113], v[116:117]
    v_pk_fma_f32 v[58:59], v[58:59], v[114:115], v[118:119]
    v_pk_fma_f32 v[60:61], v[60:61], v[112:113], v[116:117]
    v_pk_fma_f32 v[62:63], v[62:63], v[114:115], v[118:119]
    v_cvt_pk_bf16_f32 v178, v56, v57
    v_cvt_pk_bf16_f32 v179, v58, v59
    ds_write_b64 v5, v[178:179] offset:18816
    v_cvt_pk_bf16_f32 v186, v60, v61
    v_cvt_pk_bf16_f32 v187, v62, v63
    s_waitcnt lgkmcnt(13)
    ds_write_b64 v5, v[186:187] offset:28160
    s_waitcnt vmcnt(16) lgkmcnt(0)
    s_barrier
    s_lshl_b32 s35, s72, 7
    s_add_u32 s35, s35, 80838656
    v_mov_b32 v14, s75
    buffer_store_dword v14, v10, s[8:11], s35 offen sc1
    ds_read_b64 v[32:33], v11 offset:0
    ds_read_b64 v[34:35], v11 offset:8
    ds_read_b64 v[36:37], v11 offset:16
    ds_read_b64 v[38:39], v11 offset:24
    ds_read_b64 v[40:41], v11 offset:32
    ds_read_b64 v[42:43], v11 offset:40
    ds_read_b64 v[44:45], v11 offset:48
    ds_read_b64 v[46:47], v11 offset:56
    ds_read_b64 v[48:49], v11 offset:64
    ds_read_b64 v[50:51], v11 offset:72
    ds_read_b64 v[52:53], v11 offset:80
    ds_read_b64 v[54:55], v11 offset:88
    s_waitcnt lgkmcnt(6)
    v_mfma_f32_4x4x4_16b_bf16 v[56:59], v[64:65], v[32:33], 0
    ds_read_b64 v[96:97], v11 offset:9344
    v_mfma_f32_4x4x4_16b_bf16 v[60:63], v[64:65], v[34:35], 0
    buffer_load_dwordx4 a[120:123], v7, s[76:79], s39 offen offset:2048 sc1
    ds_read_b64 v[98:99], v11 offset:9352
    v_mfma_f32_4x4x4_16b_bf16 v[120:123], v[64:65], v[36:37], 0
    ds_read_b64 v[100:101], v11 offset:9360
    v_mfma_f32_4x4x4_16b_bf16 v[124:127], v[64:65], v[38:39], 0
    ds_read_b64 v[102:103], v11 offset:9368
    v_mfma_f32_4x4x4_16b_bf16 v[56:59], v[66:67], v[34:35], v[56:59]
    ds_read_b64 v[104:105], v11 offset:9376
    v_mfma_f32_4x4x4_16b_bf16 v[60:63], v[66:67], v[36:37], v[60:63]
    ds_read_b64 v[106:107], v11 offset:9384
    v_mfma_f32_4x4x4_16b_bf16 v[120:123], v[66:67], v[38:39], v[120:123]
    ds_read_b64 v[108:109], v11 offset:9392
    v_mfma_f32_4x4x4_16b_bf16 v[124:127], v[66:67], v[40:41], v[124:127]
    ds_read_b64 v[110:111], v11 offset:9400
    v_mfma_f32_4x4x4_16b_bf16 v[56:59], v[68:69], v[36:37], v[56:59]
    buffer_load_dwordx4 a[124:127], v7, s[76:79], s39 offen offset:3072 sc1
    ds_read_b64 v[112:113], v11 offset:9408
    v_mfma_f32_4x4x4_16b_bf16 v[60:63], v[68:69], v[38:39], v[60:63]
    s_waitcnt lgkmcnt(13)
    ds_read_b64 v[114:115], v11 offset:9416
    v_mfma_f32_4x4x4_16b_bf16 v[120:123], v[68:69], v[40:41], v[120:123]
    ds_read_b64 v[116:117], v11 offset:9424
    v_mfma_f32_4x4x4_16b_bf16 v[124:127], v[68:69], v[42:43], v[124:127]
    s_waitcnt lgkmcnt(13)
    ds_read_b64 v[118:119], v11 offset:9432
    s_waitcnt lgkmcnt(15)
    v_mfma_f32_4x4x4_16b_bf16 v[56:59], v[70:71], v[38:39], v[56:59]
    v_mfma_f32_4x4x4_16b_bf16 v[60:63], v[70:71], v[40:41], v[60:63]
    v_mfma_f32_4x4x4_16b_bf16 v[120:123], v[70:71], v[42:43], v[120:123]
    v_mfma_f32_4x4x4_16b_bf16 v[124:127], v[70:71], v[44:45], v[124:127]
    v_mfma_f32_4x4x4_16b_bf16 v[56:59], v[72:73], v[40:41], v[56:59]
    v_mfma_f32_4x4x4_16b_bf16 v[60:63], v[72:73], v[42:43], v[60:63]
    v_mfma_f32_4x4x4_16b_bf16 v[120:123], v[72:73], v[44:45], v[120:123]
    v_mfma_f32_4x4x4_16b_bf16 v[124:127], v[72:73], v[46:47], v[124:127]
    v_mfma_f32_4x4x4_16b_bf16 v[56:59], v[74:75], v[42:43], v[56:59]
    v_mfma_f32_4x4x4_16b_bf16 v[60:63], v[74:75], v[44:45], v[60:63]
    v_mfma_f32_4x4x4_16b_bf16 v[120:123], v[74:75], v[46:47], v[120:123]
    v_mfma_f32_4x4x4_16b_bf16 v[124:127], v[74:75], v[48:49], v[124:127]
    s_waitcnt lgkmcnt(12)
    v_mfma_f32_4x4x4_16b_bf16 v[56:59], v[76:77], v[44:45], v[56:59]
    v_mfma_f32_4x4x4_16b_bf16 v[60:63], v[76:77], v[46:47], v[60:63]
    v_mfma_f32_4x4x4_16b_bf16 v[120:123], v[76:77], v[48:49], v[120:123]
    v_mfma_f32_4x4x4_16b_bf16 v[124:127], v[76:77], v[50:51], v[124:127]
    v_mfma_f32_4x4x4_16b_bf16 v[56:59], v[78:79], v[46:47], v[56:59]
    v_mfma_f32_4x4x4_16b_bf16 v[60:63], v[78:79], v[48:49], v[60:63]
    v_mfma_f32_4x4x4_16b_bf16 v[120:123], v[78:79], v[50:51], v[120:123]
    v_mfma_f32_4x4x4_16b_bf16 v[124:127], v[78:79], v[52:53], v[124:127]
    v_mfma_f32_4x4x4_16b_bf16 v[56:59], v[80:81], v[48:49], v[56:59]
    v_mfma_f32_4x4x4_16b_bf16 v[60:63], v[80:81], v[50:51], v[60:63]
    v_mfma_f32_4x4x4_16b_bf16 v[120:123], v[80:81], v[52:53], v[120:123]
    v_mfma_f32_4x4x4_16b_bf16 v[124:127], v[80:81], v[54:55], v[124:127]
    s_waitcnt lgkmcnt(6)
    v_mfma_f32_4x4x4_16b_bf16 v[24:27], v[84:85], v[96:97], 0
    ds_read_b64 v[32:33], v11 offset:18688
    v_mfma_f32_4x4x4_16b_bf16 v[28:31], v[84:85], v[98:99], 0
    ds_read_b64 v[34:35], v11 offset:18696
    v_mfma_f32_4x4x4_16b_bf16 v[176:179], v[84:85], v[100:101], 0
    ds_read_b64 v[36:37], v11 offset:18704
    v_mfma_f32_4x4x4_16b_bf16 v[184:187], v[84:85], v[102:103], 0
    ds_read_b64 v[38:39], v11 offset:18712
    v_mfma_f32_4x4x4_16b_bf16 v[24:27], v[86:87], v[98:99], v[24:27]
    ds_read_b64 v[40:41], v11 offset:18720
    v_mfma_f32_4x4x4_16b_bf16 v[28:31], v[86:87], v[100:101], v[28:31]
    ds_read_b64 v[42:43], v11 offset:18728
    v_mfma_f32_4x4x4_16b_bf16 v[176:179], v[86:87], v[102:103], v[176:179]
    ds_read_b64 v[44:45], v11 offset:18736
    v_mfma_f32_4x4x4_16b_bf16 v[184:187], v[86:87], v[104:105], v[184:187]
    ds_read_b64 v[46:47], v11 offset:18744
    v_mfma_f32_4x4x4_16b_bf16 v[24:27], v[88:89], v[100:101], v[24:27]
    ds_read_b64 v[48:49], v11 offset:18752
    v_mfma_f32_4x4x4_16b_bf16 v[28:31], v[88:89], v[102:103], v[28:31]
    s_waitcnt lgkmcnt(13)
    ds_read_b64 v[50:51], v11 offset:18760
    v_mfma_f32_4x4x4_16b_bf16 v[176:179], v[88:89], v[104:105], v[176:179]
    ds_read_b64 v[52:53], v11 offset:18768
    v_mfma_f32_4x4x4_16b_bf16 v[184:187], v[88:89], v[106:107], v[184:187]
    s_waitcnt lgkmcnt(13)
    ds_read_b64 v[54:55], v11 offset:18776
    s_waitcnt lgkmcnt(15)
    v_mfma_f32_4x4x4_16b_bf16 v[24:27], v[90:91], v[102:103], v[24:27]
    v_cvt_pk_bf16_f32 v56, v56, v57
    v_mfma_f32_4x4x4_16b_bf16 v[28:31], v[90:91], v[104:105], v[28:31]
    v_cvt_pk_bf16_f32 v57, v58, v59
    v_mfma_f32_4x4x4_16b_bf16 v[176:179], v[90:91], v[106:107], v[176:179]
    v_cvt_pk_bf16_f32 v58, v60, v61
    v_mfma_f32_4x4x4_16b_bf16 v[184:187], v[90:91], v[108:109], v[184:187]
    v_cvt_pk_bf16_f32 v59, v62, v63
    v_mfma_f32_4x4x4_16b_bf16 v[24:27], v[92:93], v[104:105], v[24:27]
    ds_write_b128 v12, v[56:59] offset:0
    v_mfma_f32_4x4x4_16b_bf16 v[28:31], v[92:93], v[106:107], v[28:31]
    v_cvt_pk_bf16_f32 v120, v120, v121
    v_mfma_f32_4x4x4_16b_bf16 v[176:179], v[92:93], v[108:109], v[176:179]
    v_cvt_pk_bf16_f32 v121, v122, v123
    v_mfma_f32_4x4x4_16b_bf16 v[184:187], v[92:93], v[110:111], v[184:187]
    v_cvt_pk_bf16_f32 v122, v124, v125
    v_mfma_f32_4x4x4_16b_bf16 v[24:27], v[94:95], v[106:107], v[24:27]
    v_cvt_pk_bf16_f32 v123, v126, v127
    v_mfma_f32_4x4x4_16b_bf16 v[28:31], v[94:95], v[108:109], v[28:31]
    s_waitcnt lgkmcnt(13)
    ds_write_b128 v12, v[120:123] offset:16
    v_mfma_f32_4x4x4_16b_bf16 v[176:179], v[94:95], v[110:111], v[176:179]
    v_mfma_f32_4x4x4_16b_bf16 v[184:187], v[94:95], v[112:113], v[184:187]
    s_waitcnt lgkmcnt(14)
    v_mfma_f32_4x4x4_16b_bf16 v[24:27], v[16:17], v[108:109], v[24:27]
    v_mfma_f32_4x4x4_16b_bf16 v[28:31], v[16:17], v[110:111], v[28:31]
    v_mfma_f32_4x4x4_16b_bf16 v[176:179], v[16:17], v[112:113], v[176:179]
    v_mfma_f32_4x4x4_16b_bf16 v[184:187], v[16:17], v[114:115], v[184:187]
    v_mfma_f32_4x4x4_16b_bf16 v[24:27], v[18:19], v[110:111], v[24:27]
    v_mfma_f32_4x4x4_16b_bf16 v[28:31], v[18:19], v[112:113], v[28:31]
    v_mfma_f32_4x4x4_16b_bf16 v[176:179], v[18:19], v[114:115], v[176:179]
    v_mfma_f32_4x4x4_16b_bf16 v[184:187], v[18:19], v[116:117], v[184:187]
    v_mfma_f32_4x4x4_16b_bf16 v[24:27], v[20:21], v[112:113], v[24:27]
    v_mfma_f32_4x4x4_16b_bf16 v[28:31], v[20:21], v[114:115], v[28:31]
    v_mfma_f32_4x4x4_16b_bf16 v[176:179], v[20:21], v[116:117], v[176:179]
    v_mfma_f32_4x4x4_16b_bf16 v[184:187], v[20:21], v[118:119], v[184:187]
    s_waitcnt lgkmcnt(8)
    v_mfma_f32_4x4x4_16b_bf16 v[56:59], v[128:129], v[32:33], 0
    ds_read_b64 v[96:97], v11 offset:28032
    v_mfma_f32_4x4x4_16b_bf16 v[60:63], v[128:129], v[34:35], 0
    ds_read_b64 v[98:99], v11 offset:28040
    v_mfma_f32_4x4x4_16b_bf16 v[120:123], v[128:129], v[36:37], 0
    ds_read_b64 v[100:101], v11 offset:28048
    v_mfma_f32_4x4x4_16b_bf16 v[124:127], v[128:129], v[38:39], 0
    ds_read_b64 v[102:103], v11 offset:28056
    v_mfma_f32_4x4x4_16b_bf16 v[56:59], v[130:131], v[34:35], v[56:59]
    ds_read_b64 v[104:105], v11 offset:28064
    v_mfma_f32_4x4x4_16b_bf16 v[60:63], v[130:131], v[36:37], v[60:63]
    ds_read_b64 v[106:107], v11 offset:28072
    v_mfma_f32_4x4x4_16b_bf16 v[120:123], v[130:131], v[38:39], v[120:123]
    ds_read_b64 v[108:109], v11 offset:28080
    v_mfma_f32_4x4x4_16b_bf16 v[124:127], v[130:131], v[40:41], v[124:127]
    s_waitcnt lgkmcnt(13)
    ds_read_b64 v[110:111], v11 offset:28088
    v_mfma_f32_4x4x4_16b_bf16 v[56:59], v[132:133], v[36:37], v[56:59]
    ds_read_b64 v[112:113], v11 offset:28096
    v_mfma_f32_4x4x4_16b_bf16 v[60:63], v[132:133], v[38:39], v[60:63]
    s_waitcnt lgkmcnt(13)
    ds_read_b64 v[114:115], v11 offset:28104
    v_mfma_f32_4x4x4_16b_bf16 v[120:123], v[132:133], v[40:41], v[120:123]
    ds_read_b64 v[116:117], v11 offset:28112
    v_mfma_f32_4x4x4_16b_bf16 v[124:127], v[132:133], v[42:43], v[124:127]
    s_waitcnt lgkmcnt(13)
    ds_read_b64 v[118:119], v11 offset:28120
    s_waitcnt lgkmcnt(15)
    v_mfma_f32_4x4x4_16b_bf16 v[56:59], v[134:135], v[38:39], v[56:59]
    v_cvt_pk_bf16_f32 v24, v24, v25
    v_mfma_f32_4x4x4_16b_bf16 v[60:63], v[134:135], v[40:41], v[60:63]
    v_cvt_pk_bf16_f32 v25, v26, v27
    v_mfma_f32_4x4x4_16b_bf16 v[120:123], v[134:135], v[42:43], v[120:123]
    v_cvt_pk_bf16_f32 v26, v28, v29
    v_mfma_f32_4x4x4_16b_bf16 v[124:127], v[134:135], v[44:45], v[124:127]
    v_cvt_pk_bf16_f32 v27, v30, v31
    v_mfma_f32_4x4x4_16b_bf16 v[56:59], v[136:137], v[40:41], v[56:59]
    ds_write_b128 v12, v[24:27] offset:576
    v_mfma_f32_4x4x4_16b_bf16 v[60:63], v[136:137], v[42:43], v[60:63]
    v_cvt_pk_bf16_f32 v176, v176, v177
    v_mfma_f32_4x4x4_16b_bf16 v[120:123], v[136:137], v[44:45], v[120:123]
    v_cvt_pk_bf16_f32 v177, v178, v179
    v_mfma_f32_4x4x4_16b_bf16 v[124:127], v[136:137], v[46:47], v[124:127]
    v_cvt_pk_bf16_f32 v178, v184, v185
    v_mfma_f32_4x4x4_16b_bf16 v[56:59], v[138:139], v[42:43], v[56:59]
    v_cvt_pk_bf16_f32 v179, v186, v187
    v_mfma_f32_4x4x4_16b_bf16 v[60:63], v[138:139], v[44:45], v[60:63]
    s_waitcnt lgkmcnt(13)
    ds_write_b128 v12, v[176:179] offset:592
    v_mfma_f32_4x4x4_16b_bf16 v[120:123], v[138:139], v[46:47], v[120:123]
    ds_read_b64_tr_b16 v[160:161], v15 offset:0
    v_mfma_f32_4x4x4_16b_bf16 v[124:127], v[138:139], v[48:49], v[124:127]
    s_waitcnt lgkmcnt(13)
    ds_read_b64_tr_b16 v[162:163], v15 offset:576
    s_waitcnt lgkmcnt(15)
    v_mfma_f32_4x4x4_16b_bf16 v[56:59], v[140:141], v[44:45], v[56:59]
    ds_read_b64_tr_b16 v[164:165], v15 offset:32
    v_mfma_f32_4x4x4_16b_bf16 v[60:63], v[140:141], v[46:47], v[60:63]
    s_waitcnt lgkmcnt(13)
    ds_read_b64_tr_b16 v[166:167], v15 offset:608
    v_mfma_f32_4x4x4_16b_bf16 v[120:123], v[140:141], v[48:49], v[120:123]
    ds_read_b64_tr_b16 v[168:169], v15 offset:64
    v_mfma_f32_4x4x4_16b_bf16 v[124:127], v[140:141], v[50:51], v[124:127]
    s_waitcnt lgkmcnt(13)
    ds_read_b64_tr_b16 v[170:171], v15 offset:640
    v_mfma_f32_4x4x4_16b_bf16 v[56:59], v[142:143], v[46:47], v[56:59]
    ds_read_b64_tr_b16 v[172:173], v15 offset:96
    v_mfma_f32_4x4x4_16b_bf16 v[60:63], v[142:143], v[48:49], v[60:63]
    s_waitcnt lgkmcnt(13)
    ds_read_b64_tr_b16 v[174:175], v15 offset:672
    v_mfma_f32_4x4x4_16b_bf16 v[120:123], v[142:143], v[50:51], v[120:123]
    v_mfma_f32_4x4x4_16b_bf16 v[124:127], v[142:143], v[52:53], v[124:127]
    v_mfma_f32_4x4x4_16b_bf16 v[56:59], v[144:145], v[48:49], v[56:59]
    v_mfma_f32_4x4x4_16b_bf16 v[60:63], v[144:145], v[50:51], v[60:63]
    v_mfma_f32_4x4x4_16b_bf16 v[120:123], v[144:145], v[52:53], v[120:123]
    v_mfma_f32_4x4x4_16b_bf16 v[124:127], v[144:145], v[54:55], v[124:127]
    s_waitcnt lgkmcnt(15)
    v_mfma_f32_4x4x4_16b_bf16 v[24:27], v[148:149], v[96:97], 0
    s_nop 0
    v_mfma_f32_4x4x4_16b_bf16 v[28:31], v[148:149], v[98:99], 0
    s_nop 0
    v_mfma_f32_4x4x4_16b_bf16 v[176:179], v[148:149], v[100:101], 0
    s_nop 0
    v_mfma_f32_4x4x4_16b_bf16 v[184:187], v[148:149], v[102:103], 0
    v_cvt_pk_bf16_f32 v56, v56, v57
    v_mfma_f32_4x4x4_16b_bf16 v[24:27], v[150:151], v[98:99], v[24:27]
    v_cvt_pk_bf16_f32 v57, v58, v59
    v_mfma_f32_4x4x4_16b_bf16 v[28:31], v[150:151], v[100:101], v[28:31]
    v_cvt_pk_bf16_f32 v58, v60, v61
    v_mfma_f32_4x4x4_16b_bf16 v[176:179], v[150:151], v[102:103], v[176:179]
    v_cvt_pk_bf16_f32 v59, v62, v63
    v_mfma_f32_4x4x4_16b_bf16 v[184:187], v[150:151], v[104:105], v[184:187]
    ds_write_b128 v12, v[56:59] offset:0
    v_mfma_f32_4x4x4_16b_bf16 v[24:27], v[152:153], v[100:101], v[24:27]
    v_cvt_pk_bf16_f32 v120, v120, v121
    v_mfma_f32_4x4x4_16b_bf16 v[28:31], v[152:153], v[102:103], v[28:31]
    v_cvt_pk_bf16_f32 v121, v122, v123
    v_mfma_f32_4x4x4_16b_bf16 v[176:179], v[152:153], v[104:105], v[176:179]
    v_cvt_pk_bf16_f32 v122, v124, v125
    v_mfma_f32_4x4x4_16b_bf16 v[184:187], v[152:153], v[106:107], v[184:187]
    v_cvt_pk_bf16_f32 v123, v126, v127
    s_waitcnt lgkmcnt(14)
    v_mfma_f32_4x4x4_16b_bf16 v[24:27], v[154:155], v[102:103], v[24:27]
    ds_write_b128 v12, v[120:123] offset:16
    v_mfma_f32_4x4x4_16b_bf16 v[28:31], v[154:155], v[104:105], v[28:31]
    v_mfma_f32_4x4x4_16b_bf16 v[176:179], v[154:155], v[106:107], v[176:179]
    v_mfma_f32_4x4x4_16b_bf16 v[184:187], v[154:155], v[108:109], v[184:187]
    v_mfma_f32_4x4x4_16b_bf16 v[24:27], v[156:157], v[104:105], v[24:27]
    v_mfma_f32_4x4x4_16b_bf16 v[28:31], v[156:157], v[106:107], v[28:31]
    v_mfma_f32_4x4x4_16b_bf16 v[176:179], v[156:157], v[108:109], v[176:179]
    v_mfma_f32_4x4x4_16b_bf16 v[184:187], v[156:157], v[110:111], v[184:187]
    v_mfma_f32_4x4x4_16b_bf16 v[24:27], v[158:159], v[106:107], v[24:27]
    v_mfma_f32_4x4x4_16b_bf16 v[28:31], v[158:159], v[108:109], v[28:31]
    v_mfma_f32_4x4x4_16b_bf16 v[176:179], v[158:159], v[110:111], v[176:179]
    v_mfma_f32_4x4x4_16b_bf16 v[184:187], v[158:159], v[112:113], v[184:187]
    s_waitcnt lgkmcnt(12)
    v_mfma_f32_4x4x4_16b_bf16 v[24:27], v[180:181], v[108:109], v[24:27]
    v_mfma_f32_4x4x4_16b_bf16 v[28:31], v[180:181], v[110:111], v[28:31]
    v_mfma_f32_4x4x4_16b_bf16 v[176:179], v[180:181], v[112:113], v[176:179]
    v_mfma_f32_4x4x4_16b_bf16 v[184:187], v[180:181], v[114:115], v[184:187]
    v_mfma_f32_4x4x4_16b_bf16 v[24:27], v[182:183], v[110:111], v[24:27]
    v_mfma_f32_4x4x4_16b_bf16 v[28:31], v[182:183], v[112:113], v[28:31]
    v_mfma_f32_4x4x4_16b_bf16 v[176:179], v[182:183], v[114:115], v[176:179]
    v_mfma_f32_4x4x4_16b_bf16 v[184:187], v[182:183], v[116:117], v[184:187]
    v_mfma_f32_4x4x4_16b_bf16 v[24:27], v[188:189], v[112:113], v[24:27]
    v_mfma_f32_4x4x4_16b_bf16 v[28:31], v[188:189], v[114:115], v[28:31]
    v_mfma_f32_4x4x4_16b_bf16 v[176:179], v[188:189], v[116:117], v[176:179]
    v_mfma_f32_4x4x4_16b_bf16 v[184:187], v[188:189], v[118:119], v[184:187]
    s_waitcnt lgkmcnt(8)
    v_lshlrev_b32 v64, 16, v160
    v_and_b32 v65, 0xffff0000, v160
    v_lshlrev_b32 v66, 16, v161
    v_and_b32 v67, 0xffff0000, v161
    v_lshlrev_b32 v68, 16, v162
    v_and_b32 v69, 0xffff0000, v162
    v_lshlrev_b32 v70, 16, v163
    v_and_b32 v71, 0xffff0000, v163
    v_pk_mul_f32 v[64:65], v[64:65], v[192:193]
    v_pk_mul_f32 v[66:67], v[66:67], v[194:195]
    v_pk_mul_f32 v[68:69], v[68:69], v[196:197]
    v_pk_mul_f32 v[70:71], v[70:71], v[198:199]
    v_cvt_pk_bf16_f32 v192, v64, v65
    v_cvt_pk_bf16_f32 v193, v66, v67
    v_cvt_pk_bf16_f32 v194, v68, v69
    v_cvt_pk_bf16_f32 v195, v70, v71
    s_waitcnt lgkmcnt(6)
    v_lshlrev_b32 v72, 16, v164
    v_and_b32 v73, 0xffff0000, v164
    v_lshlrev_b32 v74, 16, v165
    v_and_b32 v75, 0xffff0000, v165
    v_lshlrev_b32 v76, 16, v166
    v_and_b32 v77, 0xffff0000, v166
    v_lshlrev_b32 v78, 16, v167
    v_and_b32 v79, 0xffff0000, v167
    v_pk_mul_f32 v[72:73], v[72:73], v[200:201]
    v_pk_mul_f32 v[74:75], v[74:75], v[202:203]
    v_pk_mul_f32 v[76:77], v[76:77], v[204:205]
    v_pk_mul_f32 v[78:79], v[78:79], v[206:207]
    v_cvt_pk_bf16_f32 v200, v72, v73
    v_cvt_pk_bf16_f32 v201, v74, v75
    v_cvt_pk_bf16_f32 v202, v76, v77
    v_cvt_pk_bf16_f32 v203, v78, v79
    s_waitcnt lgkmcnt(4)
    v_lshlrev_b32 v64, 16, v168
    v_and_b32 v65, 0xffff0000, v168
    v_lshlrev_b32 v66, 16, v169
    v_and_b32 v67, 0xffff0000, v169
    v_lshlrev_b32 v68, 16, v170
    v_and_b32 v69, 0xffff0000, v170
    v_lshlrev_b32 v70, 16, v171
    v_and_b32 v71, 0xffff0000, v171
    v_pk_mul_f32 v[64:65], v[64:65], v[208:209]
    v_pk_mul_f32 v[66:67], v[66:67], v[210:211]
    v_pk_mul_f32 v[68:69], v[68:69], v[212:213]
    v_pk_mul_f32 v[70:71], v[70:71], v[214:215]
    v_cvt_pk_bf16_f32 v208, v64, v65
    v_cvt_pk_bf16_f32 v209, v66, v67
    v_cvt_pk_bf16_f32 v210, v68, v69
    v_cvt_pk_bf16_f32 v211, v70, v71
    s_waitcnt lgkmcnt(2)
    v_lshlrev_b32 v72, 16, v172
    v_and_b32 v73, 0xffff0000, v172
    v_lshlrev_b32 v74, 16, v173
    v_and_b32 v75, 0xffff0000, v173
    v_lshlrev_b32 v76, 16, v174
    v_and_b32 v77, 0xffff0000, v174
    v_lshlrev_b32 v78, 16, v175
    v_and_b32 v79, 0xffff0000, v175
    v_pk_mul_f32 v[72:73], v[72:73], v[216:217]
    v_pk_mul_f32 v[74:75], v[74:75], v[218:219]
    v_pk_mul_f32 v[76:77], v[76:77], v[220:221]
    v_pk_mul_f32 v[78:79], v[78:79], v[222:223]
    v_cvt_pk_bf16_f32 v216, v72, v73
    v_cvt_pk_bf16_f32 v217, v74, v75
    v_cvt_pk_bf16_f32 v218, v76, v77
    v_cvt_pk_bf16_f32 v219, v78, v79
    v_cvt_pk_bf16_f32 v24, v24, v25
    v_cvt_pk_bf16_f32 v25, v26, v27
    v_cvt_pk_bf16_f32 v26, v28, v29
    v_cvt_pk_bf16_f32 v27, v30, v31
    ds_write_b128 v12, v[24:27] offset:576
    v_cvt_pk_bf16_f32 v176, v176, v177
    v_cvt_pk_bf16_f32 v177, v178, v179
    v_cvt_pk_bf16_f32 v178, v184, v185
    v_cvt_pk_bf16_f32 v179, v186, v187
    ds_write_b128 v12, v[176:179] offset:592
    ds_read_b64_tr_b16 v[160:161], v15 offset:0
    ds_read_b64_tr_b16 v[162:163], v15 offset:576
    ds_read_b64_tr_b16 v[164:165], v15 offset:32
    ds_read_b64_tr_b16 v[166:167], v15 offset:608
    ds_read_b64_tr_b16 v[168:169], v15 offset:64
    ds_read_b64_tr_b16 v[170:171], v15 offset:640
    ds_read_b64_tr_b16 v[172:173], v15 offset:96
    ds_read_b64_tr_b16 v[174:175], v15 offset:672
    s_sub_u32 s29, s21, 8388608
    s_lshr_b32 s29, s29, 15
    s_sub_u32 s29, s29, s37
    s_add_u32 s35, s29, s25
    s_add_u32 s35, s35, 1
    s_lshr_b32 s29, s29, 3
    s_lshr_b32 s35, s35, 3
    v_lshrrev_b32 v5, 3, v0
    v_add_u32 v5, s29, v5
    v_min_u32 v5, s35, v5
    v_and_b32 v13, 7, v0
    v_lshl_add_u32 v5, v5, 3, v13
    v_lshlrev_b32 v118, 7, v5
    s_and_b32 s38, s32, 32
    s_lshl_b32 s38, s38, 9
    s_add_u32 s38, s38, 80838656
    s_waitcnt lgkmcnt(6)
    v_lshlrev_b32 v64, 16, v160
    v_and_b32 v65, 0xffff0000, v160
    v_lshlrev_b32 v66, 16, v161
    v_and_b32 v67, 0xffff0000, v161
    v_lshlrev_b32 v68, 16, v162
    v_and_b32 v69, 0xffff0000, v162
    v_lshlrev_b32 v70, 16, v163
    v_and_b32 v71, 0xffff0000, v163
    v_pk_mul_f32 v[64:65], v[64:65], v[224:225]
    v_pk_mul_f32 v[66:67], v[66:67], v[226:227]
    v_pk_mul_f32 v[68:69], v[68:69], v[228:229]
    v_pk_mul_f32 v[70:71], v[70:71], v[230:231]
    v_cvt_pk_bf16_f32 v224, v64, v65
    v_cvt_pk_bf16_f32 v225, v66, v67
    v_cvt_pk_bf16_f32 v226, v68, v69
    v_cvt_pk_bf16_f32 v227, v70, v71
    s_waitcnt lgkmcnt(4)
    v_lshlrev_b32 v72, 16, v164
    v_and_b32 v73, 0xffff0000, v164
    v_lshlrev_b32 v74, 16, v165
    v_and_b32 v75, 0xffff0000, v165
    v_lshlrev_b32 v76, 16, v166
    v_and_b32 v77, 0xffff0000, v166
    v_lshlrev_b32 v78, 16, v167
    v_and_b32 v79, 0xffff0000, v167
    v_pk_mul_f32 v[72:73], v[72:73], v[232:233]
    v_pk_mul_f32 v[74:75], v[74:75], v[234:235]
    v_pk_mul_f32 v[76:77], v[76:77], v[236:237]
    v_pk_mul_f32 v[78:79], v[78:79], v[238:239]
    v_cvt_pk_bf16_f32 v232, v72, v73
    v_cvt_pk_bf16_f32 v233, v74, v75
    v_cvt_pk_bf16_f32 v234, v76, v77
    v_cvt_pk_bf16_f32 v235, v78, v79
    s_waitcnt lgkmcnt(2)
    v_lshlrev_b32 v64, 16, v168
    v_and_b32 v65, 0xffff0000, v168
    v_lshlrev_b32 v66, 16, v169
    v_and_b32 v67, 0xffff0000, v169
    v_lshlrev_b32 v68, 16, v170
    v_and_b32 v69, 0xffff0000, v170
    v_lshlrev_b32 v70, 16, v171
    v_and_b32 v71, 0xffff0000, v171
    v_pk_mul_f32 v[64:65], v[64:65], v[240:241]
    v_pk_mul_f32 v[66:67], v[66:67], v[242:243]
    v_pk_mul_f32 v[68:69], v[68:69], v[244:245]
    v_pk_mul_f32 v[70:71], v[70:71], v[246:247]
    v_cvt_pk_bf16_f32 v240, v64, v65
    v_cvt_pk_bf16_f32 v241, v66, v67
    v_cvt_pk_bf16_f32 v242, v68, v69
    v_cvt_pk_bf16_f32 v243, v70, v71
    s_waitcnt lgkmcnt(0)
    v_lshlrev_b32 v72, 16, v172
    v_and_b32 v73, 0xffff0000, v172
    v_lshlrev_b32 v74, 16, v173
    v_and_b32 v75, 0xffff0000, v173
    v_lshlrev_b32 v76, 16, v174
    v_and_b32 v77, 0xffff0000, v174
    v_lshlrev_b32 v78, 16, v175
    v_and_b32 v79, 0xffff0000, v175
    v_pk_mul_f32 v[72:73], v[72:73], v[248:249]
    v_pk_mul_f32 v[74:75], v[74:75], v[250:251]
    v_pk_mul_f32 v[76:77], v[76:77], v[252:253]
    v_pk_mul_f32 v[78:79], v[78:79], v[254:255]
    v_cvt_pk_bf16_f32 v248, v72, v73
    v_cvt_pk_bf16_f32 v249, v74, v75
    v_cvt_pk_bf16_f32 v250, v76, v77
    v_cvt_pk_bf16_f32 v251, v78, v79
    buffer_load_dword v117, v118, s[8:11], s38 offen sc1
    buffer_store_dwordx4 v[192:195], v3, s[8:11], s58 offen offset:0 sc1
    buffer_store_dwordx4 v[200:203], v3, s[8:11], s58 offen offset:1024 sc1
    buffer_store_dwordx4 v[208:211], v4, s[8:11], s59 offen offset:0 sc1
    buffer_store_dwordx4 v[216:219], v4, s[8:11], s59 offen offset:1024 sc1
    buffer_store_dwordx4 v[224:227], v3, s[8:11], s58 offen offset:2048 sc1
    buffer_store_dwordx4 v[232:235], v3, s[8:11], s58 offen offset:3072 sc1
    buffer_store_dwordx4 v[240:243], v4, s[8:11], s59 offen offset:2048 sc1
    buffer_store_dwordx4 v[248:251], v4, s[8:11], s59 offen offset:3072 sc1
    v_mov_b32 v127, v10
    s_add_u32 s30, s26, s28
    s_and_b32 s30, s30, 3
    s_lshl_b32 s30, s30, 13
    v_add_u32 v3, s30, v7
    v_add_u32 v4, 4096, v3
    s_mov_b32 s22, s33
    s_mov_b32 s24, 65536
    s_add_u32 s34, s34, s26
    s_and_b32 s30, s34, 15
    s_lshl_b32 s30, s30, 11
    s_cmp_ge_u32 s34, 16
    s_cselect_b32 s34, 8355840, 0
    s_add_u32 s30, s30, s34
    s_add_u32 s30, s30, 65536
    v_lshlrev_b32 v116, 5, v0
    v_add_u32 v116, s30, v116
    s_cmp_eq_u32 s31, 0
    s_cselect_b32 s30, -1, 0
    v_and_b32 v124, s30, v7
    v_mov_b32 v5, v124
    v_add_u32 v6, s24, v124
    v_mov_b32 v8, 0
    v_mov_b32 v9, 0
    ds_read_b128 v[64:67], v5 offset:0
    ds_read_b128 v[68:71], v5 offset:2048
    ds_read_b128 v[72:75], v5 offset:4096
    ds_read_b128 v[76:79], v5 offset:6144
    ds_read_b128 v[80:83], v5 offset:8192
    ds_read_b128 v[84:87], v5 offset:10240
    ds_read_b128 v[88:91], v5 offset:12288
    ds_read_b128 v[92:95], v5 offset:14336
    ds_read_b128 v[96:99], v5 offset:16384
    ds_read_b128 v[100:103], v5 offset:18432
    s_waitcnt vmcnt(9)
    s_waitcnt lgkmcnt(8)
    v_mfma_f32_16x16x32_bf16 v[16:19], v[64:67], a[0:3], 0
    v_mfma_f32_16x16x32_bf16 v[16:19], v[68:71], a[8:11], v[16:19]
    ds_read_b128 v[104:107], v5 offset:20480
    s_waitcnt lgkmcnt(9)
    v_mfma_f32_16x16x32_bf16 v[20:23], v[64:67], a[4:7], 0
    v_mfma_f32_16x16x32_bf16 v[20:23], v[68:71], a[12:15], v[20:23]
    ds_read_b128 v[108:111], v5 offset:22528
    s_waitcnt lgkmcnt(8)
    v_mfma_f32_16x16x32_bf16 v[20:23], v[72:75], a[20:23], v[20:23]
    v_mfma_f32_16x16x32_bf16 v[20:23], v[76:79], a[28:31], v[20:23]
    ds_read_b128 v[112:115], v5 offset:24576
    s_waitcnt lgkmcnt(9)
    v_mfma_f32_16x16x32_bf16 v[16:19], v[72:75], a[16:19], v[16:19]
    v_mfma_f32_16x16x32_bf16 v[16:19], v[76:79], a[24:27], v[16:19]
    ds_read_b128 v[64:67], v5 offset:26624
    s_waitcnt lgkmcnt(8)
    v_mfma_f32_16x16x32_bf16 v[16:19], v[80:83], a[32:35], v[16:19]
    v_mfma_f32_16x16x32_bf16 v[16:19], v[84:87], a[40:43], v[16:19]
    ds_read_b128 v[68:71], v5 offset:28672
    s_waitcnt lgkmcnt(9)
    v_mfma_f32_16x16x32_bf16 v[20:23], v[80:83], a[36:39], v[20:23]
    v_mfma_f32_16x16x32_bf16 v[20:23], v[84:87], a[44:47], v[20:23]
    ds_read_b128 v[72:75], v5 offset:30720
    s_waitcnt lgkmcnt(8)
    v_mfma_f32_16x16x32_bf16 v[20:23], v[88:91], a[52:55], v[20:23]
    v_mfma_f32_16x16x32_bf16 v[20:23], v[92:95], a[60:63], v[20:23]
    ds_read_b128 v[76:79], v5 offset:1024
    s_waitcnt lgkmcnt(9)
    v_mfma_f32_16x16x32_bf16 v[16:19], v[88:91], a[48:51], v[16:19]
    v_mfma_f32_16x16x32_bf16 v[16:19], v[92:95], a[56:59], v[16:19]
    ds_read_b128 v[80:83], v5 offset:3072
    s_waitcnt lgkmcnt(8)
    v_mfma_f32_16x16x32_bf16 v[16:19], v[96:99], a[64:67], v[16:19]
    v_mfma_f32_16x16x32_bf16 v[16:19], v[100:103], a[72:75], v[16:19]
    ds_read_b128 v[84:87], v5 offset:5120
    s_waitcnt lgkmcnt(9)
    v_mfma_f32_16x16x32_bf16 v[20:23], v[96:99], a[68:71], v[20:23]
    v_mfma_f32_16x16x32_bf16 v[20:23], v[100:103], a[76:79], v[20:23]
    ds_read_b128 v[88:91], v5 offset:7168
    s_waitcnt lgkmcnt(8)
    v_mfma_f32_16x16x32_bf16 v[20:23], v[104:107], a[84:87], v[20:23]
    v_mfma_f32_16x16x32_bf16 v[20:23], v[108:111], a[92:95], v[20:23]
    ds_read_b128 v[92:95], v5 offset:9216
    s_waitcnt lgkmcnt(9)
    v_mfma_f32_16x16x32_bf16 v[16:19], v[104:107], a[80:83], v[16:19]
    v_mfma_f32_16x16x32_bf16 v[16:19], v[108:111], a[88:91], v[16:19]
    ds_read_b128 v[96:99], v5 offset:11264
    s_waitcnt lgkmcnt(8)
    v_mfma_f32_16x16x32_bf16 v[16:19], v[112:115], a[96:99], v[16:19]
    v_mfma_f32_16x16x32_bf16 v[16:19], v[64:67], a[104:107], v[16:19]
    ds_read_b128 v[100:103], v5 offset:13312
    s_waitcnt lgkmcnt(9)
    v_mfma_f32_16x16x32_bf16 v[20:23], v[112:115], a[100:103], v[20:23]
    v_mfma_f32_16x16x32_bf16 v[20:23], v[64:67], a[108:111], v[20:23]
    ds_read_b128 v[104:107], v5 offset:15360
    s_waitcnt lgkmcnt(8)
    v_mfma_f32_16x16x32_bf16 v[20:23], v[68:71], a[116:119], v[20:23]
    v_mfma_f32_16x16x32_bf16 v[20:23], v[72:75], a[124:127], v[20:23]
    ds_read_b128 v[108:111], v5 offset:17408
    s_waitcnt lgkmcnt(9)
    v_mfma_f32_16x16x32_bf16 v[16:19], v[68:71], a[112:115], v[16:19]
    v_mfma_f32_16x16x32_bf16 v[16:19], v[72:75], a[120:123], v[16:19]
    ds_read_b128 v[112:115], v5 offset:19456
    s_waitcnt lgkmcnt(8)
    v_mfma_f32_16x16x32_bf16 v[24:27], v[76:79], a[0:3], 0
    v_mfma_f32_16x16x32_bf16 v[24:27], v[80:83], a[8:11], v[24:27]
    ds_read_b128 v[64:67], v5 offset:21504
    s_waitcnt vmcnt(8)
    v_cmp_ne_u32 vcc, s75, v117
    s_cbranch_vccnz L_fvs
L_fvk:
    s_add_u32 s23, s33, 65536
    s_mov_b32 m0, s23
    s_nop 0
    buffer_load_dwordx4 v3, s[8:11], s21 offen offset:0 sc1 lds
    s_waitcnt lgkmcnt(9)
    v_mfma_f32_16x16x32_bf16 v[28:31], v[76:79], a[4:7], 0
    v_mfma_f32_16x16x32_bf16 v[28:31], v[80:83], a[12:15], v[28:31]
    ds_read_b128 v[68:71], v5 offset:23552
    buffer_load_dwordx4 v3, s[8:11], s21 offen offset:1024 sc1 lds
    s_waitcnt lgkmcnt(8)
    v_mfma_f32_16x16x32_bf16 v[28:31], v[84:87], a[20:23], v[28:31]
    v_mfma_f32_16x16x32_bf16 v[28:31], v[88:91], a[28:31], v[28:31]
    ds_read_b128 v[72:75], v5 offset:25600
    buffer_load_dwordx4 v3, s[8:11], s21 offen offset:2048 sc1 lds
    s_waitcnt lgkmcnt(9)
    v_mfma_f32_16x16x32_bf16 v[24:27], v[84:87], a[16:19], v[24:27]
    v_mfma_f32_16x16x32_bf16 v[24:27], v[88:91], a[24:27], v[24:27]
    ds_read_b128 v[76:79], v5 offset:27648
    buffer_load_dwordx4 v3, s[8:11], s21 offen offset:3072 sc1 lds
    s_waitcnt lgkmcnt(8)
    v_mfma_f32_16x16x32_bf16 v[24:27], v[92:95], a[32:35], v[24:27]
    v_mfma_f32_16x16x32_bf16 v[24:27], v[96:99], a[40:43], v[24:27]
    ds_read_b128 v[80:83], v5 offset:29696
    s_add_u32 m0, s23, 4096
    s_nop 0
    buffer_load_dwordx4 v4, s[8:11], s21 offen offset:0 sc1 lds
    s_waitcnt lgkmcnt(9)
    v_mfma_f32_16x16x32_bf16 v[28:31], v[92:95], a[36:39], v[28:31]
    v_mfma_f32_16x16x32_bf16 v[28:31], v[96:99], a[44:47], v[28:31]
    ds_read_b128 v[84:87], v5 offset:31744
    buffer_load_dwordx4 v4, s[8:11], s21 offen offset:1024 sc1 lds
    s_waitcnt lgkmcnt(8)
    v_mfma_f32_16x16x32_bf16 v[28:31], v[100:103], a[52:55], v[28:31]
    v_mfma_f32_16x16x32_bf16 v[28:31], v[104:107], a[60:63], v[28:31]
    buffer_load_dwordx4 v4, s[8:11], s21 offen offset:2048 sc1 lds
    s_waitcnt lgkmcnt(8)
    v_mfma_f32_16x16x32_bf16 v[24:27], v[100:103], a[48:51], v[24:27]
    v_mfma_f32_16x16x32_bf16 v[24:27], v[104:107], a[56:59], v[24:27]
    buffer_load_dwordx4 v4, s[8:11], s21 offen offset:3072 sc1 lds
    s_waitcnt lgkmcnt(6)
    v_mfma_f32_16x16x32_bf16 v[24:27], v[108:111], a[64:67], v[24:27]
    v_mfma_f32_16x16x32_bf16 v[24:27], v[112:115], a[72:75], v[24:27]
    s_waitcnt lgkmcnt(6)
    v_mfma_f32_16x16x32_bf16 v[28:31], v[108:111], a[68:71], v[28:31]
    v_mfma_f32_16x16x32_bf16 v[28:31], v[112:115], a[76:79], v[28:31]
    s_waitcnt lgkmcnt(4)
    v_mfma_f32_16x16x32_bf16 v[28:31], v[64:67], a[84:87], v[28:31]
    v_mfma_f32_16x16x32_bf16 v[28:31], v[68:71], a[92:95], v[28:31]
    s_waitcnt lgkmcnt(4)
    v_mfma_f32_16x16x32_bf16 v[24:27], v[64:67], a[80:83], v[24:27]
    v_mfma_f32_16x16x32_bf16 v[24:27], v[68:71], a[88:91], v[24:27]
    s_waitcnt lgkmcnt(2)
    v_mfma_f32_16x16x32_bf16 v[24:27], v[72:75], a[96:99], v[24:27]
    v_mfma_f32_16x16x32_bf16 v[24:27], v[76:79], a[104:107], v[24:27]
    s_waitcnt lgkmcnt(2)
    v_mfma_f32_16x16x32_bf16 v[28:31], v[72:75], a[100:103], v[28:31]
    v_mfma_f32_16x16x32_bf16 v[28:31], v[76:79], a[108:111], v[28:31]
    s_waitcnt lgkmcnt(0)
    v_mfma_f32_16x16x32_bf16 v[28:31], v[80:83], a[116:119], v[28:31]
    v_mfma_f32_16x16x32_bf16 v[28:31], v[84:87], a[124:127], v[28:31]
    s_waitcnt lgkmcnt(0)
    v_mfma_f32_16x16x32_bf16 v[24:27], v[80:83], a[112:115], v[24:27]
    v_mfma_f32_16x16x32_bf16 v[24:27], v[84:87], a[120:123], v[24:27]
    s_add_u32 s21, s21, 32768
    s_add_u32 s23, s23, 32768
    s_nop 5
    v_max3_f32 v11, v16, v17, v18
    v_max3_f32 v11, v11, v19, v24
    v_max3_f32 v11, v11, v25, v26
    v_max_f32 v11, v11, v27
    v_max3_f32 v12, v20, v21, v22
    v_max3_f32 v12, v12, v23, v28
    v_max3_f32 v12, v12, v29, v30
    v_max_f32 v12, v12, v31
    v_mov_b32 v120, v11
    v_mov_b32 v121, v12
    s_nop 1
    v_permlane16_swap_b32 v120, v11
    v_permlane16_swap_b32 v121, v12
    s_nop 1
    v_max_f32 v11, v11, v120
    v_max_f32 v12, v12, v121
    v_mov_b32 v120, v11
    v_mov_b32 v121, v12
    s_nop 1
    v_permlane32_swap_b32 v120, v11
    v_permlane32_swap_b32 v121, v12
    s_nop 1
    v_max_f32 v11, v11, v120
    v_max_f32 v12, v12, v121
    s_cmp_lg_u32 s31, 0
    s_cselect_b32 s30, 0x7149f2ca, 0
    v_add_f32 v11, s30, v11
    v_add_f32 v12, s30, v12
    v_sub_f32 v16, v16, v11
    v_sub_f32 v17, v17, v11
    v_sub_f32 v18, v18, v11
    v_sub_f32 v19, v19, v11
    v_sub_f32 v24, v24, v11
    v_sub_f32 v25, v25, v11
    v_sub_f32 v26, v26, v11
    v_sub_f32 v27, v27, v11
    v_sub_f32 v56, 0, v11
    v_sub_f32 v57, 0, v11
    v_sub_f32 v58, 0, v11
    v_sub_f32 v59, 0, v11
    v_sub_f32 v20, v20, v12
    v_sub_f32 v21, v21, v12
    v_sub_f32 v22, v22, v12
    v_sub_f32 v23, v23, v12
    v_sub_f32 v28, v28, v12
    v_sub_f32 v29, v29, v12
    v_sub_f32 v30, v30, v12
    v_sub_f32 v31, v31, v12
    v_sub_f32 v60, 0, v12
    v_sub_f32 v61, 0, v12
    v_sub_f32 v62, 0, v12
    v_sub_f32 v63, 0, v12
    v_exp_f32 v32, v16
    v_exp_f32 v33, v17
    v_exp_f32 v34, v18
    v_exp_f32 v35, v19
    v_exp_f32 v36, v20
    v_exp_f32 v37, v21
    v_exp_f32 v38, v22
    v_exp_f32 v39, v23
    v_exp_f32 v40, v24
    v_exp_f32 v41, v25
    v_exp_f32 v42, v26
    v_exp_f32 v43, v27
    v_exp_f32 v44, v28
    v_exp_f32 v45, v29
    v_exp_f32 v46, v30
    v_exp_f32 v47, v31
    v_xor_b32 v5, 0x8000, v5
    s_lshl2_add_u32 s62, s32, s26
    s_lshl_b32 s62, s62, 9
    s_add_u32 s62, s62, 79691776
    v_and_b32 v119, 3, v0
    v_lshlrev_b32 v119, 7, v119
    s_lshl_b32 s35, s28, 7
    s_add_u32 s35, s35, s62
    v_lshlrev_b32 v13, 2, v0
    v_mov_b32 v14, 0
    s_mov_b64 exec, 0xffffffff
    buffer_store_dword v14, v13, s[8:11], s35 offen sc1
    s_mov_b64 exec, -1
    s_lshl_b32 s35, s72, 7
    s_add_u32 s35, s35, 80871424
    v_mov_b32 v126, s75
    s_waitcnt vmcnt(60)
    s_barrier
    ds_read_b128 v[64:67], v5 offset:0
    ds_read_b128 v[68:71], v5 offset:2048
    ds_read_b128 v[72:75], v5 offset:4096
    ds_read_b128 v[76:79], v5 offset:6144
    ds_read_b128 v[80:83], v5 offset:8192
    ds_read_b128 v[84:87], v5 offset:10240
    ds_read_b128 v[88:91], v5 offset:12288
    ds_read_b128 v[92:95], v5 offset:14336
    ds_read_b128 v[96:99], v5 offset:16384
    ds_read_b128 v[100:103], v5 offset:18432
    s_mov_b32 s74, s28
    s_lshl_b32 s61, s74, 17
    s_add_u32 s61, s61, 45088768
    s_lshl_b32 s60, s27, 15
    s_add_u32 s60, s60, 46137344
    s_mov_b32 s44, s20
    s_mov_b32 s45, 32768
    s_mov_b32 s46, 0
    s_sub_u32 s25, s25, 4
    s_mov_b32 s96, s40
    s_mov_b32 s97, s41
    s_mov_b32 s98, 117440512
    s_mov_b32 s99, 0x00020000
    s_lshl_b32 s54, s32, 2
    s_add_u32 s54, s54, s28
    s_lshl_b32 s54, s54, 2
    s_add_u32 s54, s54, s26
    s_lshl_b32 s54, s54, 15
    s_add_u32 s54, s54, 83886080
    s_mov_b32 s55, 0
    s_waitcnt lgkmcnt(6)
    v_mfma_f32_16x16x32_bf16 v[16:19], v[64:67], a[0:3], v[56:59]
    ds_read_b128 v[104:107], v5 offset:20480
    s_mov_b32 m0, s22
    v_mfma_f32_16x16x32_bf16 v[16:19], v[68:71], a[8:11], v[16:19]
    buffer_load_dwordx4 v1, s[8:11], s20 offen offset:0 sc1 lds
    v_mfma_f32_16x16x32_bf16 v[20:23], v[64:67], a[4:7], v[60:63]
    ds_read_b128 v[108:111], v5 offset:22528
    v_cvt_pk_bf16_f32 v48, v32, v33
    v_mfma_f32_16x16x32_bf16 v[20:23], v[68:71], a[12:15], v[20:23]
    v_cvt_pk_bf16_f32 v49, v34, v35
    v_cvt_pk_bf16_f32 v50, v40, v41
    v_mfma_f32_16x16x32_bf16 v[20:23], v[72:75], a[20:23], v[20:23]
    ds_read_b128 v[112:115], v5 offset:24576
    v_cvt_pk_bf16_f32 v51, v42, v43
    v_mfma_f32_16x16x32_bf16 v[20:23], v[76:79], a[28:31], v[20:23]
    buffer_load_dwordx4 v1, s[8:11], s20 offen offset:1024 sc1 lds
    v_mfma_f32_16x16x32_bf16 v[16:19], v[72:75], a[16:19], v[16:19]
    ds_read_b128 v[64:67], v5 offset:26624
    v_cvt_pk_bf16_f32 v52, v36, v37
    v_mfma_f32_16x16x32_bf16 v[16:19], v[76:79], a[24:27], v[16:19]
    v_cvt_pk_bf16_f32 v53, v38, v39
    s_waitcnt lgkmcnt(6)
    v_mfma_f32_16x16x32_bf16 v[16:19], v[80:83], a[32:35], v[16:19]
    ds_read_b128 v[68:71], v5 offset:28672
    v_cvt_pk_bf16_f32 v54, v44, v45
    v_mfma_f32_16x16x32_bf16 v[16:19], v[84:87], a[40:43], v[16:19]
    buffer_load_dwordx4 v1, s[8:11], s20 offen offset:2048 sc1 lds
    v_mfma_f32_16x16x32_bf16 v[20:23], v[80:83], a[36:39], v[20:23]
    ds_read_b128 v[72:75], v5 offset:30720
    v_cvt_pk_bf16_f32 v55, v46, v47
    v_mfma_f32_16x16x32_bf16 v[20:23], v[84:87], a[44:47], v[20:23]
    v_add_f32 v8, v8, v32
    v_add_f32 v8, v8, v33
    v_mfma_f32_16x16x32_bf16 v[20:23], v[88:91], a[52:55], v[20:23]
    ds_read_b128 v[76:79], v5 offset:1024
    v_add_f32 v8, v8, v34
    v_mfma_f32_16x16x32_bf16 v[20:23], v[92:95], a[60:63], v[20:23]
    buffer_load_dwordx4 v1, s[8:11], s20 offen offset:3072 sc1 lds
    v_mfma_f32_16x16x32_bf16 v[16:19], v[88:91], a[48:51], v[16:19]
    ds_read_b128 v[80:83], v5 offset:3072
    v_add_f32 v8, v8, v35
    v_mfma_f32_16x16x32_bf16 v[16:19], v[92:95], a[56:59], v[16:19]
    v_add_f32 v9, v9, v36
    s_waitcnt lgkmcnt(6)
    v_mfma_f32_16x16x32_bf16 v[16:19], v[96:99], a[64:67], v[16:19]
    ds_read_b128 v[84:87], v5 offset:5120
    s_add_u32 m0, s22, 4096
    v_mfma_f32_16x16x32_bf16 v[16:19], v[100:103], a[72:75], v[16:19]
    buffer_load_dwordx4 v2, s[8:11], s20 offen offset:0 sc1 lds
    v_mfma_f32_16x16x32_bf16 v[20:23], v[96:99], a[68:71], v[20:23]
    ds_read_b128 v[88:91], v5 offset:7168
    v_add_f32 v9, v9, v37
    v_mfma_f32_16x16x32_bf16 v[20:23], v[100:103], a[76:79], v[20:23]
    v_add_f32 v9, v9, v38
    v_add_f32 v9, v9, v39
    v_mfma_f32_16x16x32_bf16 v[20:23], v[104:107], a[84:87], v[20:23]
    ds_read_b128 v[92:95], v5 offset:9216
    v_add_f32 v8, v8, v40
    v_mfma_f32_16x16x32_bf16 v[20:23], v[108:111], a[92:95], v[20:23]
    buffer_load_dwordx4 v2, s[8:11], s20 offen offset:1024 sc1 lds
    v_mfma_f32_16x16x32_bf16 v[16:19], v[104:107], a[80:83], v[16:19]
    ds_read_b128 v[96:99], v5 offset:11264
    v_add_f32 v8, v8, v41
    v_mfma_f32_16x16x32_bf16 v[16:19], v[108:111], a[88:91], v[16:19]
    v_add_f32 v8, v8, v42
    s_waitcnt lgkmcnt(6)
    v_mfma_f32_16x16x32_bf16 v[16:19], v[112:115], a[96:99], v[16:19]
    ds_read_b128 v[100:103], v5 offset:13312
    v_add_f32 v8, v8, v43
    v_mfma_f32_16x16x32_bf16 v[16:19], v[64:67], a[104:107], v[16:19]
    buffer_load_dwordx4 v2, s[8:11], s20 offen offset:2048 sc1 lds
    v_mfma_f32_16x16x32_bf16 v[20:23], v[112:115], a[100:103], v[20:23]
    ds_read_b128 v[104:107], v5 offset:15360
    v_add_f32 v9, v9, v44
    v_mfma_f32_16x16x32_bf16 v[20:23], v[64:67], a[108:111], v[20:23]
    v_add_f32 v9, v9, v45
    v_add_f32 v9, v9, v46
    v_mfma_f32_16x16x32_bf16 v[20:23], v[68:71], a[116:119], v[20:23]
    ds_read_b128 v[108:111], v5 offset:17408
    v_add_f32 v9, v9, v47
    v_mfma_f32_16x16x32_bf16 v[20:23], v[72:75], a[124:127], v[20:23]
    buffer_load_dwordx4 v2, s[8:11], s20 offen offset:3072 sc1 lds
    v_mfma_f32_16x16x32_bf16 v[16:19], v[68:71], a[112:115], v[16:19]
    ds_read_b128 v[112:115], v5 offset:19456
    v_mfma_f32_16x16x32_bf16 v[16:19], v[72:75], a[120:123], v[16:19]
    s_waitcnt lgkmcnt(6)
    v_mfma_f32_16x16x32_bf16 v[24:27], v[76:79], a[0:3], v[56:59]
    ds_read_b128 v[64:67], v5 offset:21504
    s_mov_b32 m0, s23
    v_mfma_f32_16x16x32_bf16 v[24:27], v[80:83], a[8:11], v[24:27]
    buffer_load_dwordx4 v3, s[8:11], s21 offen offset:0 sc1 lds
    v_mfma_f32_16x16x32_bf16 v[28:31], v[76:79], a[4:7], v[60:63]
    ds_read_b128 v[68:71], v5 offset:23552
    v_mfma_f32_16x16x32_bf16 v[28:31], v[80:83], a[12:15], v[28:31]
    v_mfma_f32_16x16x32_bf16 v[28:31], v[84:87], a[20:23], v[28:31]
    ds_read_b128 v[72:75], v5 offset:25600
    v_mfma_f32_16x16x32_bf16 v[28:31], v[88:91], a[28:31], v[28:31]
    buffer_load_dwordx4 v3, s[8:11], s21 offen offset:1024 sc1 lds
    v_mfma_f32_16x16x32_bf16 v[24:27], v[84:87], a[16:19], v[24:27]
    ds_read_b128 v[76:79], v5 offset:27648
    v_mfma_f32_16x16x32_bf16 v[24:27], v[88:91], a[24:27], v[24:27]
    s_waitcnt lgkmcnt(6)
    v_mfma_f32_16x16x32_bf16 v[24:27], v[92:95], a[32:35], v[24:27]
    ds_read_b128 v[80:83], v5 offset:29696
    v_mfma_f32_16x16x32_bf16 v[24:27], v[96:99], a[40:43], v[24:27]
    s_waitcnt vmcnt(11)
    s_barrier
    buffer_store_dword v126, v127, s[8:11], s35 offen sc1
    v_mfma_f32_16x16x32_bf16 v[28:31], v[92:95], a[36:39], v[28:31]
    ds_read_b128 v[84:87], v5 offset:31744
    v_mfma_f32_16x16x32_bf16 v[28:31], v[96:99], a[44:47], v[28:31]
    buffer_load_dwordx4 v3, s[8:11], s21 offen offset:2048 sc1 lds
    v_mfma_f32_16x16x32_bf16 v[28:31], v[100:103], a[52:55], v[28:31]
    ds_read_b128 v[88:91], v6 offset:0
    v_mfma_f32_16x16x32_bf16 v[28:31], v[104:107], a[60:63], v[28:31]
    v_xor_b32 v5, 0x8000, v5
    v_mfma_f32_16x16x32_bf16 v[24:27], v[100:103], a[48:51], v[24:27]
    ds_read_b128 v[92:95], v6 offset:1024
    v_mfma_f32_16x16x32_bf16 v[24:27], v[104:107], a[56:59], v[24:27]
    s_waitcnt lgkmcnt(6)
    v_mfma_f32_16x16x32_bf16 v[24:27], v[108:111], a[64:67], v[24:27]
    ds_read_b128 v[96:99], v6 offset:2048
    v_mfma_f32_16x16x32_bf16 v[24:27], v[112:115], a[72:75], v[24:27]
    buffer_load_dwordx4 v3, s[8:11], s21 offen offset:3072 sc1 lds
    v_mfma_f32_16x16x32_bf16 v[28:31], v[108:111], a[68:71], v[28:31]
    ds_read_b128 v[100:103], v6 offset:3072
    v_mfma_f32_16x16x32_bf16 v[28:31], v[112:115], a[76:79], v[28:31]
    v_mfma_f32_16x16x32_bf16 v[28:31], v[64:67], a[84:87], v[28:31]
    ds_read_b128 v[104:107], v6 offset:4096
    s_add_u32 m0, s23, 4096
    v_mfma_f32_16x16x32_bf16 v[28:31], v[68:71], a[92:95], v[28:31]
    buffer_load_dwordx4 v4, s[8:11], s21 offen offset:0 sc1 lds
    v_mfma_f32_16x16x32_bf16 v[24:27], v[64:67], a[80:83], v[24:27]
    ds_read_b128 v[108:111], v6 offset:5120
    v_mfma_f32_16x16x32_bf16 v[24:27], v[68:71], a[88:91], v[24:27]
    s_waitcnt lgkmcnt(6)
    v_mfma_f32_16x16x32_bf16 v[24:27], v[72:75], a[96:99], v[24:27]
    ds_read_b128 v[112:115], v6 offset:6144
    v_mfma_f32_16x16x32_bf16 v[24:27], v[76:79], a[104:107], v[24:27]
    buffer_load_dwordx4 v4, s[8:11], s21 offen offset:1024 sc1 lds
    v_mfma_f32_16x16x32_bf16 v[28:31], v[72:75], a[100:103], v[28:31]
    ds_read_b128 v[64:67], v6 offset:7168
    v_mfma_f32_16x16x32_bf16 v[28:31], v[76:79], a[108:111], v[28:31]
    v_mfma_f32_16x16x32_bf16 v[28:31], v[80:83], a[116:119], v[28:31]
    ds_read_b128 v[68:71], v6 offset:8192
    v_mfma_f32_16x16x32_bf16 v[28:31], v[84:87], a[124:127], v[28:31]
    buffer_load_dwordx4 v4, s[8:11], s21 offen offset:2048 sc1 lds
    v_mfma_f32_16x16x32_bf16 v[24:27], v[80:83], a[112:115], v[24:27]
    ds_read_b128 v[72:75], v6 offset:9216
    v_mfma_f32_16x16x32_bf16 v[24:27], v[84:87], a[120:123], v[24:27]
    s_waitcnt lgkmcnt(6)
    v_mfma_f32_16x16x32_bf16 v[128:131], v[88:91], v[48:51], 0
    ds_read_b128 v[76:79], v6 offset:10240
    v_mfma_f32_16x16x32_bf16 v[132:135], v[88:91], v[52:55], 0
    buffer_load_dwordx4 v4, s[8:11], s21 offen offset:3072 sc1 lds
    v_mfma_f32_16x16x32_bf16 v[140:143], v[92:95], v[52:55], 0
    ds_read_b128 v[80:83], v6 offset:11264
    v_mfma_f32_16x16x32_bf16 v[136:139], v[92:95], v[48:51], 0
    v_mfma_f32_16x16x32_bf16 v[144:147], v[96:99], v[48:51], 0
    ds_read_b128 v[84:87], v6 offset:12288
    v_max3_f32 v10, v16, v17, v18
    v_mfma_f32_16x16x32_bf16 v[148:151], v[96:99], v[52:55], 0
    buffer_load_dword v117, v116, s[96:99], s44 offen sc1
    v_mfma_f32_16x16x32_bf16 v[156:159], v[100:103], v[52:55], 0
    ds_read_b128 v[88:91], v6 offset:13312
    v_max3_f32 v10, v10, v19, v20
    v_mfma_f32_16x16x32_bf16 v[152:155], v[100:103], v[48:51], 0
    v_max3_f32 v10, v10, v21, v22
    s_waitcnt lgkmcnt(6)
    v_mfma_f32_16x16x32_bf16 v[160:163], v[104:107], v[48:51], 0
    ds_read_b128 v[92:95], v6 offset:14336
    v_max3_f32 v10, v10, v23, v24
    v_mfma_f32_16x16x32_bf16 v[164:167], v[104:107], v[52:55], 0
    v_max3_f32 v10, v10, v25, v26
    v_max3_f32 v10, v10, v27, v28
    v_mfma_f32_16x16x32_bf16 v[172:175], v[108:111], v[52:55], 0
    ds_read_b128 v[96:99], v6 offset:15360
    v_max3_f32 v10, v10, v29, v30
    v_mfma_f32_16x16x32_bf16 v[168:171], v[108:111], v[48:51], 0
    v_max_f32 v10, v10, v31
    v_cmp_lt_f32 vcc, 0x41800000, v10
    v_mfma_f32_16x16x32_bf16 v[176:179], v[112:115], v[48:51], 0
    ds_read_b128 v[100:103], v6 offset:16384
    s_add_u32 s20, s20, 32768
    v_mfma_f32_16x16x32_bf16 v[180:183], v[112:115], v[52:55], 0
    s_add_u32 s44, s44, s45
    s_add_u32 s21, s21, 32768
    v_mfma_f32_16x16x32_bf16 v[188:191], v[64:67], v[52:55], 0
    ds_read_b128 v[104:107], v6 offset:17408
    s_xor_b32 s22, s22, 32768
    v_mfma_f32_16x16x32_bf16 v[184:187], v[64:67], v[48:51], 0
    s_cbranch_vccnz L_r1F
L_r1bF:
    s_waitcnt lgkmcnt(6)
    v_mfma_f32_16x16x32_bf16 v[192:195], v[68:71], v[48:51], 0
    ds_read_b128 v[108:111], v6 offset:18432
    s_add_u32 s23, s23, 32768
    v_mfma_f32_16x16x32_bf16 v[196:199], v[68:71], v[52:55], 0
    v_exp_f32 v32, v16
    v_mfma_f32_16x16x32_bf16 v[204:207], v[72:75], v[52:55], 0
    ds_read_b128 v[112:115], v6 offset:19456
    s_cmp_ge_u32 s23, 163840
    v_mfma_f32_16x16x32_bf16 v[200:203], v[72:75], v[48:51], 0
    v_exp_f32 v33, v17
    v_mfma_f32_16x16x32_bf16 v[208:211], v[76:79], v[48:51], 0
    ds_read_b128 v[64:67], v6 offset:20480
    s_cselect_b32 s30, 98304, 0
    v_mfma_f32_16x16x32_bf16 v[212:215], v[76:79], v[52:55], 0
    v_exp_f32 v34, v18
    v_mfma_f32_16x16x32_bf16 v[220:223], v[80:83], v[52:55], 0
    ds_read_b128 v[68:71], v6 offset:21504
    s_sub_u32 s23, s23, s30
    v_mfma_f32_16x16x32_bf16 v[216:219], v[80:83], v[48:51], 0
    s_add_u32 s24, s24, 32768
    s_waitcnt lgkmcnt(6)
    v_mfma_f32_16x16x32_bf16 v[224:227], v[84:87], v[48:51], 0
    ds_read_b128 v[72:75], v6 offset:22528
    s_cmp_ge_u32 s24, 163840
    v_mfma_f32_16x16x32_bf16 v[228:231], v[84:87], v[52:55], 0
    v_exp_f32 v35, v19
    v_mfma_f32_16x16x32_bf16 v[236:239], v[88:91], v[52:55], 0
    ds_read_b128 v[76:79], v6 offset:23552
    s_cselect_b32 s24, 65536, s24
    v_mfma_f32_16x16x32_bf16 v[232:235], v[88:91], v[48:51], 0
    v_exp_f32 v36, v20
    v_mfma_f32_16x16x32_bf16 v[240:243], v[92:95], v[48:51], 0
    ds_read_b128 v[80:83], v6 offset:24576
    s_sub_u32 s25, s25, 1
    v_mfma_f32_16x16x32_bf16 v[244:247], v[92:95], v[52:55], 0
    v_exp_f32 v37, v21
    v_mfma_f32_16x16x32_bf16 v[252:255], v[96:99], v[52:55], 0
    ds_read_b128 v[84:87], v6 offset:25600
    v_mfma_f32_16x16x32_bf16 v[248:251], v[96:99], v[48:51], 0
    s_waitcnt lgkmcnt(6)
    v_mfma_f32_16x16x32_bf16 a[128:131], v[100:103], v[48:51], 0
    ds_read_b128 v[88:91], v6 offset:26624
    v_mfma_f32_16x16x32_bf16 a[132:135], v[100:103], v[52:55], 0
    v_exp_f32 v38, v22
    v_mfma_f32_16x16x32_bf16 a[140:143], v[104:107], v[52:55], 0
    ds_read_b128 v[92:95], v6 offset:27648
    v_mfma_f32_16x16x32_bf16 a[136:139], v[104:107], v[48:51], 0
    v_exp_f32 v39, v23
    v_mfma_f32_16x16x32_bf16 a[144:147], v[108:111], v[48:51], 0
    ds_read_b128 v[96:99], v6 offset:28672
    v_mfma_f32_16x16x32_bf16 a[148:151], v[108:111], v[52:55], 0
    s_waitcnt vmcnt(1)
    s_barrier
    v_mfma_f32_16x16x32_bf16 a[156:159], v[112:115], v[52:55], 0
    ds_read_b128 v[100:103], v6 offset:29696
    v_mfma_f32_16x16x32_bf16 a[152:155], v[112:115], v[48:51], 0
    s_waitcnt lgkmcnt(6)
    v_mfma_f32_16x16x32_bf16 a[160:163], v[64:67], v[48:51], 0
    ds_read_b128 v[104:107], v6 offset:30720
    v_mfma_f32_16x16x32_bf16 a[164:167], v[64:67], v[52:55], 0
    v_exp_f32 v40, v24
    v_mfma_f32_16x16x32_bf16 a[172:175], v[68:71], v[52:55], 0
    ds_read_b128 v[108:111], v6 offset:31744
    v_mfma_f32_16x16x32_bf16 a[168:171], v[68:71], v[48:51], 0
    v_exp_f32 v41, v25
    v_mfma_f32_16x16x32_bf16 a[176:179], v[72:75], v[48:51], 0
    ds_read_b128 v[64:67], v5 offset:0
    v_mfma_f32_16x16x32_bf16 a[180:183], v[72:75], v[52:55], 0
    v_exp_f32 v42, v26
    v_mfma_f32_16x16x32_bf16 a[188:191], v[76:79], v[52:55], 0
    ds_read_b128 v[68:71], v5 offset:2048
    v_add_u32 v6, s24, v124
    v_mfma_f32_16x16x32_bf16 a[184:187], v[76:79], v[48:51], 0
    s_waitcnt lgkmcnt(6)
    v_mfma_f32_16x16x32_bf16 a[192:195], v[80:83], v[48:51], 0
    ds_read_b128 v[72:75], v5 offset:4096
    v_mfma_f32_16x16x32_bf16 a[196:199], v[80:83], v[52:55], 0
    v_exp_f32 v43, v27
    v_mfma_f32_16x16x32_bf16 a[204:207], v[84:87], v[52:55], 0
    ds_read_b128 v[76:79], v5 offset:6144
    v_mfma_f32_16x16x32_bf16 a[200:203], v[84:87], v[48:51], 0
    v_exp_f32 v44, v28
    v_mfma_f32_16x16x32_bf16 a[208:211], v[88:91], v[48:51], 0
    ds_read_b128 v[80:83], v5 offset:8192
    v_mfma_f32_16x16x32_bf16 a[212:215], v[88:91], v[52:55], 0
    v_exp_f32 v45, v29
    v_mfma_f32_16x16x32_bf16 a[220:223], v[92:95], v[52:55], 0
    ds_read_b128 v[84:87], v5 offset:10240
    v_mfma_f32_16x16x32_bf16 a[216:219], v[92:95], v[48:51], 0
    s_waitcnt lgkmcnt(6)
    v_mfma_f32_16x16x32_bf16 a[224:227], v[96:99], v[48:51], 0
    ds_read_b128 v[88:91], v5 offset:12288
    v_mfma_f32_16x16x32_bf16 a[228:231], v[96:99], v[52:55], 0
    v_exp_f32 v46, v30
    v_mfma_f32_16x16x32_bf16 a[236:239], v[100:103], v[52:55], 0
    ds_read_b128 v[92:95], v5 offset:14336
    v_mfma_f32_16x16x32_bf16 a[232:235], v[100:103], v[48:51], 0
    v_exp_f32 v47, v31
    v_mfma_f32_16x16x32_bf16 a[240:243], v[104:107], v[48:51], 0
    ds_read_b128 v[96:99], v5 offset:16384
    v_mfma_f32_16x16x32_bf16 a[244:247], v[104:107], v[52:55], 0
    v_mfma_f32_16x16x32_bf16 a[252:255], v[108:111], v[52:55], 0
    ds_read_b128 v[100:103], v5 offset:18432
    v_mfma_f32_16x16x32_bf16 a[248:251], v[108:111], v[48:51], 0
    s_cbranch_vccnz L_r2F
L_r2bF:
    .p2align 6
L_loop:
    s_waitcnt lgkmcnt(6)
    v_mfma_f32_16x16x32_bf16 v[16:19], v[64:67], a[0:3], v[56:59]
    ds_read_b128 v[104:107], v5 offset:20480
    s_mov_b32 m0, s22
    v_mfma_f32_16x16x32_bf16 v[16:19], v[68:71], a[8:11], v[16:19]
    buffer_load_dwordx4 v1, s[8:11], s20 offen offset:0 sc1 lds
    v_mfma_f32_16x16x32_bf16 v[20:23], v[64:67], a[4:7], v[60:63]
    ds_read_b128 v[108:111], v5 offset:22528
    v_cvt_pk_bf16_f32 v48, v32, v33
    v_mfma_f32_16x16x32_bf16 v[20:23], v[68:71], a[12:15], v[20:23]
    v_cvt_pk_bf16_f32 v49, v34, v35
    v_cvt_pk_bf16_f32 v50, v40, v41
    v_mfma_f32_16x16x32_bf16 v[20:23], v[72:75], a[20:23], v[20:23]
    ds_read_b128 v[112:115], v5 offset:24576
    v_cvt_pk_bf16_f32 v51, v42, v43
    v_mfma_f32_16x16x32_bf16 v[20:23], v[76:79], a[28:31], v[20:23]
    buffer_load_dwordx4 v1, s[8:11], s20 offen offset:1024 sc1 lds
    v_mfma_f32_16x16x32_bf16 v[16:19], v[72:75], a[16:19], v[16:19]
    ds_read_b128 v[64:67], v5 offset:26624
    v_cvt_pk_bf16_f32 v52, v36, v37
    v_mfma_f32_16x16x32_bf16 v[16:19], v[76:79], a[24:27], v[16:19]
    v_cvt_pk_bf16_f32 v53, v38, v39
    s_waitcnt lgkmcnt(6)
    v_mfma_f32_16x16x32_bf16 v[16:19], v[80:83], a[32:35], v[16:19]
    ds_read_b128 v[68:71], v5 offset:28672
    v_cvt_pk_bf16_f32 v54, v44, v45
    v_mfma_f32_16x16x32_bf16 v[16:19], v[84:87], a[40:43], v[16:19]
    buffer_load_dwordx4 v1, s[8:11], s20 offen offset:2048 sc1 lds
    v_mfma_f32_16x16x32_bf16 v[20:23], v[80:83], a[36:39], v[20:23]
    ds_read_b128 v[72:75], v5 offset:30720
    v_cvt_pk_bf16_f32 v55, v46, v47
    v_mfma_f32_16x16x32_bf16 v[20:23], v[84:87], a[44:47], v[20:23]
    v_add_f32 v8, v8, v32
    v_add_f32 v8, v8, v33
    v_mfma_f32_16x16x32_bf16 v[20:23], v[88:91], a[52:55], v[20:23]
    ds_read_b128 v[76:79], v5 offset:1024
    v_add_f32 v8, v8, v34
    v_mfma_f32_16x16x32_bf16 v[20:23], v[92:95], a[60:63], v[20:23]
    buffer_load_dwordx4 v1, s[8:11], s20 offen offset:3072 sc1 lds
    v_mfma_f32_16x16x32_bf16 v[16:19], v[88:91], a[48:51], v[16:19]
    ds_read_b128 v[80:83], v5 offset:3072
    v_add_f32 v8, v8, v35
    v_mfma_f32_16x16x32_bf16 v[16:19], v[92:95], a[56:59], v[16:19]
    v_add_f32 v9, v9, v36
    s_waitcnt lgkmcnt(6)
    v_mfma_f32_16x16x32_bf16 v[16:19], v[96:99], a[64:67], v[16:19]
    ds_read_b128 v[84:87], v5 offset:5120
    s_add_u32 m0, s22, 4096
    v_mfma_f32_16x16x32_bf16 v[16:19], v[100:103], a[72:75], v[16:19]
    buffer_load_dwordx4 v2, s[8:11], s20 offen offset:0 sc1 lds
    v_mfma_f32_16x16x32_bf16 v[20:23], v[96:99], a[68:71], v[20:23]
    ds_read_b128 v[88:91], v5 offset:7168
    v_add_f32 v9, v9, v37
    v_mfma_f32_16x16x32_bf16 v[20:23], v[100:103], a[76:79], v[20:23]
    v_add_f32 v9, v9, v38
    v_add_f32 v9, v9, v39
    v_mfma_f32_16x16x32_bf16 v[20:23], v[104:107], a[84:87], v[20:23]
    ds_read_b128 v[92:95], v5 offset:9216
    v_add_f32 v8, v8, v40
    v_mfma_f32_16x16x32_bf16 v[20:23], v[108:111], a[92:95], v[20:23]
    buffer_load_dwordx4 v2, s[8:11], s20 offen offset:1024 sc1 lds
    v_mfma_f32_16x16x32_bf16 v[16:19], v[104:107], a[80:83], v[16:19]
    ds_read_b128 v[96:99], v5 offset:11264
    v_add_f32 v8, v8, v41
    v_mfma_f32_16x16x32_bf16 v[16:19], v[108:111], a[88:91], v[16:19]
    v_add_f32 v8, v8, v42
    s_waitcnt lgkmcnt(6)
    v_mfma_f32_16x16x32_bf16 v[16:19], v[112:115], a[96:99], v[16:19]
    ds_read_b128 v[100:103], v5 offset:13312
    v_add_f32 v8, v8, v43
    v_mfma_f32_16x16x32_bf16 v[16:19], v[64:67], a[104:107], v[16:19]
    buffer_load_dwordx4 v2, s[8:11], s20 offen offset:2048 sc1 lds
    v_mfma_f32_16x16x32_bf16 v[20:23], v[112:115], a[100:103], v[20:23]
    ds_read_b128 v[104:107], v5 offset:15360
    v_add_f32 v9, v9, v44
    v_mfma_f32_16x16x32_bf16 v[20:23], v[64:67], a[108:111], v[20:23]
    v_add_f32 v9, v9, v45
    v_add_f32 v9, v9, v46
    v_mfma_f32_16x16x32_bf16 v[20:23], v[68:71], a[116:119], v[20:23]
    ds_read_b128 v[108:111], v5 offset:17408
    v_add_f32 v9, v9, v47
    v_mfma_f32_16x16x32_bf16 v[20:23], v[72:75], a[124:127], v[20:23]
    buffer_load_dwordx4 v2, s[8:11], s20 offen offset:3072 sc1 lds
    v_mfma_f32_16x16x32_bf16 v[16:19], v[68:71], a[112:115], v[16:19]
    ds_read_b128 v[112:115], v5 offset:19456
    v_mfma_f32_16x16x32_bf16 v[16:19], v[72:75], a[120:123], v[16:19]
    s_waitcnt lgkmcnt(6)
    v_mfma_f32_16x16x32_bf16 v[24:27], v[76:79], a[0:3], v[56:59]
    ds_read_b128 v[64:67], v5 offset:21504
    s_mov_b32 m0, s23
    v_mfma_f32_16x16x32_bf16 v[24:27], v[80:83], a[8:11], v[24:27]
    buffer_load_dwordx4 v3, s[8:11], s21 offen offset:0 sc1 lds
    v_mfma_f32_16x16x32_bf16 v[28:31], v[76:79], a[4:7], v[60:63]
    ds_read_b128 v[68:71], v5 offset:23552
    v_mfma_f32_16x16x32_bf16 v[28:31], v[80:83], a[12:15], v[28:31]
    v_mfma_f32_16x16x32_bf16 v[28:31], v[84:87], a[20:23], v[28:31]
    ds_read_b128 v[72:75], v5 offset:25600
    v_mfma_f32_16x16x32_bf16 v[28:31], v[88:91], a[28:31], v[28:31]
    buffer_load_dwordx4 v3, s[8:11], s21 offen offset:1024 sc1 lds
    v_mfma_f32_16x16x32_bf16 v[24:27], v[84:87], a[16:19], v[24:27]
    ds_read_b128 v[76:79], v5 offset:27648
    v_mfma_f32_16x16x32_bf16 v[24:27], v[88:91], a[24:27], v[24:27]
    s_waitcnt lgkmcnt(6)
    v_mfma_f32_16x16x32_bf16 v[24:27], v[92:95], a[32:35], v[24:27]
    ds_read_b128 v[80:83], v5 offset:29696
    v_mfma_f32_16x16x32_bf16 v[24:27], v[96:99], a[40:43], v[24:27]
    buffer_load_dwordx4 v3, s[8:11], s21 offen offset:2048 sc1 lds
    v_mfma_f32_16x16x32_bf16 v[28:31], v[92:95], a[36:39], v[28:31]
    ds_read_b128 v[84:87], v5 offset:31744
    v_mfma_f32_16x16x32_bf16 v[28:31], v[96:99], a[44:47], v[28:31]
    v_mfma_f32_16x16x32_bf16 v[28:31], v[100:103], a[52:55], v[28:31]
    ds_read_b128 v[88:91], v6 offset:0
    v_mfma_f32_16x16x32_bf16 v[28:31], v[104:107], a[60:63], v[28:31]
    buffer_load_dwordx4 v3, s[8:11], s21 offen offset:3072 sc1 lds
    v_mfma_f32_16x16x32_bf16 v[24:27], v[100:103], a[48:51], v[24:27]
    ds_read_b128 v[92:95], v6 offset:1024
    v_xor_b32 v5, 0x8000, v5
    v_mfma_f32_16x16x32_bf16 v[24:27], v[104:107], a[56:59], v[24:27]
    s_waitcnt lgkmcnt(6)
    v_mfma_f32_16x16x32_bf16 v[24:27], v[108:111], a[64:67], v[24:27]
    ds_read_b128 v[96:99], v6 offset:2048
    s_add_u32 m0, s23, 4096
    v_mfma_f32_16x16x32_bf16 v[24:27], v[112:115], a[72:75], v[24:27]
    buffer_load_dwordx4 v4, s[8:11], s21 offen offset:0 sc1 lds
    v_mfma_f32_16x16x32_bf16 v[28:31], v[108:111], a[68:71], v[28:31]
    ds_read_b128 v[100:103], v6 offset:3072
    v_mfma_f32_16x16x32_bf16 v[28:31], v[112:115], a[76:79], v[28:31]
    v_mfma_f32_16x16x32_bf16 v[28:31], v[64:67], a[84:87], v[28:31]
    ds_read_b128 v[104:107], v6 offset:4096
    v_mfma_f32_16x16x32_bf16 v[28:31], v[68:71], a[92:95], v[28:31]
    buffer_load_dwordx4 v4, s[8:11], s21 offen offset:1024 sc1 lds
    v_mfma_f32_16x16x32_bf16 v[24:27], v[64:67], a[80:83], v[24:27]
    ds_read_b128 v[108:111], v6 offset:5120
    v_mfma_f32_16x16x32_bf16 v[24:27], v[68:71], a[88:91], v[24:27]
    s_waitcnt lgkmcnt(6)
    v_mfma_f32_16x16x32_bf16 v[24:27], v[72:75], a[96:99], v[24:27]
    ds_read_b128 v[112:115], v6 offset:6144
    v_mfma_f32_16x16x32_bf16 v[24:27], v[76:79], a[104:107], v[24:27]
    buffer_load_dwordx4 v4, s[8:11], s21 offen offset:2048 sc1 lds
    v_mfma_f32_16x16x32_bf16 v[28:31], v[72:75], a[100:103], v[28:31]
    ds_read_b128 v[64:67], v6 offset:7168
    v_mfma_f32_16x16x32_bf16 v[28:31], v[76:79], a[108:111], v[28:31]
    v_mfma_f32_16x16x32_bf16 v[28:31], v[80:83], a[116:119], v[28:31]
    ds_read_b128 v[68:71], v6 offset:8192
    v_mfma_f32_16x16x32_bf16 v[28:31], v[84:87], a[124:127], v[28:31]
    buffer_load_dwordx4 v4, s[8:11], s21 offen offset:3072 sc1 lds
    v_mfma_f32_16x16x32_bf16 v[24:27], v[80:83], a[112:115], v[24:27]
    ds_read_b128 v[72:75], v6 offset:9216
    v_mfma_f32_16x16x32_bf16 v[24:27], v[84:87], a[120:123], v[24:27]
    s_waitcnt lgkmcnt(6)
    v_mfma_f32_16x16x32_bf16 v[128:131], v[88:91], v[48:51], v[128:131]
    ds_read_b128 v[76:79], v6 offset:10240
    v_mfma_f32_16x16x32_bf16 v[132:135], v[88:91], v[52:55], v[132:135]
    buffer_load_dword v117, v116, s[96:99], s44 offen sc1
    v_mfma_f32_16x16x32_bf16 v[140:143], v[92:95], v[52:55], v[140:143]
    ds_read_b128 v[80:83], v6 offset:11264
    s_add_u32 s20, s20, 32768
    v_mfma_f32_16x16x32_bf16 v[136:139], v[92:95], v[48:51], v[136:139]
    s_add_u32 s44, s44, s45
    s_add_u32 s21, s21, 32768
    v_mfma_f32_16x16x32_bf16 v[144:147], v[96:99], v[48:51], v[144:147]
    ds_read_b128 v[84:87], v6 offset:12288
    v_max3_f32 v10, v16, v17, v18
    v_mfma_f32_16x16x32_bf16 v[148:151], v[96:99], v[52:55], v[148:151]
    v_max3_f32 v10, v10, v19, v20
    v_max3_f32 v10, v10, v21, v22
    v_mfma_f32_16x16x32_bf16 v[156:159], v[100:103], v[52:55], v[156:159]
    ds_read_b128 v[88:91], v6 offset:13312
    v_max3_f32 v10, v10, v23, v24
    v_mfma_f32_16x16x32_bf16 v[152:155], v[100:103], v[48:51], v[152:155]
    v_max3_f32 v10, v10, v25, v26
    s_waitcnt lgkmcnt(6)
    v_mfma_f32_16x16x32_bf16 v[160:163], v[104:107], v[48:51], v[160:163]
    ds_read_b128 v[92:95], v6 offset:14336
    v_max3_f32 v10, v10, v27, v28
    v_mfma_f32_16x16x32_bf16 v[164:167], v[104:107], v[52:55], v[164:167]
    v_max3_f32 v10, v10, v29, v30
    v_max_f32 v10, v10, v31
    v_mfma_f32_16x16x32_bf16 v[172:175], v[108:111], v[52:55], v[172:175]
    ds_read_b128 v[96:99], v6 offset:15360
    v_cmp_lt_f32 vcc, 0x41800000, v10
    v_mfma_f32_16x16x32_bf16 v[168:171], v[108:111], v[48:51], v[168:171]
    s_xor_b32 s22, s22, 32768
    s_add_u32 s23, s23, 32768
    v_mfma_f32_16x16x32_bf16 v[176:179], v[112:115], v[48:51], v[176:179]
    ds_read_b128 v[100:103], v6 offset:16384
    s_cmp_ge_u32 s23, 163840
    v_mfma_f32_16x16x32_bf16 v[180:183], v[112:115], v[52:55], v[180:183]
    s_cselect_b32 s30, 98304, 0
    s_sub_u32 s23, s23, s30
    v_mfma_f32_16x16x32_bf16 v[188:191], v[64:67], v[52:55], v[188:191]
    ds_read_b128 v[104:107], v6 offset:17408
    s_cbranch_vccnz L_r1M
L_r1bM:
    v_mfma_f32_16x16x32_bf16 v[184:187], v[64:67], v[48:51], v[184:187]
    s_add_u32 s24, s24, 32768
    s_waitcnt lgkmcnt(6)
    v_mfma_f32_16x16x32_bf16 v[192:195], v[68:71], v[48:51], v[192:195]
    ds_read_b128 v[108:111], v6 offset:18432
    s_cmp_ge_u32 s24, 163840
    v_mfma_f32_16x16x32_bf16 v[196:199], v[68:71], v[52:55], v[196:199]
    v_exp_f32 v32, v16
    v_mfma_f32_16x16x32_bf16 v[204:207], v[72:75], v[52:55], v[204:207]
    ds_read_b128 v[112:115], v6 offset:19456
    s_cselect_b32 s24, 65536, s24
    v_mfma_f32_16x16x32_bf16 v[200:203], v[72:75], v[48:51], v[200:203]
    v_exp_f32 v33, v17
    v_mfma_f32_16x16x32_bf16 v[208:211], v[76:79], v[48:51], v[208:211]
    ds_read_b128 v[64:67], v6 offset:20480
    s_sub_u32 s25, s25, 1
    v_mfma_f32_16x16x32_bf16 v[212:215], v[76:79], v[52:55], v[212:215]
    v_exp_f32 v34, v18
    v_mfma_f32_16x16x32_bf16 v[220:223], v[80:83], v[52:55], v[220:223]
    ds_read_b128 v[68:71], v6 offset:21504
    v_mfma_f32_16x16x32_bf16 v[216:219], v[80:83], v[48:51], v[216:219]
    s_waitcnt lgkmcnt(6)
    v_mfma_f32_16x16x32_bf16 v[224:227], v[84:87], v[48:51], v[224:227]
    ds_read_b128 v[72:75], v6 offset:22528
    v_mfma_f32_16x16x32_bf16 v[228:231], v[84:87], v[52:55], v[228:231]
    v_exp_f32 v35, v19
    v_mfma_f32_16x16x32_bf16 v[236:239], v[88:91], v[52:55], v[236:239]
    ds_read_b128 v[76:79], v6 offset:23552
    v_mfma_f32_16x16x32_bf16 v[232:235], v[88:91], v[48:51], v[232:235]
    v_exp_f32 v36, v20
    v_mfma_f32_16x16x32_bf16 v[240:243], v[92:95], v[48:51], v[240:243]
    ds_read_b128 v[80:83], v6 offset:24576
    v_mfma_f32_16x16x32_bf16 v[244:247], v[92:95], v[52:55], v[244:247]
    v_exp_f32 v37, v21
    v_mfma_f32_16x16x32_bf16 v[252:255], v[96:99], v[52:55], v[252:255]
    ds_read_b128 v[84:87], v6 offset:25600
    v_mfma_f32_16x16x32_bf16 v[248:251], v[96:99], v[48:51], v[248:251]
    s_waitcnt lgkmcnt(6)
    v_mfma_f32_16x16x32_bf16 a[128:131], v[100:103], v[48:51], a[128:131]
    ds_read_b128 v[88:91], v6 offset:26624
    v_mfma_f32_16x16x32_bf16 a[132:135], v[100:103], v[52:55], a[132:135]
    v_exp_f32 v38, v22
    v_mfma_f32_16x16x32_bf16 a[140:143], v[104:107], v[52:55], a[140:143]
    ds_read_b128 v[92:95], v6 offset:27648
    v_mfma_f32_16x16x32_bf16 a[136:139], v[104:107], v[48:51], a[136:139]
    v_exp_f32 v39, v23
    v_mfma_f32_16x16x32_bf16 a[144:147], v[108:111], v[48:51], a[144:147]
    ds_read_b128 v[96:99], v6 offset:28672
    v_mfma_f32_16x16x32_bf16 a[148:151], v[108:111], v[52:55], a[148:151]
    s_waitcnt vmcnt(1)
    s_barrier
    v_mfma_f32_16x16x32_bf16 a[156:159], v[112:115], v[52:55], a[156:159]
    ds_read_b128 v[100:103], v6 offset:29696
    v_mfma_f32_16x16x32_bf16 a[152:155], v[112:115], v[48:51], a[152:155]
    s_waitcnt lgkmcnt(6)
    v_mfma_f32_16x16x32_bf16 a[160:163], v[64:67], v[48:51], a[160:163]
    ds_read_b128 v[104:107], v6 offset:30720
    v_mfma_f32_16x16x32_bf16 a[164:167], v[64:67], v[52:55], a[164:167]
    v_exp_f32 v40, v24
    v_mfma_f32_16x16x32_bf16 a[172:175], v[68:71], v[52:55], a[172:175]
    ds_read_b128 v[108:111], v6 offset:31744
    v_mfma_f32_16x16x32_bf16 a[168:171], v[68:71], v[48:51], a[168:171]
    v_exp_f32 v41, v25
    v_mfma_f32_16x16x32_bf16 a[176:179], v[72:75], v[48:51], a[176:179]
    ds_read_b128 v[64:67], v5 offset:0
    v_mfma_f32_16x16x32_bf16 a[180:183], v[72:75], v[52:55], a[180:183]
    v_exp_f32 v42, v26
    v_mfma_f32_16x16x32_bf16 a[188:191], v[76:79], v[52:55], a[188:191]
    ds_read_b128 v[68:71], v5 offset:2048
    v_add_u32 v6, s24, v124
    v_mfma_f32_16x16x32_bf16 a[184:187], v[76:79], v[48:51], a[184:187]
    s_waitcnt lgkmcnt(6)
    v_mfma_f32_16x16x32_bf16 a[192:195], v[80:83], v[48:51], a[192:195]
    ds_read_b128 v[72:75], v5 offset:4096
    v_mfma_f32_16x16x32_bf16 a[196:199], v[80:83], v[52:55], a[196:199]
    v_exp_f32 v43, v27
    v_mfma_f32_16x16x32_bf16 a[204:207], v[84:87], v[52:55], a[204:207]
    ds_read_b128 v[76:79], v5 offset:6144
    v_mfma_f32_16x16x32_bf16 a[200:203], v[84:87], v[48:51], a[200:203]
    v_exp_f32 v44, v28
    v_mfma_f32_16x16x32_bf16 a[208:211], v[88:91], v[48:51], a[208:211]
    ds_read_b128 v[80:83], v5 offset:8192
    v_mfma_f32_16x16x32_bf16 a[212:215], v[88:91], v[52:55], a[212:215]
    v_exp_f32 v45, v29
    v_mfma_f32_16x16x32_bf16 a[220:223], v[92:95], v[52:55], a[220:223]
    ds_read_b128 v[84:87], v5 offset:10240
    v_mfma_f32_16x16x32_bf16 a[216:219], v[92:95], v[48:51], a[216:219]
    s_waitcnt lgkmcnt(6)
    v_mfma_f32_16x16x32_bf16 a[224:227], v[96:99], v[48:51], a[224:227]
    ds_read_b128 v[88:91], v5 offset:12288
    v_mfma_f32_16x16x32_bf16 a[228:231], v[96:99], v[52:55], a[228:231]
    v_exp_f32 v46, v30
    v_mfma_f32_16x16x32_bf16 a[236:239], v[100:103], v[52:55], a[236:239]
    ds_read_b128 v[92:95], v5 offset:14336
    v_mfma_f32_16x16x32_bf16 a[232:235], v[100:103], v[48:51], a[232:235]
    v_exp_f32 v47, v31
    v_mfma_f32_16x16x32_bf16 a[240:243], v[104:107], v[48:51], a[240:243]
    ds_read_b128 v[96:99], v5 offset:16384
    v_mfma_f32_16x16x32_bf16 a[244:247], v[104:107], v[52:55], a[244:247]
    v_mfma_f32_16x16x32_bf16 a[252:255], v[108:111], v[52:55], a[252:255]
    ds_read_b128 v[100:103], v5 offset:18432
    v_mfma_f32_16x16x32_bf16 a[248:251], v[108:111], v[48:51], a[248:251]
    s_cmp_gt_u32 s25, s55
    s_cbranch_scc1 L_loop
    s_cbranch_vccnz L_r2M
L_r2bM:
    s_mov_b32 s55, 0
    s_cmp_lg_u32 s25, 0
    s_cbranch_scc1 L_loop
    s_add_u32 s46, s46, 1
    s_mov_b32 s25, 1
    s_cmp_eq_u32 s46, 5
    s_cbranch_scc1 L_ph5
    s_cmp_eq_u32 s46, 4
    s_cbranch_scc1 L_ph4
    s_cmp_eq_u32 s46, 3
    s_cbranch_scc1 L_ph3
    s_cmp_eq_u32 s46, 2
    s_cbranch_scc1 L_ph2
    s_mov_b32 s96, s4
    s_mov_b32 s97, s5
    s_mov_b32 s98, 8192000
    v_lshrrev_b32 v116, 1, v0
    v_lshlrev_b32 v116, 10, v116
    v_and_b32 v13, 1, v0
    v_lshl_add_u32 v116, v13, 7, v116
    s_lshl_b32 s44, s27, 15
    s_lshl_b32 s30, s28, 8
    s_add_u32 s44, s44, s30
    s_branch L_loop
L_ph2:
    s_mov_b32 s96, s40
    s_mov_b32 s97, s41
    s_mov_b32 s98, 117440512
    v_and_b32 v118, 7, v0
    v_lshlrev_b32 v118, 7, v118
    v_mov_b32 v116, v118
    s_add_u32 s48, s48, 65536
    s_mov_b32 s44, s48
    s_branch L_loop
L_ph3:
    s_waitcnt vmcnt(0)
    v_cmp_ne_u32 s[38:39], s75, v117
    v_lshlrev_b32 v116, 7, v0
    s_lshl_b32 s44, s28, 13
    s_add_u32 s44, s44, s60
    s_nop 1
    s_cmp_eq_u64 s[38:39], 0
    s_cbranch_scc0 L_cfslow
L_cfok:
    s_branch L_loop
L_ph4:
    v_lshlrev_b32 v116, 6, v0
    s_and_b32 s44, s36, 7
    s_lshl_b32 s44, s44, 2
    s_add_u32 s44, s44, s26
    s_lshl_b32 s44, s44, 12
    s_add_u32 s44, s44, s61
    s_branch L_loop
L_ph5:
    s_waitcnt lgkmcnt(6)
    v_mfma_f32_16x16x32_bf16 v[16:19], v[64:67], a[0:3], v[56:59]
    ds_read_b128 v[104:107], v5 offset:20480
    s_mov_b32 m0, s23
    v_mfma_f32_16x16x32_bf16 v[16:19], v[68:71], a[8:11], v[16:19]
    buffer_load_dwordx4 v3, s[8:11], s21 offen offset:0 sc1 lds
    v_mfma_f32_16x16x32_bf16 v[20:23], v[64:67], a[4:7], v[60:63]
    ds_read_b128 v[108:111], v5 offset:22528
    v_cvt_pk_bf16_f32 v48, v32, v33
    v_mfma_f32_16x16x32_bf16 v[20:23], v[68:71], a[12:15], v[20:23]
    v_cvt_pk_bf16_f32 v49, v34, v35
    v_cvt_pk_bf16_f32 v50, v40, v41
    v_mfma_f32_16x16x32_bf16 v[20:23], v[72:75], a[20:23], v[20:23]
    ds_read_b128 v[112:115], v5 offset:24576
    v_cvt_pk_bf16_f32 v51, v42, v43
    v_mfma_f32_16x16x32_bf16 v[20:23], v[76:79], a[28:31], v[20:23]
    buffer_load_dwordx4 v3, s[8:11], s21 offen offset:1024 sc1 lds
    v_mfma_f32_16x16x32_bf16 v[16:19], v[72:75], a[16:19], v[16:19]
    ds_read_b128 v[64:67], v5 offset:26624
    v_cvt_pk_bf16_f32 v52, v36, v37
    v_mfma_f32_16x16x32_bf16 v[16:19], v[76:79], a[24:27], v[16:19]
    v_cvt_pk_bf16_f32 v53, v38, v39
    s_waitcnt lgkmcnt(6)
    v_mfma_f32_16x16x32_bf16 v[16:19], v[80:83], a[32:35], v[16:19]
    ds_read_b128 v[68:71], v5 offset:28672
    v_cvt_pk_bf16_f32 v54, v44, v45
    v_mfma_f32_16x16x32_bf16 v[16:19], v[84:87], a[40:43], v[16:19]
    buffer_load_dwordx4 v3, s[8:11], s21 offen offset:2048 sc1 lds
    v_mfma_f32_16x16x32_bf16 v[20:23], v[80:83], a[36:39], v[20:23]
    ds_read_b128 v[72:75], v5 offset:30720
    v_cvt_pk_bf16_f32 v55, v46, v47
    v_mfma_f32_16x16x32_bf16 v[20:23], v[84:87], a[44:47], v[20:23]
    v_add_f32 v8, v8, v32
    v_add_f32 v8, v8, v33
    v_mfma_f32_16x16x32_bf16 v[20:23], v[88:91], a[52:55], v[20:23]
    ds_read_b128 v[76:79], v5 offset:1024
    v_add_f32 v8, v8, v34
    v_mfma_f32_16x16x32_bf16 v[20:23], v[92:95], a[60:63], v[20:23]
    buffer_load_dwordx4 v3, s[8:11], s21 offen offset:3072 sc1 lds
    v_mfma_f32_16x16x32_bf16 v[16:19], v[88:91], a[48:51], v[16:19]
    ds_read_b128 v[80:83], v5 offset:3072
    v_add_f32 v8, v8, v35
    v_mfma_f32_16x16x32_bf16 v[16:19], v[92:95], a[56:59], v[16:19]
    v_add_f32 v9, v9, v36
    s_waitcnt lgkmcnt(6)
    v_mfma_f32_16x16x32_bf16 v[16:19], v[96:99], a[64:67], v[16:19]
    ds_read_b128 v[84:87], v5 offset:5120
    s_add_u32 m0, s23, 4096
    v_mfma_f32_16x16x32_bf16 v[16:19], v[100:103], a[72:75], v[16:19]
    buffer_load_dwordx4 v4, s[8:11], s21 offen offset:0 sc1 lds
    v_mfma_f32_16x16x32_bf16 v[20:23], v[96:99], a[68:71], v[20:23]
    ds_read_b128 v[88:91], v5 offset:7168
    v_add_f32 v9, v9, v37
    v_mfma_f32_16x16x32_bf16 v[20:23], v[100:103], a[76:79], v[20:23]
    v_add_f32 v9, v9, v38
    v_add_f32 v9, v9, v39
    v_mfma_f32_16x16x32_bf16 v[20:23], v[104:107], a[84:87], v[20:23]
    ds_read_b128 v[92:95], v5 offset:9216
    v_add_f32 v8, v8, v40
    v_mfma_f32_16x16x32_bf16 v[20:23], v[108:111], a[92:95], v[20:23]
    buffer_load_dwordx4 v4, s[8:11], s21 offen offset:1024 sc1 lds
    v_mfma_f32_16x16x32_bf16 v[16:19], v[104:107], a[80:83], v[16:19]
    ds_read_b128 v[96:99], v5 offset:11264
    v_add_f32 v8, v8, v41
    v_mfma_f32_16x16x32_bf16 v[16:19], v[108:111], a[88:91], v[16:19]
    v_add_f32 v8, v8, v42
    s_waitcnt lgkmcnt(6)
    v_mfma_f32_16x16x32_bf16 v[16:19], v[112:115], a[96:99], v[16:19]
    ds_read_b128 v[100:103], v5 offset:13312
    v_add_f32 v8, v8, v43
    v_mfma_f32_16x16x32_bf16 v[16:19], v[64:67], a[104:107], v[16:19]
    buffer_load_dwordx4 v4, s[8:11], s21 offen offset:2048 sc1 lds
    v_mfma_f32_16x16x32_bf16 v[20:23], v[112:115], a[100:103], v[20:23]
    ds_read_b128 v[104:107], v5 offset:15360
    v_add_f32 v9, v9, v44
    v_mfma_f32_16x16x32_bf16 v[20:23], v[64:67], a[108:111], v[20:23]
    v_add_f32 v9, v9, v45
    v_add_f32 v9, v9, v46
    v_mfma_f32_16x16x32_bf16 v[20:23], v[68:71], a[116:119], v[20:23]
    ds_read_b128 v[108:111], v5 offset:17408
    v_add_f32 v9, v9, v47
    v_mfma_f32_16x16x32_bf16 v[20:23], v[72:75], a[124:127], v[20:23]
    buffer_load_dwordx4 v4, s[8:11], s21 offen offset:3072 sc1 lds
    v_mfma_f32_16x16x32_bf16 v[16:19], v[68:71], a[112:115], v[16:19]
    ds_read_b128 v[112:115], v5 offset:19456
    v_mfma_f32_16x16x32_bf16 v[16:19], v[72:75], a[120:123], v[16:19]
    s_waitcnt lgkmcnt(6)
    v_mfma_f32_16x16x32_bf16 v[24:27], v[76:79], a[0:3], v[56:59]
    ds_read_b128 v[64:67], v5 offset:21504
    s_mov_b32 m0, s22
    v_mfma_f32_16x16x32_bf16 v[24:27], v[80:83], a[8:11], v[24:27]
    buffer_load_dwordx4 v1, s[8:11], s61 offen offset:0 sc1 lds
    v_mfma_f32_16x16x32_bf16 v[28:31], v[76:79], a[4:7], v[60:63]
    ds_read_b128 v[68:71], v5 offset:23552
    v_mfma_f32_16x16x32_bf16 v[28:31], v[80:83], a[12:15], v[28:31]
    v_mfma_f32_16x16x32_bf16 v[28:31], v[84:87], a[20:23], v[28:31]
    ds_read_b128 v[72:75], v5 offset:25600
    v_mfma_f32_16x16x32_bf16 v[28:31], v[88:91], a[28:31], v[28:31]
    buffer_load_dwordx4 v1, s[8:11], s61 offen offset:1024 sc1 lds
    v_mfma_f32_16x16x32_bf16 v[24:27], v[84:87], a[16:19], v[24:27]
    ds_read_b128 v[76:79], v5 offset:27648
    v_mfma_f32_16x16x32_bf16 v[24:27], v[88:91], a[24:27], v[24:27]
    s_waitcnt lgkmcnt(6)
    v_mfma_f32_16x16x32_bf16 v[24:27], v[92:95], a[32:35], v[24:27]
    ds_read_b128 v[80:83], v5 offset:29696
    v_mfma_f32_16x16x32_bf16 v[24:27], v[96:99], a[40:43], v[24:27]
    buffer_load_dwordx4 v1, s[8:11], s61 offen offset:2048 sc1 lds
    v_mfma_f32_16x16x32_bf16 v[28:31], v[92:95], a[36:39], v[28:31]
    ds_read_b128 v[84:87], v5 offset:31744
    v_mfma_f32_16x16x32_bf16 v[28:31], v[96:99], a[44:47], v[28:31]
    v_mfma_f32_16x16x32_bf16 v[28:31], v[100:103], a[52:55], v[28:31]
    ds_read_b128 v[88:91], v6 offset:0
    v_mfma_f32_16x16x32_bf16 v[28:31], v[104:107], a[60:63], v[28:31]
    buffer_load_dwordx4 v1, s[8:11], s61 offen offset:3072 sc1 lds
    v_mfma_f32_16x16x32_bf16 v[24:27], v[100:103], a[48:51], v[24:27]
    ds_read_b128 v[92:95], v6 offset:1024
    s_sub_u32 s20, s23, s33
    v_mfma_f32_16x16x32_bf16 v[24:27], v[104:107], a[56:59], v[24:27]
    v_add_u32 v5, s20, v7
    s_waitcnt lgkmcnt(6)
    v_mfma_f32_16x16x32_bf16 v[24:27], v[108:111], a[64:67], v[24:27]
    ds_read_b128 v[96:99], v6 offset:2048
    s_add_u32 m0, s22, 4096
    v_mfma_f32_16x16x32_bf16 v[24:27], v[112:115], a[72:75], v[24:27]
    buffer_load_dwordx4 v2, s[8:11], s61 offen offset:0 sc1 lds
    v_mfma_f32_16x16x32_bf16 v[28:31], v[108:111], a[68:71], v[28:31]
    ds_read_b128 v[100:103], v6 offset:3072
    s_sub_u32 s56, s22, s33
    v_mfma_f32_16x16x32_bf16 v[28:31], v[112:115], a[76:79], v[28:31]
    s_xor_b32 s57, s56, 32768
    v_mfma_f32_16x16x32_bf16 v[28:31], v[64:67], a[84:87], v[28:31]
    ds_read_b128 v[104:107], v6 offset:4096
    s_mov_b32 s59, s24
    v_mfma_f32_16x16x32_bf16 v[28:31], v[68:71], a[92:95], v[28:31]
    buffer_load_dwordx4 v2, s[8:11], s61 offen offset:1024 sc1 lds
    v_mfma_f32_16x16x32_bf16 v[24:27], v[64:67], a[80:83], v[24:27]
    ds_read_b128 v[108:111], v6 offset:5120
    s_add_u32 s58, s59, s20
    v_mfma_f32_16x16x32_bf16 v[24:27], v[68:71], a[88:91], v[24:27]
    s_sub_u32 s58, 294912, s58
    s_waitcnt lgkmcnt(6)
    v_mfma_f32_16x16x32_bf16 v[24:27], v[72:75], a[96:99], v[24:27]
    ds_read_b128 v[112:115], v6 offset:6144
    v_mfma_f32_16x16x32_bf16 v[24:27], v[76:79], a[104:107], v[24:27]
    buffer_load_dwordx4 v2, s[8:11], s61 offen offset:2048 sc1 lds
    v_mfma_f32_16x16x32_bf16 v[28:31], v[72:75], a[100:103], v[28:31]
    ds_read_b128 v[64:67], v6 offset:7168
    v_mfma_f32_16x16x32_bf16 v[28:31], v[76:79], a[108:111], v[28:31]
    v_mfma_f32_16x16x32_bf16 v[28:31], v[80:83], a[116:119], v[28:31]
    ds_read_b128 v[68:71], v6 offset:8192
    v_mfma_f32_16x16x32_bf16 v[28:31], v[84:87], a[124:127], v[28:31]
    buffer_load_dwordx4 v2, s[8:11], s61 offen offset:3072 sc1 lds
    v_mfma_f32_16x16x32_bf16 v[24:27], v[80:83], a[112:115], v[24:27]
    ds_read_b128 v[72:75], v6 offset:9216
    v_mfma_f32_16x16x32_bf16 v[24:27], v[84:87], a[120:123], v[24:27]
    s_waitcnt lgkmcnt(6)
    v_mfma_f32_16x16x32_bf16 v[128:131], v[88:91], v[48:51], v[128:131]
    ds_read_b128 v[76:79], v6 offset:10240
    v_mfma_f32_16x16x32_bf16 v[132:135], v[88:91], v[52:55], v[132:135]
    v_mfma_f32_16x16x32_bf16 v[140:143], v[92:95], v[52:55], v[140:143]
    ds_read_b128 v[80:83], v6 offset:11264
    buffer_load_dwordx4 a[0:3], v7, s[76:79], s60 offen offset:0 sc1
    v_mfma_f32_16x16x32_bf16 v[136:139], v[92:95], v[48:51], v[136:139]
    v_mfma_f32_16x16x32_bf16 v[144:147], v[96:99], v[48:51], v[144:147]
    ds_read_b128 v[84:87], v6 offset:12288
    v_max3_f32 v10, v16, v17, v18
    v_mfma_f32_16x16x32_bf16 v[148:151], v[96:99], v[52:55], v[148:151]
    v_max3_f32 v10, v10, v19, v20
    v_max3_f32 v10, v10, v21, v22
    v_mfma_f32_16x16x32_bf16 v[156:159], v[100:103], v[52:55], v[156:159]
    ds_read_b128 v[88:91], v6 offset:13312
    v_max3_f32 v10, v10, v23, v24
    buffer_load_dwordx4 a[4:7], v7, s[76:79], s60 offen offset:1024 sc1
    v_mfma_f32_16x16x32_bf16 v[152:155], v[100:103], v[48:51], v[152:155]
    v_max3_f32 v10, v10, v25, v26
    s_waitcnt lgkmcnt(6)
    v_mfma_f32_16x16x32_bf16 v[160:163], v[104:107], v[48:51], v[160:163]
    ds_read_b128 v[92:95], v6 offset:14336
    v_max3_f32 v10, v10, v27, v28
    v_mfma_f32_16x16x32_bf16 v[164:167], v[104:107], v[52:55], v[164:167]
    v_max3_f32 v10, v10, v29, v30
    v_max_f32 v10, v10, v31
    v_mfma_f32_16x16x32_bf16 v[172:175], v[108:111], v[52:55], v[172:175]
    ds_read_b128 v[96:99], v6 offset:15360
    v_cmp_lt_f32 vcc, 0x41800000, v10
    buffer_load_dwordx4 a[8:11], v7, s[76:79], s60 offen offset:2048 sc1
    v_mfma_f32_16x16x32_bf16 v[168:171], v[108:111], v[48:51], v[168:171]
    v_mfma_f32_16x16x32_bf16 v[176:179], v[112:115], v[48:51], v[176:179]
    ds_read_b128 v[100:103], v6 offset:16384
    v_mfma_f32_16x16x32_bf16 v[180:183], v[112:115], v[52:55], v[180:183]
    v_mfma_f32_16x16x32_bf16 v[188:191], v[64:67], v[52:55], v[188:191]
    ds_read_b128 v[104:107], v6 offset:17408
    s_cbranch_vccnz L_r1L
L_r1bL:
    buffer_load_dwordx4 a[12:15], v7, s[76:79], s60 offen offset:3072 sc1
    v_mfma_f32_16x16x32_bf16 v[184:187], v[64:67], v[48:51], v[184:187]
    s_waitcnt lgkmcnt(6)
    v_mfma_f32_16x16x32_bf16 v[192:195], v[68:71], v[48:51], v[192:195]
    ds_read_b128 v[108:111], v6 offset:18432
    v_mfma_f32_16x16x32_bf16 v[196:199], v[68:71], v[52:55], v[196:199]
    v_exp_f32 v32, v16
    v_mfma_f32_16x16x32_bf16 v[204:207], v[72:75], v[52:55], v[204:207]
    ds_read_b128 v[112:115], v6 offset:19456
    s_add_u32 s60, s60, 4096
    buffer_load_dwordx4 a[16:19], v7, s[76:79], s60 offen offset:0 sc1
    v_mfma_f32_16x16x32_bf16 v[200:203], v[72:75], v[48:51], v[200:203]
    v_exp_f32 v33, v17
    v_mfma_f32_16x16x32_bf16 v[208:211], v[76:79], v[48:51], v[208:211]
    ds_read_b128 v[64:67], v6 offset:20480
    v_mfma_f32_16x16x32_bf16 v[212:215], v[76:79], v[52:55], v[212:215]
    v_exp_f32 v34, v18
    v_mfma_f32_16x16x32_bf16 v[220:223], v[80:83], v[52:55], v[220:223]
    ds_read_b128 v[68:71], v6 offset:21504
    buffer_load_dwordx4 a[20:23], v7, s[76:79], s60 offen offset:1024 sc1
    v_mfma_f32_16x16x32_bf16 v[216:219], v[80:83], v[48:51], v[216:219]
    s_waitcnt lgkmcnt(6)
    v_mfma_f32_16x16x32_bf16 v[224:227], v[84:87], v[48:51], v[224:227]
    ds_read_b128 v[72:75], v6 offset:22528
    v_mfma_f32_16x16x32_bf16 v[228:231], v[84:87], v[52:55], v[228:231]
    v_exp_f32 v35, v19
    v_mfma_f32_16x16x32_bf16 v[236:239], v[88:91], v[52:55], v[236:239]
    ds_read_b128 v[76:79], v6 offset:23552
    buffer_load_dwordx4 a[24:27], v7, s[76:79], s60 offen offset:2048 sc1
    v_mfma_f32_16x16x32_bf16 v[232:235], v[88:91], v[48:51], v[232:235]
    v_exp_f32 v36, v20
    v_mfma_f32_16x16x32_bf16 v[240:243], v[92:95], v[48:51], v[240:243]
    ds_read_b128 v[80:83], v6 offset:24576
    v_mfma_f32_16x16x32_bf16 v[244:247], v[92:95], v[52:55], v[244:247]
    v_exp_f32 v37, v21
    v_mfma_f32_16x16x32_bf16 v[252:255], v[96:99], v[52:55], v[252:255]
    ds_read_b128 v[84:87], v6 offset:25600
    buffer_load_dwordx4 a[28:31], v7, s[76:79], s60 offen offset:3072 sc1
    v_mfma_f32_16x16x32_bf16 v[248:251], v[96:99], v[48:51], v[248:251]
    s_waitcnt lgkmcnt(6)
    v_mfma_f32_16x16x32_bf16 a[128:131], v[100:103], v[48:51], a[128:131]
    ds_read_b128 v[88:91], v6 offset:26624
    v_mfma_f32_16x16x32_bf16 a[132:135], v[100:103], v[52:55], a[132:135]
    v_exp_f32 v38, v22
    v_mfma_f32_16x16x32_bf16 a[140:143], v[104:107], v[52:55], a[140:143]
    ds_read_b128 v[92:95], v6 offset:27648
    s_add_u32 s60, s60, 4096
    buffer_load_dwordx4 a[32:35], v7, s[76:79], s60 offen offset:0 sc1
    v_mfma_f32_16x16x32_bf16 a[136:139], v[104:107], v[48:51], a[136:139]
    v_exp_f32 v39, v23
    v_mfma_f32_16x16x32_bf16 a[144:147], v[108:111], v[48:51], a[144:147]
    ds_read_b128 v[96:99], v6 offset:28672
    v_mfma_f32_16x16x32_bf16 a[148:151], v[108:111], v[52:55], a[148:151]
    s_waitcnt vmcnt(9)
    s_barrier
    v_mfma_f32_16x16x32_bf16 a[156:159], v[112:115], v[52:55], a[156:159]
    ds_read_b128 v[100:103], v6 offset:29696
    buffer_load_dwordx4 a[36:39], v7, s[76:79], s60 offen offset:1024 sc1
    v_mfma_f32_16x16x32_bf16 a[152:155], v[112:115], v[48:51], a[152:155]
    s_waitcnt lgkmcnt(6)
    v_mfma_f32_16x16x32_bf16 a[160:163], v[64:67], v[48:51], a[160:163]
    ds_read_b128 v[104:107], v6 offset:30720
    v_mfma_f32_16x16x32_bf16 a[164:167], v[64:67], v[52:55], a[164:167]
    v_exp_f32 v40, v24
    v_mfma_f32_16x16x32_bf16 a[172:175], v[68:71], v[52:55], a[172:175]
    ds_read_b128 v[108:111], v6 offset:31744
    buffer_load_dwordx4 a[40:43], v7, s[76:79], s60 offen offset:2048 sc1
    v_mfma_f32_16x16x32_bf16 a[168:171], v[68:71], v[48:51], a[168:171]
    v_exp_f32 v41, v25
    v_mfma_f32_16x16x32_bf16 a[176:179], v[72:75], v[48:51], a[176:179]
    ds_read_b128 v[64:67], v5 offset:8192
    v_mfma_f32_16x16x32_bf16 a[180:183], v[72:75], v[52:55], a[180:183]
    v_exp_f32 v42, v26
    v_mfma_f32_16x16x32_bf16 a[188:191], v[76:79], v[52:55], a[188:191]
    ds_read_b128 v[68:71], v5 offset:9216
    buffer_load_dwordx4 a[44:47], v7, s[76:79], s60 offen offset:3072 sc1
    v_mfma_f32_16x16x32_bf16 a[184:187], v[76:79], v[48:51], a[184:187]
    s_waitcnt lgkmcnt(6)
    v_mfma_f32_16x16x32_bf16 a[192:195], v[80:83], v[48:51], a[192:195]
    ds_read_b128 v[72:75], v5 offset:10240
    v_mfma_f32_16x16x32_bf16 a[196:199], v[80:83], v[52:55], a[196:199]
    v_exp_f32 v43, v27
    v_mfma_f32_16x16x32_bf16 a[204:207], v[84:87], v[52:55], a[204:207]
    ds_read_b128 v[76:79], v5 offset:11264
    s_add_u32 s60, s60, 4096
    buffer_load_dwordx4 a[48:51], v7, s[76:79], s60 offen offset:0 sc1
    v_mfma_f32_16x16x32_bf16 a[200:203], v[84:87], v[48:51], a[200:203]
    v_exp_f32 v44, v28
    v_mfma_f32_16x16x32_bf16 a[208:211], v[88:91], v[48:51], a[208:211]
    ds_read_b128 v[80:83], v5 offset:12288
    v_mfma_f32_16x16x32_bf16 a[212:215], v[88:91], v[52:55], a[212:215]
    v_exp_f32 v45, v29
    v_mfma_f32_16x16x32_bf16 a[220:223], v[92:95], v[52:55], a[220:223]
    ds_read_b128 v[84:87], v5 offset:13312
    buffer_load_dwordx4 a[52:55], v7, s[76:79], s60 offen offset:1024 sc1
    v_mfma_f32_16x16x32_bf16 a[216:219], v[92:95], v[48:51], a[216:219]
    s_waitcnt lgkmcnt(6)
    v_mfma_f32_16x16x32_bf16 a[224:227], v[96:99], v[48:51], a[224:227]
    ds_read_b128 v[88:91], v5 offset:14336
    v_mfma_f32_16x16x32_bf16 a[228:231], v[96:99], v[52:55], a[228:231]
    v_exp_f32 v46, v30
    v_mfma_f32_16x16x32_bf16 a[236:239], v[100:103], v[52:55], a[236:239]
    ds_read_b128 v[92:95], v5 offset:15360
    buffer_load_dwordx4 a[56:59], v7, s[76:79], s60 offen offset:2048 sc1
    v_mfma_f32_16x16x32_bf16 a[232:235], v[100:103], v[48:51], a[232:235]
    v_exp_f32 v47, v31
    v_mfma_f32_16x16x32_bf16 a[240:243], v[104:107], v[48:51], a[240:243]
    ds_read_b128 v[96:99], v5 offset:16384
    v_mfma_f32_16x16x32_bf16 a[244:247], v[104:107], v[52:55], a[244:247]
    v_mfma_f32_16x16x32_bf16 a[252:255], v[108:111], v[52:55], a[252:255]
    ds_read_b128 v[100:103], v5 offset:17408
    buffer_load_dwordx4 a[60:63], v7, s[76:79], s60 offen offset:3072 sc1
    v_mfma_f32_16x16x32_bf16 a[248:251], v[108:111], v[48:51], a[248:251]
    s_cbranch_vccnz L_r2L
L_r2bL:
    s_mov_b64 vcc, -1
    v_cvt_pk_bf16_f32 v48, v32, v33
    v_cvt_pk_bf16_f32 v49, v34, v35
    v_cvt_pk_bf16_f32 v50, v40, v41
    v_cvt_pk_bf16_f32 v51, v42, v43
    v_cvt_pk_bf16_f32 v52, v36, v37
    v_cvt_pk_bf16_f32 v53, v38, v39
    v_cvt_pk_bf16_f32 v54, v44, v45
    v_cvt_pk_bf16_f32 v55, v46, v47
    s_lshl_b32 s29, s32, 2
    v_add_u32 v6, s56, v7
    s_waitcnt lgkmcnt(8)
    v_mfma_f32_16x16x32_bf16 v[192:195], v[64:67], v[48:51], v[192:195]
    ds_read_b128 v[104:107], v5 offset:18432
    v_add_f32 v8, v8, v32
    v_add_f32 v8, v8, v33
    v_add_f32 v8, v8, v34
    v_add_f32 v8, v8, v35
    v_add_f32 v9, v9, v36
    v_mfma_f32_16x16x32_bf16 v[196:199], v[64:67], v[52:55], v[196:199]
    v_add_f32 v9, v9, v37
    v_add_f32 v9, v9, v38
    v_add_f32 v9, v9, v39
    v_add_f32 v8, v8, v40
    v_add_f32 v8, v8, v41
    v_add_f32 v8, v8, v42
    v_mfma_f32_16x16x32_bf16 v[204:207], v[68:71], v[52:55], v[204:207]
    ds_read_b128 v[108:111], v5 offset:19456
    v_add_f32 v8, v8, v43
    v_add_f32 v9, v9, v44
    v_add_f32 v9, v9, v45
    v_add_f32 v9, v9, v46
    v_add_f32 v9, v9, v47
    v_mfma_f32_16x16x32_bf16 v[200:203], v[68:71], v[48:51], v[200:203]
    v_add_u32 v3, s57, v7
    v_add_u32 v4, s58, v7
    v_add_u32 v116, s59, v7
    s_add_u32 s63, s54, 0
    s_waitcnt lgkmcnt(8)
    v_mfma_f32_16x16x32_bf16 v[208:211], v[72:75], v[48:51], v[208:211]
    ds_read_b128 v[112:115], v5 offset:20480
    v_mfma_f32_16x16x32_bf16 v[212:215], v[72:75], v[52:55], v[212:215]
    v_mfma_f32_16x16x32_bf16 v[220:223], v[76:79], v[52:55], v[220:223]
    ds_read_b128 v[64:67], v5 offset:21504
    v_mfma_f32_16x16x32_bf16 v[216:219], v[76:79], v[48:51], v[216:219]
    s_waitcnt lgkmcnt(8)
    v_mfma_f32_16x16x32_bf16 v[224:227], v[80:83], v[48:51], v[224:227]
    ds_read_b128 v[68:71], v5 offset:22528
    v_mfma_f32_16x16x32_bf16 v[228:231], v[80:83], v[52:55], v[228:231]
    v_mfma_f32_16x16x32_bf16 v[236:239], v[84:87], v[52:55], v[236:239]
    ds_read_b128 v[72:75], v5 offset:23552
    v_cvt_pk_bf16_f32 v32, v192, v193
    v_cvt_pk_bf16_f32 v33, v194, v195
    v_cvt_pk_bf16_f32 v34, v200, v201
    v_cvt_pk_bf16_f32 v35, v202, v203
    buffer_store_dwordx4 v[32:35], v7, s[8:11], s63 offen offset:0 sc1
    v_mfma_f32_16x16x32_bf16 v[232:235], v[84:87], v[48:51], v[232:235]
    v_cvt_pk_bf16_f32 v36, v196, v197
    v_cvt_pk_bf16_f32 v37, v198, v199
    v_cvt_pk_bf16_f32 v38, v204, v205
    v_cvt_pk_bf16_f32 v39, v206, v207
    buffer_store_dwordx4 v[36:39], v7, s[8:11], s63 offen offset:1024 sc1
    s_waitcnt lgkmcnt(8)
    v_mfma_f32_16x16x32_bf16 v[240:243], v[88:91], v[48:51], v[240:243]
    ds_read_b128 v[76:79], v5 offset:24576
    v_mfma_f32_16x16x32_bf16 v[244:247], v[88:91], v[52:55], v[244:247]
    v_mfma_f32_16x16x32_bf16 v[252:255], v[92:95], v[52:55], v[252:255]
    ds_read_b128 v[80:83], v5 offset:25600
    v_cvt_pk_bf16_f32 v40, v208, v209
    v_cvt_pk_bf16_f32 v41, v210, v211
    v_cvt_pk_bf16_f32 v42, v216, v217
    v_cvt_pk_bf16_f32 v43, v218, v219
    buffer_store_dwordx4 v[40:43], v7, s[8:11], s63 offen offset:2048 sc1
    v_mfma_f32_16x16x32_bf16 v[248:251], v[92:95], v[48:51], v[248:251]
    v_cvt_pk_bf16_f32 v44, v212, v213
    v_cvt_pk_bf16_f32 v45, v214, v215
    v_cvt_pk_bf16_f32 v46, v220, v221
    v_cvt_pk_bf16_f32 v47, v222, v223
    buffer_store_dwordx4 v[44:47], v7, s[8:11], s63 offen offset:3072 sc1
    s_waitcnt lgkmcnt(8)
    v_mfma_f32_16x16x32_bf16 a[128:131], v[96:99], v[48:51], a[128:131]
    ds_read_b128 v[84:87], v5 offset:26624
    v_mfma_f32_16x16x32_bf16 a[132:135], v[96:99], v[52:55], a[132:135]
    v_mfma_f32_16x16x32_bf16 a[140:143], v[100:103], v[52:55], a[140:143]
    ds_read_b128 v[88:91], v5 offset:27648
    s_add_u32 s63, s63, 4096
    v_cvt_pk_bf16_f32 v32, v224, v225
    v_cvt_pk_bf16_f32 v33, v226, v227
    v_cvt_pk_bf16_f32 v34, v232, v233
    v_cvt_pk_bf16_f32 v35, v234, v235
    v_mfma_f32_16x16x32_bf16 a[136:139], v[100:103], v[48:51], a[136:139]
    buffer_store_dwordx4 v[32:35], v7, s[8:11], s63 offen offset:0 sc1
    v_cvt_pk_bf16_f32 v36, v228, v229
    v_cvt_pk_bf16_f32 v37, v230, v231
    v_cvt_pk_bf16_f32 v38, v236, v237
    v_cvt_pk_bf16_f32 v39, v238, v239
    s_waitcnt lgkmcnt(8)
    v_mfma_f32_16x16x32_bf16 a[144:147], v[104:107], v[48:51], a[144:147]
    ds_read_b128 v[92:95], v5 offset:28672
    buffer_store_dwordx4 v[36:39], v7, s[8:11], s63 offen offset:1024 sc1
    v_mfma_f32_16x16x32_bf16 a[148:151], v[104:107], v[52:55], a[148:151]
    v_mfma_f32_16x16x32_bf16 a[156:159], v[108:111], v[52:55], a[156:159]
    ds_read_b128 v[96:99], v5 offset:29696
    v_cvt_pk_bf16_f32 v40, v240, v241
    v_cvt_pk_bf16_f32 v41, v242, v243
    v_cvt_pk_bf16_f32 v42, v248, v249
    v_cvt_pk_bf16_f32 v43, v250, v251
    buffer_store_dwordx4 v[40:43], v7, s[8:11], s63 offen offset:2048 sc1
    v_mfma_f32_16x16x32_bf16 a[152:155], v[108:111], v[48:51], a[152:155]
    v_cvt_pk_bf16_f32 v44, v244, v245
    v_cvt_pk_bf16_f32 v45, v246, v247
    v_cvt_pk_bf16_f32 v46, v252, v253
    v_cvt_pk_bf16_f32 v47, v254, v255
    buffer_store_dwordx4 v[44:47], v7, s[8:11], s63 offen offset:3072 sc1
    s_waitcnt lgkmcnt(8)
    v_mfma_f32_16x16x32_bf16 a[160:163], v[112:115], v[48:51], a[160:163]
    ds_read_b128 v[100:103], v5 offset:30720
    s_add_u32 s63, s54, 8192
    v_mfma_f32_16x16x32_bf16 a[164:167], v[112:115], v[52:55], a[164:167]
    v_mfma_f32_16x16x32_bf16 a[172:175], v[64:67], v[52:55], a[172:175]
    ds_read_b128 v[104:107], v5 offset:31744
    v_accvgpr_read_b32 v16, a128
    v_accvgpr_read_b32 v17, a129
    v_accvgpr_read_b32 v18, a130
    v_accvgpr_read_b32 v19, a131
    v_accvgpr_read_b32 v20, a136
    v_mfma_f32_16x16x32_bf16 a[168:171], v[64:67], v[48:51], a[168:171]
    v_accvgpr_read_b32 v21, a137
    v_accvgpr_read_b32 v22, a138
    v_accvgpr_read_b32 v23, a139
    v_cvt_pk_bf16_f32 v32, v16, v17
    v_cvt_pk_bf16_f32 v33, v18, v19
    v_cvt_pk_bf16_f32 v34, v20, v21
    s_waitcnt lgkmcnt(8)
    v_mfma_f32_16x16x32_bf16 a[176:179], v[68:71], v[48:51], a[176:179]
    ds_read_b128 v[108:111], v5 offset:0
    v_cvt_pk_bf16_f32 v35, v22, v23
    buffer_store_dwordx4 v[32:35], v7, s[8:11], s63 offen offset:0 sc1
    v_accvgpr_read_b32 v24, a132
    v_accvgpr_read_b32 v25, a133
    v_mfma_f32_16x16x32_bf16 a[180:183], v[68:71], v[52:55], a[180:183]
    v_accvgpr_read_b32 v26, a134
    v_accvgpr_read_b32 v27, a135
    v_accvgpr_read_b32 v28, a140
    v_accvgpr_read_b32 v29, a141
    v_accvgpr_read_b32 v30, a142
    v_accvgpr_read_b32 v31, a143
    v_mfma_f32_16x16x32_bf16 a[188:191], v[72:75], v[52:55], a[188:191]
    ds_read_b128 v[112:115], v5 offset:1024
    v_cvt_pk_bf16_f32 v36, v24, v25
    v_cvt_pk_bf16_f32 v37, v26, v27
    v_cvt_pk_bf16_f32 v38, v28, v29
    v_cvt_pk_bf16_f32 v39, v30, v31
    buffer_store_dwordx4 v[36:39], v7, s[8:11], s63 offen offset:1024 sc1
    v_mfma_f32_16x16x32_bf16 a[184:187], v[72:75], v[48:51], a[184:187]
    v_accvgpr_read_b32 v16, a144
    v_accvgpr_read_b32 v17, a145
    v_accvgpr_read_b32 v18, a146
    v_accvgpr_read_b32 v19, a147
    v_accvgpr_read_b32 v20, a152
    v_accvgpr_read_b32 v21, a153
    s_waitcnt lgkmcnt(8)
    v_mfma_f32_16x16x32_bf16 a[192:195], v[76:79], v[48:51], a[192:195]
    ds_read_b128 v[64:67], v5 offset:2048
    v_accvgpr_read_b32 v22, a154
    v_accvgpr_read_b32 v23, a155
    v_cvt_pk_bf16_f32 v40, v16, v17
    v_cvt_pk_bf16_f32 v41, v18, v19
    v_cvt_pk_bf16_f32 v42, v20, v21
    v_mfma_f32_16x16x32_bf16 a[196:199], v[76:79], v[52:55], a[196:199]
    v_cvt_pk_bf16_f32 v43, v22, v23
    buffer_store_dwordx4 v[40:43], v7, s[8:11], s63 offen offset:2048 sc1
    v_accvgpr_read_b32 v24, a148
    v_accvgpr_read_b32 v25, a149
    v_accvgpr_read_b32 v26, a150
    v_mfma_f32_16x16x32_bf16 a[204:207], v[80:83], v[52:55], a[204:207]
    ds_read_b128 v[68:71], v5 offset:3072
    v_accvgpr_read_b32 v27, a151
    v_accvgpr_read_b32 v28, a156
    v_accvgpr_read_b32 v29, a157
    v_accvgpr_read_b32 v30, a158
    v_accvgpr_read_b32 v31, a159
    v_mfma_f32_16x16x32_bf16 a[200:203], v[80:83], v[48:51], a[200:203]
    v_cvt_pk_bf16_f32 v44, v24, v25
    v_cvt_pk_bf16_f32 v45, v26, v27
    v_cvt_pk_bf16_f32 v46, v28, v29
    v_cvt_pk_bf16_f32 v47, v30, v31
    buffer_store_dwordx4 v[44:47], v7, s[8:11], s63 offen offset:3072 sc1
    s_waitcnt lgkmcnt(8)
    v_mfma_f32_16x16x32_bf16 a[208:211], v[84:87], v[48:51], a[208:211]
    ds_read_b128 v[72:75], v5 offset:4096
    s_add_u32 s63, s63, 4096
    v_accvgpr_read_b32 v16, a160
    v_accvgpr_read_b32 v17, a161
    v_accvgpr_read_b32 v18, a162
    v_accvgpr_read_b32 v19, a163
    v_mfma_f32_16x16x32_bf16 a[212:215], v[84:87], v[52:55], a[212:215]
    v_accvgpr_read_b32 v20, a168
    v_accvgpr_read_b32 v21, a169
    v_accvgpr_read_b32 v22, a170
    v_accvgpr_read_b32 v23, a171
    v_cvt_pk_bf16_f32 v32, v16, v17
    v_cvt_pk_bf16_f32 v33, v18, v19
    v_mfma_f32_16x16x32_bf16 a[220:223], v[88:91], v[52:55], a[220:223]
    ds_read_b128 v[76:79], v5 offset:5120
    v_cvt_pk_bf16_f32 v34, v20, v21
    v_cvt_pk_bf16_f32 v35, v22, v23
    buffer_store_dwordx4 v[32:35], v7, s[8:11], s63 offen offset:0 sc1
    v_accvgpr_read_b32 v24, a164
    v_mfma_f32_16x16x32_bf16 a[216:219], v[88:91], v[48:51], a[216:219]
    v_accvgpr_read_b32 v25, a165
    v_accvgpr_read_b32 v26, a166
    v_accvgpr_read_b32 v27, a167
    v_accvgpr_read_b32 v28, a172
    v_accvgpr_read_b32 v29, a173
    v_accvgpr_read_b32 v30, a174
    s_waitcnt lgkmcnt(8)
    v_mfma_f32_16x16x32_bf16 a[224:227], v[92:95], v[48:51], a[224:227]
    ds_read_b128 v[80:83], v5 offset:6144
    v_accvgpr_read_b32 v31, a175
    v_cvt_pk_bf16_f32 v36, v24, v25
    v_cvt_pk_bf16_f32 v37, v26, v27
    v_cvt_pk_bf16_f32 v38, v28, v29
    v_cvt_pk_bf16_f32 v39, v30, v31
    v_mfma_f32_16x16x32_bf16 a[228:231], v[92:95], v[52:55], a[228:231]
    buffer_store_dwordx4 v[36:39], v7, s[8:11], s63 offen offset:1024 sc1
    v_accvgpr_read_b32 v16, a176
    v_accvgpr_read_b32 v17, a177
    v_accvgpr_read_b32 v18, a178
    v_accvgpr_read_b32 v19, a179
    v_mfma_f32_16x16x32_bf16 a[236:239], v[96:99], v[52:55], a[236:239]
    ds_read_b128 v[84:87], v5 offset:7168
    v_accvgpr_read_b32 v20, a184
    v_accvgpr_read_b32 v21, a185
    v_accvgpr_read_b32 v22, a186
    v_accvgpr_read_b32 v23, a187
    v_cvt_pk_bf16_f32 v40, v16, v17
    v_mfma_f32_16x16x32_bf16 a[232:235], v[96:99], v[48:51], a[232:235]
    v_cvt_pk_bf16_f32 v41, v18, v19
    v_cvt_pk_bf16_f32 v42, v20, v21
    v_cvt_pk_bf16_f32 v43, v22, v23
    buffer_store_dwordx4 v[40:43], v7, s[8:11], s63 offen offset:2048 sc1
    v_accvgpr_read_b32 v24, a180
    s_waitcnt lgkmcnt(8)
    v_mfma_f32_16x16x32_bf16 a[240:243], v[100:103], v[48:51], a[240:243]
    ds_read_b128 v[88:91], v6 offset:0
    v_accvgpr_read_b32 v25, a181
    v_accvgpr_read_b32 v26, a182
    v_accvgpr_read_b32 v27, a183
    v_accvgpr_read_b32 v28, a188
    v_accvgpr_read_b32 v29, a189
    v_mfma_f32_16x16x32_bf16 a[244:247], v[100:103], v[52:55], a[244:247]
    v_accvgpr_read_b32 v30, a190
    v_accvgpr_read_b32 v31, a191
    v_cvt_pk_bf16_f32 v44, v24, v25
    v_cvt_pk_bf16_f32 v45, v26, v27
    v_cvt_pk_bf16_f32 v46, v28, v29
    v_cvt_pk_bf16_f32 v47, v30, v31
    v_mfma_f32_16x16x32_bf16 a[252:255], v[104:107], v[52:55], a[252:255]
    ds_read_b128 v[92:95], v6 offset:1024
    buffer_store_dwordx4 v[44:47], v7, s[8:11], s63 offen offset:3072 sc1
    s_add_u32 s63, s54, 16384
    v_accvgpr_read_b32 v16, a192
    v_accvgpr_read_b32 v17, a193
    v_mfma_f32_16x16x32_bf16 a[248:251], v[104:107], v[48:51], a[248:251]
    v_accvgpr_read_b32 v18, a194
    v_accvgpr_read_b32 v19, a195
    v_accvgpr_read_b32 v20, a200
    v_accvgpr_read_b32 v21, a201
    v_accvgpr_read_b32 v22, a202
    v_accvgpr_read_b32 v23, a203
    s_waitcnt lgkmcnt(8)
    v_mfma_f32_16x16x32_bf16 v[128:131], v[108:111], v[48:51], v[128:131]
    ds_read_b128 v[96:99], v6 offset:2048
    v_cvt_pk_bf16_f32 v32, v16, v17
    v_cvt_pk_bf16_f32 v33, v18, v19
    v_cvt_pk_bf16_f32 v34, v20, v21
    v_cvt_pk_bf16_f32 v35, v22, v23
    buffer_store_dwordx4 v[32:35], v7, s[8:11], s63 offen offset:0 sc1
    v_mfma_f32_16x16x32_bf16 v[132:135], v[108:111], v[52:55], v[132:135]
    v_accvgpr_read_b32 v24, a196
    v_accvgpr_read_b32 v25, a197
    v_accvgpr_read_b32 v26, a198
    v_accvgpr_read_b32 v27, a199
    v_accvgpr_read_b32 v28, a204
    v_accvgpr_read_b32 v29, a205
    v_mfma_f32_16x16x32_bf16 v[140:143], v[112:115], v[52:55], v[140:143]
    ds_read_b128 v[100:103], v6 offset:3072
    v_accvgpr_read_b32 v30, a206
    v_accvgpr_read_b32 v31, a207
    v_cvt_pk_bf16_f32 v36, v24, v25
    v_cvt_pk_bf16_f32 v37, v26, v27
    v_cvt_pk_bf16_f32 v38, v28, v29
    v_mfma_f32_16x16x32_bf16 v[136:139], v[112:115], v[48:51], v[136:139]
    v_cvt_pk_bf16_f32 v39, v30, v31
    buffer_store_dwordx4 v[36:39], v7, s[8:11], s63 offen offset:1024 sc1
    v_accvgpr_read_b32 v16, a208
    v_accvgpr_read_b32 v17, a209
    v_accvgpr_read_b32 v18, a210
    s_waitcnt lgkmcnt(8)
    v_mfma_f32_16x16x32_bf16 v[144:147], v[64:67], v[48:51], v[144:147]
    ds_read_b128 v[104:107], v6 offset:4096
    v_accvgpr_read_b32 v19, a211
    v_accvgpr_read_b32 v20, a216
    v_accvgpr_read_b32 v21, a217
    v_accvgpr_read_b32 v22, a218
    v_accvgpr_read_b32 v23, a219
    v_mfma_f32_16x16x32_bf16 v[148:151], v[64:67], v[52:55], v[148:151]
    v_cvt_pk_bf16_f32 v40, v16, v17
    v_cvt_pk_bf16_f32 v41, v18, v19
    v_cvt_pk_bf16_f32 v42, v20, v21
    v_cvt_pk_bf16_f32 v43, v22, v23
    buffer_store_dwordx4 v[40:43], v7, s[8:11], s63 offen offset:2048 sc1
    v_mfma_f32_16x16x32_bf16 v[156:159], v[68:71], v[52:55], v[156:159]
    ds_read_b128 v[108:111], v6 offset:5120
    v_accvgpr_read_b32 v24, a212
    v_accvgpr_read_b32 v25, a213
    v_accvgpr_read_b32 v26, a214
    v_accvgpr_read_b32 v27, a215
    v_accvgpr_read_b32 v28, a220
    v_mfma_f32_16x16x32_bf16 v[152:155], v[68:71], v[48:51], v[152:155]
    v_accvgpr_read_b32 v29, a221
    v_accvgpr_read_b32 v30, a222
    v_accvgpr_read_b32 v31, a223
    v_cvt_pk_bf16_f32 v44, v24, v25
    v_cvt_pk_bf16_f32 v45, v26, v27
    v_cvt_pk_bf16_f32 v46, v28, v29
    s_waitcnt lgkmcnt(8)
    v_mfma_f32_16x16x32_bf16 v[160:163], v[72:75], v[48:51], v[160:163]
    ds_read_b128 v[112:115], v6 offset:6144
    v_cvt_pk_bf16_f32 v47, v30, v31
    buffer_store_dwordx4 v[44:47], v7, s[8:11], s63 offen offset:3072 sc1
    s_add_u32 s63, s63, 4096
    v_accvgpr_read_b32 v16, a224
    v_mfma_f32_16x16x32_bf16 v[164:167], v[72:75], v[52:55], v[164:167]
    v_accvgpr_read_b32 v17, a225
    v_accvgpr_read_b32 v18, a226
    v_accvgpr_read_b32 v19, a227
    v_accvgpr_read_b32 v20, a232
    v_accvgpr_read_b32 v21, a233
    v_accvgpr_read_b32 v22, a234
    v_mfma_f32_16x16x32_bf16 v[172:175], v[76:79], v[52:55], v[172:175]
    ds_read_b128 v[64:67], v6 offset:7168
    v_accvgpr_read_b32 v23, a235
    v_cvt_pk_bf16_f32 v32, v16, v17
    v_cvt_pk_bf16_f32 v33, v18, v19
    v_cvt_pk_bf16_f32 v34, v20, v21
    v_cvt_pk_bf16_f32 v35, v22, v23
    v_mfma_f32_16x16x32_bf16 v[168:171], v[76:79], v[48:51], v[168:171]
    buffer_store_dwordx4 v[32:35], v7, s[8:11], s63 offen offset:0 sc1
    v_accvgpr_read_b32 v24, a228
    v_accvgpr_read_b32 v25, a229
    v_accvgpr_read_b32 v26, a230
    v_accvgpr_read_b32 v27, a231
    s_waitcnt lgkmcnt(8)
    v_mfma_f32_16x16x32_bf16 v[176:179], v[80:83], v[48:51], v[176:179]
    ds_read_b128 v[68:71], v6 offset:8192
    v_accvgpr_read_b32 v28, a236
    v_accvgpr_read_b32 v29, a237
    v_accvgpr_read_b32 v30, a238
    v_accvgpr_read_b32 v31, a239
    v_cvt_pk_bf16_f32 v36, v24, v25
    v_mfma_f32_16x16x32_bf16 v[180:183], v[80:83], v[52:55], v[180:183]
    v_cvt_pk_bf16_f32 v37, v26, v27
    v_cvt_pk_bf16_f32 v38, v28, v29
    v_cvt_pk_bf16_f32 v39, v30, v31
    buffer_store_dwordx4 v[36:39], v7, s[8:11], s63 offen offset:1024 sc1
    v_accvgpr_read_b32 v16, a240
    v_mfma_f32_16x16x32_bf16 v[188:191], v[84:87], v[52:55], v[188:191]
    ds_read_b128 v[72:75], v6 offset:9216
    v_accvgpr_read_b32 v17, a241
    v_accvgpr_read_b32 v18, a242
    v_accvgpr_read_b32 v19, a243
    v_accvgpr_read_b32 v20, a248
    v_accvgpr_read_b32 v21, a249
    v_mfma_f32_16x16x32_bf16 v[184:187], v[84:87], v[48:51], v[184:187]
    v_accvgpr_read_b32 v22, a250
    v_accvgpr_read_b32 v23, a251
    v_cvt_pk_bf16_f32 v40, v16, v17
    v_cvt_pk_bf16_f32 v41, v18, v19
    v_cvt_pk_bf16_f32 v42, v20, v21
    v_cvt_pk_bf16_f32 v43, v22, v23
    s_barrier
    v_lshrrev_b32 v13, 4, v0
    v_and_b32 v14, 15, v0
    v_xor_b32 v15, v13, v14
    v_lshlrev_b32 v15, 4, v15
    v_lshl_add_u32 v48, v13, 10, v15
    v_xor_b32 v49, 64, v48
    v_xor_b32 v50, 128, v48
    v_xor_b32 v51, 192, v48
    s_add_u32 s20, s20, s33
    v_lshl_add_u32 v52, v14, 8, v15
    v_add_u32 v52, s20, v52
    v_xor_b32 v53, 64, v52
    v_xor_b32 v54, 128, v52
    v_xor_b32 v55, 192, v52
    v_add_u32 v118, s20, v7
    s_lshl_b32 s39, s27, 15
    s_lshl_b32 s30, s74, 8
    s_add_u32 s39, s39, s30
    s_add_u32 m0, s20, 0
    s_add_u32 s30, s39, 0
    buffer_load_dwordx4 v48, s[12:15], s30 offen lds
    s_add_u32 m0, s20, 1024
    s_add_u32 s30, s39, 4096
    buffer_load_dwordx4 v49, s[12:15], s30 offen lds
    s_add_u32 m0, s20, 2048
    s_add_u32 s30, s39, 8192
    buffer_load_dwordx4 v50, s[12:15], s30 offen lds
    s_add_u32 m0, s20, 3072
    s_add_u32 s30, s39, 12288
    buffer_load_dwordx4 v51, s[12:15], s30 offen lds
    s_add_u32 m0, s20, 4096
    s_add_u32 s30, s39, 16384
    buffer_load_dwordx4 v48, s[12:15], s30 offen lds
    s_add_u32 m0, s20, 5120
    s_add_u32 s30, s39, 20480
    buffer_load_dwordx4 v49, s[12:15], s30 offen lds
    s_add_u32 m0, s20, 6144
    s_add_u32 s30, s39, 24576
    buffer_load_dwordx4 v50, s[12:15], s30 offen lds
    s_add_u32 m0, s20, 7168
    s_add_u32 s30, s39, 28672
    buffer_load_dwordx4 v51, s[12:15], s30 offen lds
L_nox:
    buffer_store_dwordx4 v[40:43], v7, s[8:11], s63 offen offset:2048 sc1
    v_accvgpr_read_b32 v24, a244
    v_accvgpr_read_b32 v25, a245
    v_accvgpr_read_b32 v26, a246
    v_accvgpr_read_b32 v27, a247
    v_accvgpr_read_b32 v28, a252
    v_accvgpr_read_b32 v29, a253
    v_accvgpr_read_b32 v30, a254
    v_accvgpr_read_b32 v31, a255
    v_cvt_pk_bf16_f32 v44, v24, v25
    v_cvt_pk_bf16_f32 v45, v26, v27
    v_cvt_pk_bf16_f32 v46, v28, v29
    v_cvt_pk_bf16_f32 v47, v30, v31
    buffer_store_dwordx4 v[44:47], v7, s[8:11], s63 offen offset:3072 sc1
    v_mov_b32 v126, v8
    v_mov_b32 v127, v9
    s_nop 1
    v_permlane16_swap_b32 v126, v8
    v_permlane16_swap_b32 v127, v9
    s_nop 1
    v_add_f32 v8, v8, v126
    v_add_f32 v9, v9, v127
    v_mov_b32 v126, v8
    v_mov_b32 v127, v9
    s_nop 1
    v_permlane32_swap_b32 v126, v8
    v_permlane32_swap_b32 v127, v9
    s_nop 1
    v_add_f32 v8, v8, v126
    v_add_f32 v9, v9, v127
    v_mov_b32 v120, v8
    v_sub_f32 v121, 0, v56
    v_mov_b32 v122, v9
    v_sub_f32 v123, 0, v60
    s_add_u32 s30, s54, 24576
    buffer_store_dwordx4 v[120:123], v7, s[8:11], s30 offen sc1
    s_add_u32 s60, s60, 4096
    buffer_load_dwordx4 a[64:67], v7, s[76:79], s60 offen offset:0 sc1
    buffer_load_dwordx4 a[68:71], v7, s[76:79], s60 offen offset:1024 sc1
    buffer_load_dwordx4 a[72:75], v7, s[76:79], s60 offen offset:2048 sc1
    buffer_load_dwordx4 a[76:79], v7, s[76:79], s60 offen offset:3072 sc1
    s_add_u32 s60, s60, 4096
    buffer_load_dwordx4 a[80:83], v7, s[76:79], s60 offen offset:0 sc1
    buffer_load_dwordx4 a[84:87], v7, s[76:79], s60 offen offset:1024 sc1
    buffer_load_dwordx4 a[88:91], v7, s[76:79], s60 offen offset:2048 sc1
    buffer_load_dwordx4 a[92:95], v7, s[76:79], s60 offen offset:3072 sc1
    s_add_u32 s60, s60, 4096
    buffer_load_dwordx4 a[96:99], v7, s[76:79], s60 offen offset:0 sc1
    buffer_load_dwordx4 a[100:103], v7, s[76:79], s60 offen offset:1024 sc1
    buffer_load_dwordx4 a[104:107], v7, s[76:79], s60 offen offset:2048 sc1
    buffer_load_dwordx4 a[108:111], v7, s[76:79], s60 offen offset:3072 sc1
    s_add_u32 s60, s60, 4096
    buffer_load_dwordx4 a[112:115], v7, s[76:79], s60 offen offset:0 sc1
    s_waitcnt vmcnt(56)
    buffer_load_dwordx4 a[116:119], v7, s[76:79], s60 offen offset:1024 sc1
    buffer_load_dwordx4 a[120:123], v7, s[76:79], s60 offen offset:2048 sc1
    buffer_load_dwordx4 a[124:127], v7, s[76:79], s60 offen offset:3072 sc1
L_uc3:
    s_lshl_b32 s38, s28, 7
    s_add_u32 s38, s38, s62
    v_lshlrev_b32 v13, 2, v0
    v_mov_b32 v14, s75
    s_lshl_b32 s25, 1, s28
    s_mov_b64 exec, 0xffffffff
    s_waitcnt vmcnt(16)
    buffer_store_dword v14, v13, s[8:11], s38 offen sc1
    s_mov_b64 exec, -1
    s_add_u32 s61, s61, 32768
    s_add_u32 s35, s57, s33
    s_mov_b32 m0, s35
    s_nop 0
    buffer_load_dwordx4 v1, s[8:11], s61 offen offset:0 sc1 lds
    buffer_load_dwordx4 v1, s[8:11], s61 offen offset:1024 sc1 lds
    buffer_load_dwordx4 v1, s[8:11], s61 offen offset:2048 sc1 lds
    buffer_load_dwordx4 v1, s[8:11], s61 offen offset:3072 sc1 lds
    s_add_u32 m0, s35, 4096
    s_nop 0
    buffer_load_dwordx4 v2, s[8:11], s61 offen offset:0 sc1 lds
    buffer_load_dwordx4 v2, s[8:11], s61 offen offset:1024 sc1 lds
    buffer_load_dwordx4 v2, s[8:11], s61 offen offset:2048 sc1 lds
    buffer_load_dwordx4 v2, s[8:11], s61 offen offset:3072 sc1 lds
    ds_read_b128 v[16:19], v52 offset:0
    ds_read_b128 v[20:23], v52 offset:4096
    ds_read_b128 v[24:27], v53 offset:0
    ds_read_b128 v[28:31], v53 offset:4096
    ds_read_b128 v[32:35], v54 offset:0
    s_waitcnt lgkmcnt(13)
    ds_read_b128 v[36:39], v54 offset:4096
    ds_read_b128 v[40:43], v55 offset:0
    s_waitcnt lgkmcnt(13)
    ds_read_b128 v[44:47], v55 offset:4096
    s_waitcnt lgkmcnt(7)
    v_lshlrev_b32 v192, 16, v16
    v_and_b32 v193, 0xffff0000, v16
    v_lshlrev_b32 v194, 16, v17
    v_and_b32 v195, 0xffff0000, v17
    v_lshlrev_b32 v200, 16, v18
    v_and_b32 v201, 0xffff0000, v18
    v_lshlrev_b32 v202, 16, v19
    v_and_b32 v203, 0xffff0000, v19
    s_waitcnt lgkmcnt(6)
    v_lshlrev_b32 v196, 16, v20
    v_and_b32 v197, 0xffff0000, v20
    v_lshlrev_b32 v198, 16, v21
    v_and_b32 v199, 0xffff0000, v21
    v_lshlrev_b32 v204, 16, v22
    v_and_b32 v205, 0xffff0000, v22
    v_lshlrev_b32 v206, 16, v23
    v_and_b32 v207, 0xffff0000, v23
    s_waitcnt lgkmcnt(5)
    v_lshlrev_b32 v208, 16, v24
    v_and_b32 v209, 0xffff0000, v24
    v_lshlrev_b32 v210, 16, v25
    v_and_b32 v211, 0xffff0000, v25
    v_lshlrev_b32 v216, 16, v26
    v_and_b32 v217, 0xffff0000, v26
    v_lshlrev_b32 v218, 16, v27
    v_and_b32 v219, 0xffff0000, v27
    s_waitcnt lgkmcnt(4)
    v_lshlrev_b32 v212, 16, v28
    v_and_b32 v213, 0xffff0000, v28
    v_lshlrev_b32 v214, 16, v29
    v_and_b32 v215, 0xffff0000, v29
    v_lshlrev_b32 v220, 16, v30
    v_and_b32 v221, 0xffff0000, v30
    v_lshlrev_b32 v222, 16, v31
    v_and_b32 v223, 0xffff0000, v31
    s_waitcnt lgkmcnt(3)
    v_lshlrev_b32 v224, 16, v32
    v_and_b32 v225, 0xffff0000, v32
    v_lshlrev_b32 v226, 16, v33
    v_and_b32 v227, 0xffff0000, v33
    v_lshlrev_b32 v232, 16, v34
    v_and_b32 v233, 0xffff0000, v34
    v_lshlrev_b32 v234, 16, v35
    v_and_b32 v235, 0xffff0000, v35
    s_waitcnt lgkmcnt(2)
    v_lshlrev_b32 v228, 16, v36
    v_and_b32 v229, 0xffff0000, v36
    v_lshlrev_b32 v230, 16, v37
    v_and_b32 v231, 0xffff0000, v37
    v_lshlrev_b32 v236, 16, v38
    v_and_b32 v237, 0xffff0000, v38
    v_lshlrev_b32 v238, 16, v39
    v_and_b32 v239, 0xffff0000, v39
    s_waitcnt lgkmcnt(1)
    v_lshlrev_b32 v240, 16, v40
    v_and_b32 v241, 0xffff0000, v40
    v_lshlrev_b32 v242, 16, v41
    v_and_b32 v243, 0xffff0000, v41
    v_lshlrev_b32 v248, 16, v42
    v_and_b32 v249, 0xffff0000, v42
    v_lshlrev_b32 v250, 16, v43
    v_and_b32 v251, 0xffff0000, v43
    s_waitcnt lgkmcnt(0)
    v_lshlrev_b32 v244, 16, v44
    v_and_b32 v245, 0xffff0000, v44
    v_lshlrev_b32 v246, 16, v45
    v_and_b32 v247, 0xffff0000, v45
    v_lshlrev_b32 v252, 16, v46
    v_and_b32 v253, 0xffff0000, v46
    v_lshlrev_b32 v254, 16, v47
    v_and_b32 v255, 0xffff0000, v47
    s_nop 1
    s_waitcnt vmcnt(63) lgkmcnt(15)
    v_mfma_f32_16x16x32_bf16 v[192:195], v[88:91], a[0:3], v[192:195]
    ds_read_b128 v[76:79], v6 offset:10240
    v_mfma_f32_16x16x32_bf16 v[196:199], v[88:91], a[4:7], v[196:199]
    buffer_load_dword v117, v119, s[8:11], s62 offen offset:4 sc1
    v_mfma_f32_16x16x32_bf16 v[204:207], v[92:95], a[4:7], v[204:207]
    ds_read_b128 v[80:83], v6 offset:11264
    v_mfma_f32_16x16x32_bf16 v[200:203], v[92:95], a[0:3], v[200:203]
    s_add_u32 s61, s61, 32768
    s_add_u32 s35, s58, s33
    s_mov_b32 m0, s35
    s_nop 0
    buffer_load_dwordx4 v1, s[8:11], s61 offen offset:0 sc1 lds
    s_waitcnt vmcnt(63) lgkmcnt(15)
    v_mfma_f32_16x16x32_bf16 v[192:195], v[96:99], a[8:11], v[192:195]
    ds_read_b128 v[84:87], v6 offset:12288
    v_mfma_f32_16x16x32_bf16 v[196:199], v[96:99], a[12:15], v[196:199]
    buffer_load_dwordx4 v1, s[8:11], s61 offen offset:1024 sc1 lds
    v_mfma_f32_16x16x32_bf16 v[204:207], v[100:103], a[12:15], v[204:207]
    ds_read_b128 v[88:91], v6 offset:13312
    v_mfma_f32_16x16x32_bf16 v[200:203], v[100:103], a[8:11], v[200:203]
    buffer_load_dwordx4 v1, s[8:11], s61 offen offset:2048 sc1 lds
    s_waitcnt vmcnt(63) lgkmcnt(15)
    v_mfma_f32_16x16x32_bf16 v[192:195], v[104:107], a[16:19], v[192:195]
    ds_read_b128 v[92:95], v6 offset:14336
    v_mfma_f32_16x16x32_bf16 v[196:199], v[104:107], a[20:23], v[196:199]
    buffer_load_dwordx4 v1, s[8:11], s61 offen offset:3072 sc1 lds
    v_mfma_f32_16x16x32_bf16 v[204:207], v[108:111], a[20:23], v[204:207]
    ds_read_b128 v[96:99], v6 offset:15360
    v_mfma_f32_16x16x32_bf16 v[200:203], v[108:111], a[16:19], v[200:203]
    s_add_u32 m0, s35, 4096
    s_nop 0
    buffer_load_dwordx4 v2, s[8:11], s61 offen offset:0 sc1 lds
    s_waitcnt vmcnt(63) lgkmcnt(15)
    v_mfma_f32_16x16x32_bf16 v[192:195], v[112:115], a[24:27], v[192:195]
    ds_read_b128 v[100:103], v6 offset:16384
    v_mfma_f32_16x16x32_bf16 v[196:199], v[112:115], a[28:31], v[196:199]
    buffer_load_dwordx4 v2, s[8:11], s61 offen offset:1024 sc1 lds
    v_mfma_f32_16x16x32_bf16 v[204:207], v[64:67], a[28:31], v[204:207]
    ds_read_b128 v[104:107], v6 offset:17408
    v_mfma_f32_16x16x32_bf16 v[200:203], v[64:67], a[24:27], v[200:203]
    buffer_load_dwordx4 v2, s[8:11], s61 offen offset:2048 sc1 lds
    s_waitcnt vmcnt(63) lgkmcnt(15)
    v_mfma_f32_16x16x32_bf16 v[192:195], v[68:71], a[32:35], v[192:195]
    ds_read_b128 v[108:111], v6 offset:18432
    v_mfma_f32_16x16x32_bf16 v[196:199], v[68:71], a[36:39], v[196:199]
    buffer_load_dwordx4 v2, s[8:11], s61 offen offset:3072 sc1 lds
    v_mfma_f32_16x16x32_bf16 v[204:207], v[72:75], a[36:39], v[204:207]
    ds_read_b128 v[112:115], v6 offset:19456
    v_mfma_f32_16x16x32_bf16 v[200:203], v[72:75], a[32:35], v[200:203]
    s_add_u32 s61, s61, 32768
    s_add_u32 s35, s59, s33
    s_mov_b32 m0, s35
    s_nop 0
    buffer_load_dwordx4 v1, s[8:11], s61 offen offset:0 sc1 lds
    s_waitcnt vmcnt(63) lgkmcnt(8)
    v_mfma_f32_16x16x32_bf16 v[192:195], v[76:79], a[40:43], v[192:195]
    ds_read_b128 v[64:67], v6 offset:20480
    v_mfma_f32_16x16x32_bf16 v[196:199], v[76:79], a[44:47], v[196:199]
    buffer_load_dwordx4 v1, s[8:11], s61 offen offset:1024 sc1 lds
    v_mfma_f32_16x16x32_bf16 v[204:207], v[80:83], a[44:47], v[204:207]
    ds_read_b128 v[68:71], v6 offset:21504
    v_mfma_f32_16x16x32_bf16 v[200:203], v[80:83], a[40:43], v[200:203]
    buffer_load_dwordx4 v1, s[8:11], s61 offen offset:2048 sc1 lds
    s_waitcnt vmcnt(63) lgkmcnt(8)
    v_mfma_f32_16x16x32_bf16 v[192:195], v[84:87], a[48:51], v[192:195]
    ds_read_b128 v[72:75], v6 offset:22528
    v_mfma_f32_16x16x32_bf16 v[196:199], v[84:87], a[52:55], v[196:199]
    buffer_load_dwordx4 v1, s[8:11], s61 offen offset:3072 sc1 lds
    v_mfma_f32_16x16x32_bf16 v[204:207], v[88:91], a[52:55], v[204:207]
    ds_read_b128 v[76:79], v6 offset:23552
    v_mfma_f32_16x16x32_bf16 v[200:203], v[88:91], a[48:51], v[200:203]
    s_add_u32 m0, s35, 4096
    s_nop 0
    buffer_load_dwordx4 v2, s[8:11], s61 offen offset:0 sc1 lds
    s_waitcnt vmcnt(63) lgkmcnt(8)
    v_mfma_f32_16x16x32_bf16 v[192:195], v[92:95], a[56:59], v[192:195]
    ds_read_b128 v[80:83], v6 offset:24576
    v_mfma_f32_16x16x32_bf16 v[196:199], v[92:95], a[60:63], v[196:199]
    buffer_load_dwordx4 v2, s[8:11], s61 offen offset:1024 sc1 lds
    v_mfma_f32_16x16x32_bf16 v[204:207], v[96:99], a[60:63], v[204:207]
    ds_read_b128 v[84:87], v6 offset:25600
    v_mfma_f32_16x16x32_bf16 v[200:203], v[96:99], a[56:59], v[200:203]
    buffer_load_dwordx4 v2, s[8:11], s61 offen offset:2048 sc1 lds
    s_waitcnt vmcnt(39) lgkmcnt(8)
    v_mfma_f32_16x16x32_bf16 v[192:195], v[100:103], a[64:67], v[192:195]
    ds_read_b128 v[88:91], v6 offset:26624
    v_mfma_f32_16x16x32_bf16 v[196:199], v[100:103], a[68:71], v[196:199]
    buffer_load_dwordx4 v2, s[8:11], s61 offen offset:3072 sc1 lds
    v_mfma_f32_16x16x32_bf16 v[204:207], v[104:107], a[68:71], v[204:207]
    ds_read_b128 v[92:95], v6 offset:27648
    v_mfma_f32_16x16x32_bf16 v[200:203], v[104:107], a[64:67], v[200:203]
    s_waitcnt vmcnt(38) lgkmcnt(8)
    v_mfma_f32_16x16x32_bf16 v[192:195], v[108:111], a[72:75], v[192:195]
    ds_read_b128 v[96:99], v6 offset:28672
    v_mfma_f32_16x16x32_bf16 v[196:199], v[108:111], a[76:79], v[196:199]
    v_mfma_f32_16x16x32_bf16 v[204:207], v[112:115], a[76:79], v[204:207]
    ds_read_b128 v[100:103], v6 offset:29696
    v_mfma_f32_16x16x32_bf16 v[200:203], v[112:115], a[72:75], v[200:203]
    s_waitcnt vmcnt(36) lgkmcnt(8)
    v_mfma_f32_16x16x32_bf16 v[192:195], v[64:67], a[80:83], v[192:195]
    ds_read_b128 v[104:107], v6 offset:30720
    v_mfma_f32_16x16x32_bf16 v[196:199], v[64:67], a[84:87], v[196:199]
    v_mfma_f32_16x16x32_bf16 v[204:207], v[68:71], a[84:87], v[204:207]
    ds_read_b128 v[108:111], v6 offset:31744
    v_mfma_f32_16x16x32_bf16 v[200:203], v[68:71], a[80:83], v[200:203]
    s_waitcnt vmcnt(34) lgkmcnt(8)
    v_mfma_f32_16x16x32_bf16 v[192:195], v[72:75], a[88:91], v[192:195]
    s_waitcnt vmcnt(17)
    s_barrier
    ds_read_b128 v[64:67], v3 offset:0
    v_mfma_f32_16x16x32_bf16 v[196:199], v[72:75], a[92:95], v[196:199]
    v_mfma_f32_16x16x32_bf16 v[204:207], v[76:79], a[92:95], v[204:207]
    ds_read_b128 v[68:71], v3 offset:2048
    v_mfma_f32_16x16x32_bf16 v[200:203], v[76:79], a[88:91], v[200:203]
    s_waitcnt vmcnt(32) lgkmcnt(8)
    v_mfma_f32_16x16x32_bf16 v[192:195], v[80:83], a[96:99], v[192:195]
    ds_read_b128 v[72:75], v3 offset:4096
    v_mfma_f32_16x16x32_bf16 v[196:199], v[80:83], a[100:103], v[196:199]
    v_mfma_f32_16x16x32_bf16 v[204:207], v[84:87], a[100:103], v[204:207]
    ds_read_b128 v[76:79], v3 offset:6144
    v_mfma_f32_16x16x32_bf16 v[200:203], v[84:87], a[96:99], v[200:203]
    s_waitcnt vmcnt(30) lgkmcnt(8)
    v_mfma_f32_16x16x32_bf16 v[192:195], v[88:91], a[104:107], v[192:195]
    ds_read_b128 v[80:83], v3 offset:8192
    v_mfma_f32_16x16x32_bf16 v[196:199], v[88:91], a[108:111], v[196:199]
    v_mfma_f32_16x16x32_bf16 v[204:207], v[92:95], a[108:111], v[204:207]
    ds_read_b128 v[84:87], v3 offset:10240
    v_mfma_f32_16x16x32_bf16 v[200:203], v[92:95], a[104:107], v[200:203]
    s_waitcnt vmcnt(16)
    v_cmp_eq_u32 vcc, s75, v117
    s_nop 3
    s_and_b32 s44, vcc_lo, 15
    s_andn2_b32 s44, s44, s25
    s_or_b32 s25, s25, s44
    s_waitcnt vmcnt(28) lgkmcnt(8)
    v_mfma_f32_16x16x32_bf16 v[192:195], v[96:99], a[112:115], v[192:195]
    ds_read_b128 v[88:91], v3 offset:12288
    v_mfma_f32_16x16x32_bf16 v[196:199], v[96:99], a[116:119], v[196:199]
    s_sub_u32 s30, s28, 1
    s_and_b32 s30, s30, 3
    s_bitcmp1_b32 s44, s30
    s_cselect_b32 s46, 0, 0x80000000
    v_or_b32 v15, s46, v7
    s_add_u32 s30, s30, s29
    s_lshl_b32 s30, s30, 2
    s_add_u32 s30, s30, s26
    s_lshl_b32 s63, s30, 15
    s_add_u32 s30, s63, 83910656
    buffer_load_dwordx4 v[56:59], v15, s[8:11], s30 offen sc1
    v_mfma_f32_16x16x32_bf16 v[204:207], v[100:103], a[116:119], v[204:207]
    ds_read_b128 v[92:95], v3 offset:14336
    v_mfma_f32_16x16x32_bf16 v[200:203], v[100:103], a[112:115], v[200:203]
    s_waitcnt vmcnt(27) lgkmcnt(8)
    v_mfma_f32_16x16x32_bf16 v[192:195], v[104:107], a[120:123], v[192:195]
    ds_read_b128 v[96:99], v3 offset:16384
    v_mfma_f32_16x16x32_bf16 v[196:199], v[104:107], a[124:127], v[196:199]
    v_mfma_f32_16x16x32_bf16 v[204:207], v[108:111], a[124:127], v[204:207]
    ds_read_b128 v[100:103], v3 offset:18432
    s_add_u32 s30, s63, 83886080
    buffer_load_dwordx4 v[16:19], v15, s[8:11], s30 offen offset:0 sc1
    v_mfma_f32_16x16x32_bf16 v[200:203], v[108:111], a[120:123], v[200:203]
    s_waitcnt lgkmcnt(8)
    v_mfma_f32_16x16x32_bf16 v[208:211], v[64:67], a[0:3], v[208:211]
    ds_read_b128 v[104:107], v3 offset:20480
    v_mfma_f32_16x16x32_bf16 v[208:211], v[68:71], a[8:11], v[208:211]
    v_mfma_f32_16x16x32_bf16 v[212:215], v[64:67], a[4:7], v[212:215]
    ds_read_b128 v[108:111], v3 offset:22528
    v_mfma_f32_16x16x32_bf16 v[212:215], v[68:71], a[12:15], v[212:215]
    buffer_load_dwordx4 v[20:23], v15, s[8:11], s30 offen offset:1024 sc1
    s_waitcnt lgkmcnt(8)
    v_mfma_f32_16x16x32_bf16 v[212:215], v[72:75], a[20:23], v[212:215]
    ds_read_b128 v[112:115], v3 offset:24576
    v_mfma_f32_16x16x32_bf16 v[212:215], v[76:79], a[28:31], v[212:215]
    v_mfma_f32_16x16x32_bf16 v[208:211], v[72:75], a[16:19], v[208:211]
    ds_read_b128 v[64:67], v3 offset:26624
    v_mfma_f32_16x16x32_bf16 v[208:211], v[76:79], a[24:27], v[208:211]
    s_waitcnt lgkmcnt(8)
    v_mfma_f32_16x16x32_bf16 v[208:211], v[80:83], a[32:35], v[208:211]
    ds_read_b128 v[68:71], v3 offset:28672
    buffer_load_dwordx4 v[24:27], v15, s[8:11], s30 offen offset:2048 sc1
    v_mfma_f32_16x16x32_bf16 v[208:211], v[84:87], a[40:43], v[208:211]
    v_mfma_f32_16x16x32_bf16 v[212:215], v[80:83], a[36:39], v[212:215]
    ds_read_b128 v[72:75], v3 offset:30720
    v_mfma_f32_16x16x32_bf16 v[212:215], v[84:87], a[44:47], v[212:215]
    s_waitcnt lgkmcnt(8)
    v_mfma_f32_16x16x32_bf16 v[212:215], v[88:91], a[52:55], v[212:215]
    ds_read_b128 v[76:79], v3 offset:1024
    v_mfma_f32_16x16x32_bf16 v[212:215], v[92:95], a[60:63], v[212:215]
    buffer_load_dwordx4 v[28:31], v15, s[8:11], s30 offen offset:3072 sc1
    v_mfma_f32_16x16x32_bf16 v[208:211], v[88:91], a[48:51], v[208:211]
    ds_read_b128 v[80:83], v3 offset:3072
    v_mfma_f32_16x16x32_bf16 v[208:211], v[92:95], a[56:59], v[208:211]
    s_waitcnt lgkmcnt(8)
    v_mfma_f32_16x16x32_bf16 v[208:211], v[96:99], a[64:67], v[208:211]
    ds_read_b128 v[84:87], v3 offset:5120
    v_mfma_f32_16x16x32_bf16 v[208:211], v[100:103], a[72:75], v[208:211]
    v_mfma_f32_16x16x32_bf16 v[212:215], v[96:99], a[68:71], v[212:215]
    ds_read_b128 v[88:91], v3 offset:7168
    s_add_u32 s30, s63, 83890176
    buffer_load_dwordx4 v[32:35], v15, s[8:11], s30 offen offset:0 sc1
    v_mfma_f32_16x16x32_bf16 v[212:215], v[100:103], a[76:79], v[212:215]
    s_waitcnt lgkmcnt(8)
    v_mfma_f32_16x16x32_bf16 v[212:215], v[104:107], a[84:87], v[212:215]
    ds_read_b128 v[92:95], v3 offset:9216
    v_mfma_f32_16x16x32_bf16 v[212:215], v[108:111], a[92:95], v[212:215]
    v_mfma_f32_16x16x32_bf16 v[208:211], v[104:107], a[80:83], v[208:211]
    ds_read_b128 v[96:99], v3 offset:11264
    v_mfma_f32_16x16x32_bf16 v[208:211], v[108:111], a[88:91], v[208:211]
    buffer_load_dwordx4 v[36:39], v15, s[8:11], s30 offen offset:1024 sc1
    s_waitcnt lgkmcnt(8)
    v_mfma_f32_16x16x32_bf16 v[208:211], v[112:115], a[96:99], v[208:211]
    ds_read_b128 v[100:103], v3 offset:13312
    v_mfma_f32_16x16x32_bf16 v[208:211], v[64:67], a[104:107], v[208:211]
    v_mfma_f32_16x16x32_bf16 v[212:215], v[112:115], a[100:103], v[212:215]
    ds_read_b128 v[104:107], v3 offset:15360
    v_mfma_f32_16x16x32_bf16 v[212:215], v[64:67], a[108:111], v[212:215]
    s_waitcnt lgkmcnt(8)
    v_mfma_f32_16x16x32_bf16 v[212:215], v[68:71], a[116:119], v[212:215]
    ds_read_b128 v[108:111], v3 offset:17408
    buffer_load_dwordx4 v[40:43], v15, s[8:11], s30 offen offset:2048 sc1
    v_mfma_f32_16x16x32_bf16 v[212:215], v[72:75], a[124:127], v[212:215]
    v_mfma_f32_16x16x32_bf16 v[208:211], v[68:71], a[112:115], v[208:211]
    ds_read_b128 v[112:115], v3 offset:19456
    v_mfma_f32_16x16x32_bf16 v[208:211], v[72:75], a[120:123], v[208:211]
    s_waitcnt lgkmcnt(8)
    v_mfma_f32_16x16x32_bf16 v[216:219], v[76:79], a[0:3], v[216:219]
    ds_read_b128 v[64:67], v3 offset:21504
    v_mfma_f32_16x16x32_bf16 v[216:219], v[80:83], a[8:11], v[216:219]
    buffer_load_dwordx4 v[44:47], v15, s[8:11], s30 offen offset:3072 sc1
    v_mfma_f32_16x16x32_bf16 v[220:223], v[76:79], a[4:7], v[220:223]
    ds_read_b128 v[68:71], v3 offset:23552
    v_mfma_f32_16x16x32_bf16 v[220:223], v[80:83], a[12:15], v[220:223]
    s_waitcnt lgkmcnt(8)
    v_mfma_f32_16x16x32_bf16 v[220:223], v[84:87], a[20:23], v[220:223]
    ds_read_b128 v[72:75], v3 offset:25600
    v_mfma_f32_16x16x32_bf16 v[220:223], v[88:91], a[28:31], v[220:223]
    v_mfma_f32_16x16x32_bf16 v[216:219], v[84:87], a[16:19], v[216:219]
    ds_read_b128 v[76:79], v3 offset:27648
    s_sub_u32 s30, s28, 2
    s_and_b32 s30, s30, 3
    s_bitcmp1_b32 s44, s30
    s_cselect_b32 s46, 0, 0x80000000
    v_or_b32 v15, s46, v7
    s_add_u32 s30, s30, s29
    s_lshl_b32 s30, s30, 2
    s_add_u32 s30, s30, s26
    s_lshl_b32 s63, s30, 15
    s_add_u32 s30, s63, 83910656
    buffer_load_dwordx4 v[60:63], v15, s[8:11], s30 offen sc1
    v_mfma_f32_16x16x32_bf16 v[216:219], v[88:91], a[24:27], v[216:219]
    s_waitcnt lgkmcnt(8)
    v_mfma_f32_16x16x32_bf16 v[216:219], v[92:95], a[32:35], v[216:219]
    ds_read_b128 v[80:83], v3 offset:29696
    v_mfma_f32_16x16x32_bf16 v[216:219], v[96:99], a[40:43], v[216:219]
    v_mfma_f32_16x16x32_bf16 v[220:223], v[92:95], a[36:39], v[220:223]
    ds_read_b128 v[84:87], v3 offset:31744
    v_mfma_f32_16x16x32_bf16 v[220:223], v[96:99], a[44:47], v[220:223]
    s_add_u32 s30, s63, 83894272
    buffer_load_dwordx4 a[160:163], v15, s[8:11], s30 offen offset:0 sc1
    s_waitcnt lgkmcnt(8)
    v_mfma_f32_16x16x32_bf16 v[220:223], v[100:103], a[52:55], v[220:223]
    s_waitcnt vmcnt(11)
    s_barrier
    ds_read_b128 v[88:91], v4 offset:0
    v_mfma_f32_16x16x32_bf16 v[220:223], v[104:107], a[60:63], v[220:223]
    v_mfma_f32_16x16x32_bf16 v[216:219], v[100:103], a[48:51], v[216:219]
    ds_read_b128 v[92:95], v4 offset:2048
    v_mfma_f32_16x16x32_bf16 v[216:219], v[104:107], a[56:59], v[216:219]
    s_waitcnt lgkmcnt(8)
    v_mfma_f32_16x16x32_bf16 v[216:219], v[108:111], a[64:67], v[216:219]
    ds_read_b128 v[96:99], v4 offset:4096
    buffer_load_dwordx4 a[164:167], v15, s[8:11], s30 offen offset:1024 sc1
    v_mfma_f32_16x16x32_bf16 v[216:219], v[112:115], a[72:75], v[216:219]
    v_mfma_f32_16x16x32_bf16 v[220:223], v[108:111], a[68:71], v[220:223]
    ds_read_b128 v[100:103], v4 offset:6144
    v_mfma_f32_16x16x32_bf16 v[220:223], v[112:115], a[76:79], v[220:223]
    s_waitcnt lgkmcnt(8)
    v_mfma_f32_16x16x32_bf16 v[220:223], v[64:67], a[84:87], v[220:223]
    ds_read_b128 v[104:107], v4 offset:8192
    v_mfma_f32_16x16x32_bf16 v[220:223], v[68:71], a[92:95], v[220:223]
    buffer_load_dwordx4 a[168:171], v15, s[8:11], s30 offen offset:2048 sc1
    v_mfma_f32_16x16x32_bf16 v[216:219], v[64:67], a[80:83], v[216:219]
    ds_read_b128 v[108:111], v4 offset:10240
    v_mfma_f32_16x16x32_bf16 v[216:219], v[68:71], a[88:91], v[216:219]
    s_waitcnt lgkmcnt(8)
    v_mfma_f32_16x16x32_bf16 v[216:219], v[72:75], a[96:99], v[216:219]
    ds_read_b128 v[112:115], v4 offset:12288
    v_mfma_f32_16x16x32_bf16 v[216:219], v[76:79], a[104:107], v[216:219]
    v_mfma_f32_16x16x32_bf16 v[220:223], v[72:75], a[100:103], v[220:223]
    ds_read_b128 v[64:67], v4 offset:14336
    buffer_load_dwordx4 a[172:175], v15, s[8:11], s30 offen offset:3072 sc1
    v_mfma_f32_16x16x32_bf16 v[220:223], v[76:79], a[108:111], v[220:223]
    s_waitcnt lgkmcnt(8)
    v_mfma_f32_16x16x32_bf16 v[220:223], v[80:83], a[116:119], v[220:223]
    ds_read_b128 v[68:71], v4 offset:16384
    v_mfma_f32_16x16x32_bf16 v[220:223], v[84:87], a[124:127], v[220:223]
    v_mfma_f32_16x16x32_bf16 v[216:219], v[80:83], a[112:115], v[216:219]
    ds_read_b128 v[72:75], v4 offset:18432
    v_mfma_f32_16x16x32_bf16 v[216:219], v[84:87], a[120:123], v[216:219]
    s_add_u32 s30, s63, 83898368
    buffer_load_dwordx4 a[176:179], v15, s[8:11], s30 offen offset:0 sc1
    s_waitcnt lgkmcnt(8)
    v_mfma_f32_16x16x32_bf16 v[224:227], v[88:91], a[0:3], v[224:227]
    ds_read_b128 v[76:79], v4 offset:20480
    v_mfma_f32_16x16x32_bf16 v[224:227], v[92:95], a[8:11], v[224:227]
    v_mfma_f32_16x16x32_bf16 v[228:231], v[88:91], a[4:7], v[228:231]
    ds_read_b128 v[80:83], v4 offset:22528
    v_mfma_f32_16x16x32_bf16 v[228:231], v[92:95], a[12:15], v[228:231]
    s_waitcnt lgkmcnt(8)
    v_mfma_f32_16x16x32_bf16 v[228:231], v[96:99], a[20:23], v[228:231]
    ds_read_b128 v[84:87], v4 offset:24576
    buffer_load_dwordx4 a[180:183], v15, s[8:11], s30 offen offset:1024 sc1
    v_mfma_f32_16x16x32_bf16 v[228:231], v[100:103], a[28:31], v[228:231]
    v_mfma_f32_16x16x32_bf16 v[224:227], v[96:99], a[16:19], v[224:227]
    ds_read_b128 v[88:91], v4 offset:26624
    v_mfma_f32_16x16x32_bf16 v[224:227], v[100:103], a[24:27], v[224:227]
    s_waitcnt lgkmcnt(8)
    v_mfma_f32_16x16x32_bf16 v[224:227], v[104:107], a[32:35], v[224:227]
    ds_read_b128 v[92:95], v4 offset:28672
    v_mfma_f32_16x16x32_bf16 v[224:227], v[108:111], a[40:43], v[224:227]
    buffer_load_dwordx4 a[184:187], v15, s[8:11], s30 offen offset:2048 sc1
    v_mfma_f32_16x16x32_bf16 v[228:231], v[104:107], a[36:39], v[228:231]
    ds_read_b128 v[96:99], v4 offset:30720
    v_mfma_f32_16x16x32_bf16 v[228:231], v[108:111], a[44:47], v[228:231]
    s_waitcnt lgkmcnt(8)
    v_mfma_f32_16x16x32_bf16 v[228:231], v[112:115], a[52:55], v[228:231]
    ds_read_b128 v[100:103], v4 offset:1024
    v_mfma_f32_16x16x32_bf16 v[228:231], v[64:67], a[60:63], v[228:231]
    v_mfma_f32_16x16x32_bf16 v[224:227], v[112:115], a[48:51], v[224:227]
    ds_read_b128 v[104:107], v4 offset:3072
    buffer_load_dwordx4 a[188:191], v15, s[8:11], s30 offen offset:3072 sc1
    v_mfma_f32_16x16x32_bf16 v[224:227], v[64:67], a[56:59], v[224:227]
    s_waitcnt lgkmcnt(8)
    v_mfma_f32_16x16x32_bf16 v[224:227], v[68:71], a[64:67], v[224:227]
    ds_read_b128 v[108:111], v4 offset:5120
    v_mfma_f32_16x16x32_bf16 v[224:227], v[72:75], a[72:75], v[224:227]
    v_mfma_f32_16x16x32_bf16 v[228:231], v[68:71], a[68:71], v[228:231]
    ds_read_b128 v[112:115], v4 offset:7168
    v_mfma_f32_16x16x32_bf16 v[228:231], v[72:75], a[76:79], v[228:231]
    s_sub_u32 s30, s28, 3
    s_and_b32 s30, s30, 3
    s_bitcmp1_b32 s44, s30
    s_cselect_b32 s46, 0, 0x80000000
    v_or_b32 v15, s46, v7
    s_add_u32 s30, s30, s29
    s_lshl_b32 s30, s30, 2
    s_add_u32 s30, s30, s26
    s_lshl_b32 s63, s30, 15
    s_add_u32 s30, s63, 83910656
    buffer_load_dwordx4 v[124:127], v15, s[8:11], s30 offen sc1
    s_waitcnt lgkmcnt(8)
    v_mfma_f32_16x16x32_bf16 v[228:231], v[76:79], a[84:87], v[228:231]
    ds_read_b128 v[64:67], v4 offset:9216
    v_mfma_f32_16x16x32_bf16 v[228:231], v[80:83], a[92:95], v[228:231]
    v_mfma_f32_16x16x32_bf16 v[224:227], v[76:79], a[80:83], v[224:227]
    ds_read_b128 v[68:71], v4 offset:11264
    v_mfma_f32_16x16x32_bf16 v[224:227], v[80:83], a[88:91], v[224:227]
    s_waitcnt lgkmcnt(8)
    v_mfma_f32_16x16x32_bf16 v[224:227], v[84:87], a[96:99], v[224:227]
    ds_read_b128 v[72:75], v4 offset:13312
    s_add_u32 s30, s63, 83902464
    buffer_load_dwordx4 a[192:195], v15, s[8:11], s30 offen offset:0 sc1
    v_mfma_f32_16x16x32_bf16 v[224:227], v[88:91], a[104:107], v[224:227]
    v_mfma_f32_16x16x32_bf16 v[228:231], v[84:87], a[100:103], v[228:231]
    ds_read_b128 v[76:79], v4 offset:15360
    v_mfma_f32_16x16x32_bf16 v[228:231], v[88:91], a[108:111], v[228:231]
    s_waitcnt lgkmcnt(8)
    v_mfma_f32_16x16x32_bf16 v[228:231], v[92:95], a[116:119], v[228:231]
    ds_read_b128 v[80:83], v4 offset:17408
    v_mfma_f32_16x16x32_bf16 v[228:231], v[96:99], a[124:127], v[228:231]
    buffer_load_dwordx4 a[196:199], v15, s[8:11], s30 offen offset:1024 sc1
    v_mfma_f32_16x16x32_bf16 v[224:227], v[92:95], a[112:115], v[224:227]
    ds_read_b128 v[84:87], v4 offset:19456
    v_mfma_f32_16x16x32_bf16 v[224:227], v[96:99], a[120:123], v[224:227]
    s_waitcnt lgkmcnt(8)
    v_mfma_f32_16x16x32_bf16 v[232:235], v[100:103], a[0:3], v[232:235]
    ds_read_b128 v[88:91], v4 offset:21504
    v_mfma_f32_16x16x32_bf16 v[232:235], v[104:107], a[8:11], v[232:235]
    v_mfma_f32_16x16x32_bf16 v[236:239], v[100:103], a[4:7], v[236:239]
    ds_read_b128 v[92:95], v4 offset:23552
    buffer_load_dwordx4 a[200:203], v15, s[8:11], s30 offen offset:2048 sc1
    v_mfma_f32_16x16x32_bf16 v[236:239], v[104:107], a[12:15], v[236:239]
    s_waitcnt lgkmcnt(8)
    v_mfma_f32_16x16x32_bf16 v[236:239], v[108:111], a[20:23], v[236:239]
    ds_read_b128 v[96:99], v4 offset:25600
    v_mfma_f32_16x16x32_bf16 v[236:239], v[112:115], a[28:31], v[236:239]
    v_mfma_f32_16x16x32_bf16 v[232:235], v[108:111], a[16:19], v[232:235]
    ds_read_b128 v[100:103], v4 offset:27648
    v_mfma_f32_16x16x32_bf16 v[232:235], v[112:115], a[24:27], v[232:235]
    buffer_load_dwordx4 a[204:207], v15, s[8:11], s30 offen offset:3072 sc1
    s_waitcnt lgkmcnt(8)
    v_mfma_f32_16x16x32_bf16 v[232:235], v[64:67], a[32:35], v[232:235]
    ds_read_b128 v[104:107], v4 offset:29696
    v_mfma_f32_16x16x32_bf16 v[232:235], v[68:71], a[40:43], v[232:235]
    v_mfma_f32_16x16x32_bf16 v[236:239], v[64:67], a[36:39], v[236:239]
    ds_read_b128 v[108:111], v4 offset:31744
    v_mfma_f32_16x16x32_bf16 v[236:239], v[68:71], a[44:47], v[236:239]
    s_waitcnt lgkmcnt(8)
    v_mfma_f32_16x16x32_bf16 v[236:239], v[72:75], a[52:55], v[236:239]
    ds_read_b128 v[64:67], v116 offset:0
    s_add_u32 s30, s63, 83906560
    buffer_load_dwordx4 a[208:211], v15, s[8:11], s30 offen offset:0 sc1
    v_mfma_f32_16x16x32_bf16 v[236:239], v[76:79], a[60:63], v[236:239]
    v_mfma_f32_16x16x32_bf16 v[232:235], v[72:75], a[48:51], v[232:235]
    ds_read_b128 v[68:71], v116 offset:2048
    v_mfma_f32_16x16x32_bf16 v[232:235], v[76:79], a[56:59], v[232:235]
    s_waitcnt lgkmcnt(8)
    v_mfma_f32_16x16x32_bf16 v[232:235], v[80:83], a[64:67], v[232:235]
    ds_read_b128 v[72:75], v116 offset:4096
    v_mfma_f32_16x16x32_bf16 v[232:235], v[84:87], a[72:75], v[232:235]
    buffer_load_dwordx4 a[212:215], v15, s[8:11], s30 offen offset:1024 sc1
    v_mfma_f32_16x16x32_bf16 v[236:239], v[80:83], a[68:71], v[236:239]
    ds_read_b128 v[76:79], v116 offset:6144
    v_mfma_f32_16x16x32_bf16 v[236:239], v[84:87], a[76:79], v[236:239]
    s_waitcnt lgkmcnt(8)
    v_mfma_f32_16x16x32_bf16 v[236:239], v[88:91], a[84:87], v[236:239]
    ds_read_b128 v[80:83], v116 offset:8192
    v_mfma_f32_16x16x32_bf16 v[236:239], v[92:95], a[92:95], v[236:239]
    v_mfma_f32_16x16x32_bf16 v[232:235], v[88:91], a[80:83], v[232:235]
    ds_read_b128 v[84:87], v116 offset:10240
    buffer_load_dwordx4 a[216:219], v15, s[8:11], s30 offen offset:2048 sc1
    v_mfma_f32_16x16x32_bf16 v[232:235], v[92:95], a[88:91], v[232:235]
    s_waitcnt lgkmcnt(8)
    v_mfma_f32_16x16x32_bf16 v[232:235], v[96:99], a[96:99], v[232:235]
    ds_read_b128 v[88:91], v116 offset:12288
    v_mfma_f32_16x16x32_bf16 v[232:235], v[100:103], a[104:107], v[232:235]
    v_mfma_f32_16x16x32_bf16 v[236:239], v[96:99], a[100:103], v[236:239]
    ds_read_b128 v[92:95], v116 offset:14336
    v_mfma_f32_16x16x32_bf16 v[236:239], v[100:103], a[108:111], v[236:239]
    buffer_load_dwordx4 a[220:223], v15, s[8:11], s30 offen offset:3072 sc1
    s_waitcnt lgkmcnt(8)
    v_mfma_f32_16x16x32_bf16 v[236:239], v[104:107], a[116:119], v[236:239]
    ds_read_b128 v[96:99], v116 offset:16384
    v_mfma_f32_16x16x32_bf16 v[236:239], v[108:111], a[124:127], v[236:239]
    v_mfma_f32_16x16x32_bf16 v[232:235], v[104:107], a[112:115], v[232:235]
    ds_read_b128 v[100:103], v116 offset:18432
    v_mfma_f32_16x16x32_bf16 v[232:235], v[108:111], a[120:123], v[232:235]
    s_waitcnt lgkmcnt(8)
    v_mfma_f32_16x16x32_bf16 v[240:243], v[64:67], a[0:3], v[240:243]
    ds_read_b128 v[104:107], v116 offset:20480
    buffer_load_dword v117, v119, s[8:11], s62 offen offset:4 sc1
    v_mfma_f32_16x16x32_bf16 v[240:243], v[68:71], a[8:11], v[240:243]
    v_mfma_f32_16x16x32_bf16 v[244:247], v[64:67], a[4:7], v[244:247]
    ds_read_b128 v[108:111], v116 offset:22528
    v_mfma_f32_16x16x32_bf16 v[244:247], v[68:71], a[12:15], v[244:247]
    s_waitcnt lgkmcnt(8)
    v_mfma_f32_16x16x32_bf16 v[244:247], v[72:75], a[20:23], v[244:247]
    ds_read_b128 v[112:115], v116 offset:24576
    v_mfma_f32_16x16x32_bf16 v[244:247], v[76:79], a[28:31], v[244:247]
    v_mfma_f32_16x16x32_bf16 v[240:243], v[72:75], a[16:19], v[240:243]
    ds_read_b128 v[64:67], v116 offset:26624
    v_mfma_f32_16x16x32_bf16 v[240:243], v[76:79], a[24:27], v[240:243]
    s_waitcnt lgkmcnt(8)
    v_mfma_f32_16x16x32_bf16 v[240:243], v[80:83], a[32:35], v[240:243]
    ds_read_b128 v[68:71], v116 offset:28672
    v_mfma_f32_16x16x32_bf16 v[240:243], v[84:87], a[40:43], v[240:243]
    v_mfma_f32_16x16x32_bf16 v[244:247], v[80:83], a[36:39], v[244:247]
    ds_read_b128 v[72:75], v116 offset:30720
    v_mfma_f32_16x16x32_bf16 v[244:247], v[84:87], a[44:47], v[244:247]
    s_waitcnt lgkmcnt(8)
    v_mfma_f32_16x16x32_bf16 v[244:247], v[88:91], a[52:55], v[244:247]
    ds_read_b128 v[76:79], v116 offset:1024
    v_mfma_f32_16x16x32_bf16 v[244:247], v[92:95], a[60:63], v[244:247]
    v_mfma_f32_16x16x32_bf16 v[240:243], v[88:91], a[48:51], v[240:243]
    ds_read_b128 v[80:83], v116 offset:3072
    v_mfma_f32_16x16x32_bf16 v[240:243], v[92:95], a[56:59], v[240:243]
    s_waitcnt lgkmcnt(8)
    v_mfma_f32_16x16x32_bf16 v[240:243], v[96:99], a[64:67], v[240:243]
    ds_read_b128 v[84:87], v116 offset:5120
    v_mfma_f32_16x16x32_bf16 v[240:243], v[100:103], a[72:75], v[240:243]
    v_mfma_f32_16x16x32_bf16 v[244:247], v[96:99], a[68:71], v[244:247]
    ds_read_b128 v[88:91], v116 offset:7168
    v_mfma_f32_16x16x32_bf16 v[244:247], v[100:103], a[76:79], v[244:247]
    s_waitcnt lgkmcnt(8)
    v_mfma_f32_16x16x32_bf16 v[244:247], v[104:107], a[84:87], v[244:247]
    ds_read_b128 v[92:95], v116 offset:9216
    v_mfma_f32_16x16x32_bf16 v[244:247], v[108:111], a[92:95], v[244:247]
    v_mfma_f32_16x16x32_bf16 v[240:243], v[104:107], a[80:83], v[240:243]
    ds_read_b128 v[96:99], v116 offset:11264
    v_mfma_f32_16x16x32_bf16 v[240:243], v[108:111], a[88:91], v[240:243]
    s_waitcnt lgkmcnt(8)
    v_mfma_f32_16x16x32_bf16 v[240:243], v[112:115], a[96:99], v[240:243]
    ds_read_b128 v[100:103], v116 offset:13312
    v_mfma_f32_16x16x32_bf16 v[240:243], v[64:67], a[104:107], v[240:243]
    v_mfma_f32_16x16x32_bf16 v[244:247], v[112:115], a[100:103], v[244:247]
    ds_read_b128 v[104:107], v116 offset:15360
    v_mfma_f32_16x16x32_bf16 v[244:247], v[64:67], a[108:111], v[244:247]
    s_waitcnt lgkmcnt(8)
    v_mfma_f32_16x16x32_bf16 v[244:247], v[68:71], a[116:119], v[244:247]
    ds_read_b128 v[108:111], v116 offset:17408
    v_mfma_f32_16x16x32_bf16 v[244:247], v[72:75], a[124:127], v[244:247]
    v_mfma_f32_16x16x32_bf16 v[240:243], v[68:71], a[112:115], v[240:243]
    ds_read_b128 v[112:115], v116 offset:19456
    v_mfma_f32_16x16x32_bf16 v[240:243], v[72:75], a[120:123], v[240:243]
    s_waitcnt lgkmcnt(8)
    v_mfma_f32_16x16x32_bf16 v[248:251], v[76:79], a[0:3], v[248:251]
    ds_read_b128 v[64:67], v116 offset:21504
    v_mfma_f32_16x16x32_bf16 v[248:251], v[80:83], a[8:11], v[248:251]
    v_mfma_f32_16x16x32_bf16 v[252:255], v[76:79], a[4:7], v[252:255]
    ds_read_b128 v[68:71], v116 offset:23552
    v_mfma_f32_16x16x32_bf16 v[252:255], v[80:83], a[12:15], v[252:255]
    s_waitcnt lgkmcnt(8)
    v_mfma_f32_16x16x32_bf16 v[252:255], v[84:87], a[20:23], v[252:255]
    ds_read_b128 v[72:75], v116 offset:25600
    v_mfma_f32_16x16x32_bf16 v[252:255], v[88:91], a[28:31], v[252:255]
    v_mfma_f32_16x16x32_bf16 v[248:251], v[84:87], a[16:19], v[248:251]
    ds_read_b128 v[76:79], v116 offset:27648
    v_mfma_f32_16x16x32_bf16 v[248:251], v[88:91], a[24:27], v[248:251]
    s_waitcnt lgkmcnt(8)
    v_mfma_f32_16x16x32_bf16 v[248:251], v[92:95], a[32:35], v[248:251]
    ds_read_b128 v[80:83], v116 offset:29696
    v_mfma_f32_16x16x32_bf16 v[248:251], v[96:99], a[40:43], v[248:251]
    v_mfma_f32_16x16x32_bf16 v[252:255], v[92:95], a[36:39], v[252:255]
    ds_read_b128 v[84:87], v116 offset:31744
    v_mfma_f32_16x16x32_bf16 v[252:255], v[96:99], a[44:47], v[252:255]
    s_waitcnt lgkmcnt(8)
    v_mfma_f32_16x16x32_bf16 v[252:255], v[100:103], a[52:55], v[252:255]
    v_mfma_f32_16x16x32_bf16 v[252:255], v[104:107], a[60:63], v[252:255]
    v_mfma_f32_16x16x32_bf16 v[248:251], v[100:103], a[48:51], v[248:251]
    v_mfma_f32_16x16x32_bf16 v[248:251], v[104:107], a[56:59], v[248:251]
    s_waitcnt lgkmcnt(6)
    v_mfma_f32_16x16x32_bf16 v[248:251], v[108:111], a[64:67], v[248:251]
    v_mfma_f32_16x16x32_bf16 v[248:251], v[112:115], a[72:75], v[248:251]
    v_mfma_f32_16x16x32_bf16 v[252:255], v[108:111], a[68:71], v[252:255]
    v_mfma_f32_16x16x32_bf16 v[252:255], v[112:115], a[76:79], v[252:255]
    s_waitcnt lgkmcnt(4)
    v_mfma_f32_16x16x32_bf16 v[252:255], v[64:67], a[84:87], v[252:255]
    v_mfma_f32_16x16x32_bf16 v[252:255], v[68:71], a[92:95], v[252:255]
    v_mfma_f32_16x16x32_bf16 v[248:251], v[64:67], a[80:83], v[248:251]
    v_mfma_f32_16x16x32_bf16 v[248:251], v[68:71], a[88:91], v[248:251]
    s_waitcnt lgkmcnt(2)
    v_mfma_f32_16x16x32_bf16 v[248:251], v[72:75], a[96:99], v[248:251]
    v_mfma_f32_16x16x32_bf16 v[248:251], v[76:79], a[104:107], v[248:251]
    v_mfma_f32_16x16x32_bf16 v[252:255], v[72:75], a[100:103], v[252:255]
    v_mfma_f32_16x16x32_bf16 v[252:255], v[76:79], a[108:111], v[252:255]
    s_waitcnt lgkmcnt(0)
    v_mfma_f32_16x16x32_bf16 v[252:255], v[80:83], a[116:119], v[252:255]
    v_mfma_f32_16x16x32_bf16 v[252:255], v[84:87], a[124:127], v[252:255]
    v_mfma_f32_16x16x32_bf16 v[248:251], v[80:83], a[112:115], v[248:251]
    v_mfma_f32_16x16x32_bf16 v[248:251], v[84:87], a[120:123], v[248:251]
L_spin:
    s_waitcnt vmcnt(0)
    v_cmp_eq_u32 vcc, s75, v117
    s_nop 3
    s_and_b32 s44, vcc_lo, 15
    s_andn2_b32 s44, s44, s25
    s_or_b32 s25, s25, s44
    s_sub_u32 s30, s28, 1
    s_and_b32 s30, s30, 3
    s_bitcmp1_b32 s44, s30
    s_cbranch_scc0 L_ck_4
    s_add_u32 s30, s30, s29
    s_lshl_b32 s30, s30, 2
    s_add_u32 s30, s30, s26
    s_lshl_b32 s63, s30, 15
    s_add_u32 s30, s63, 83910656
    buffer_load_dwordx4 v[56:59], v7, s[8:11], s30 offen sc1
    s_add_u32 s30, s63, 83886080
    buffer_load_dwordx4 v[16:19], v7, s[8:11], s30 offen offset:0 sc1
    buffer_load_dwordx4 v[20:23], v7, s[8:11], s30 offen offset:1024 sc1
    buffer_load_dwordx4 v[24:27], v7, s[8:11], s30 offen offset:2048 sc1
    buffer_load_dwordx4 v[28:31], v7, s[8:11], s30 offen offset:3072 sc1
    s_add_u32 s30, s63, 83890176
    buffer_load_dwordx4 v[32:35], v7, s[8:11], s30 offen offset:0 sc1
    buffer_load_dwordx4 v[36:39], v7, s[8:11], s30 offen offset:1024 sc1
    buffer_load_dwordx4 v[40:43], v7, s[8:11], s30 offen offset:2048 sc1
    buffer_load_dwordx4 v[44:47], v7, s[8:11], s30 offen offset:3072 sc1
L_ck_4:
    s_sub_u32 s30, s28, 2
    s_and_b32 s30, s30, 3
    s_bitcmp1_b32 s44, s30
    s_cbranch_scc0 L_ck_5
    s_add_u32 s30, s30, s29
    s_lshl_b32 s30, s30, 2
    s_add_u32 s30, s30, s26
    s_lshl_b32 s63, s30, 15
    s_add_u32 s30, s63, 83910656
    buffer_load_dwordx4 v[60:63], v7, s[8:11], s30 offen sc1
    s_add_u32 s30, s63, 83894272
    buffer_load_dwordx4 a[160:163], v7, s[8:11], s30 offen offset:0 sc1
    buffer_load_dwordx4 a[164:167], v7, s[8:11], s30 offen offset:1024 sc1
    buffer_load_dwordx4 a[168:171], v7, s[8:11], s30 offen offset:2048 sc1
    buffer_load_dwordx4 a[172:175], v7, s[8:11], s30 offen offset:3072 sc1
    s_add_u32 s30, s63, 83898368
    buffer_load_dwordx4 a[176:179], v7, s[8:11], s30 offen offset:0 sc1
    buffer_load_dwordx4 a[180:183], v7, s[8:11], s30 offen offset:1024 sc1
    buffer_load_dwordx4 a[184:187], v7, s[8:11], s30 offen offset:2048 sc1
    buffer_load_dwordx4 a[188:191], v7, s[8:11], s30 offen offset:3072 sc1
L_ck_5:
    s_sub_u32 s30, s28, 3
    s_and_b32 s30, s30, 3
    s_bitcmp1_b32 s44, s30
    s_cbranch_scc0 L_ck_6
    s_add_u32 s30, s30, s29
    s_lshl_b32 s30, s30, 2
    s_add_u32 s30, s30, s26
    s_lshl_b32 s63, s30, 15
    s_add_u32 s30, s63, 83910656
    buffer_load_dwordx4 v[124:127], v7, s[8:11], s30 offen sc1
    s_add_u32 s30, s63, 83902464
    buffer_load_dwordx4 a[192:195], v7, s[8:11], s30 offen offset:0 sc1
    buffer_load_dwordx4 a[196:199], v7, s[8:11], s30 offen offset:1024 sc1
    buffer_load_dwordx4 a[200:203], v7, s[8:11], s30 offen offset:2048 sc1
    buffer_load_dwordx4 a[204:207], v7, s[8:11], s30 offen offset:3072 sc1
    s_add_u32 s30, s63, 83906560
    buffer_load_dwordx4 a[208:211], v7, s[8:11], s30 offen offset:0 sc1
    buffer_load_dwordx4 a[212:215], v7, s[8:11], s30 offen offset:1024 sc1
    buffer_load_dwordx4 a[216:219], v7, s[8:11], s30 offen offset:2048 sc1
    buffer_load_dwordx4 a[220:223], v7, s[8:11], s30 offen offset:3072 sc1
L_ck_6:
    s_cmp_eq_u32 s25, 15
    s_cbranch_scc1 L_got
    buffer_load_dword v117, v119, s[8:11], s62 offen offset:4 sc1
    s_branch L_spin
L_got:
    s_waitcnt vmcnt(0)
    v_max3_f32 v13, v121, v57, v61
    v_max_f32 v13, v13, v125
    v_max3_f32 v14, v123, v59, v63
    v_max_f32 v14, v14, v127
    v_sub_f32 v121, v121, v13
    v_sub_f32 v57, v57, v13
    v_sub_f32 v61, v61, v13
    v_sub_f32 v125, v125, v13
    v_sub_f32 v123, v123, v14
    v_sub_f32 v59, v59, v14
    v_sub_f32 v63, v63, v14
    v_sub_f32 v127, v127, v14
    v_exp_f32 v121, v121
    v_exp_f32 v57, v57
    v_exp_f32 v61, v61
    v_exp_f32 v125, v125
    v_exp_f32 v123, v123
    v_exp_f32 v59, v59
    v_exp_f32 v63, v63
    v_exp_f32 v127, v127
    v_mul_f32 v13, v120, v121
    v_mul_f32 v14, v122, v123
    v_fmac_f32 v13, v56, v57
    v_fmac_f32 v14, v58, v59
    v_fmac_f32 v13, v60, v61
    v_fmac_f32 v14, v62, v63
    v_fmac_f32 v13, v124, v125
    v_fmac_f32 v14, v126, v127
    v_rcp_f32 v13, v13
    v_rcp_f32 v14, v14
    s_nop 0
    v_mul_f32 v121, v121, v13
    v_mul_f32 v57, v57, v13
    v_mul_f32 v61, v61, v13
    v_mul_f32 v125, v125, v13
    v_mul_f32 v123, v123, v14
    v_mul_f32 v59, v59, v14
    v_mul_f32 v63, v63, v14
    v_mul_f32 v127, v127, v14
    v_or_b32 v48, s31, v48
    v_or_b32 v49, s31, v49
    v_or_b32 v50, s31, v50
    v_or_b32 v51, s31, v51
    v_pk_fma_f32 v[192:193], v[128:129], v[120:121], v[192:193] op_sel:[0,1,0] op_sel_hi:[1,1,1]
    v_pk_fma_f32 v[194:195], v[130:131], v[120:121], v[194:195] op_sel:[0,1,0] op_sel_hi:[1,1,1]
    v_pk_fma_f32 v[200:201], v[136:137], v[120:121], v[200:201] op_sel:[0,1,0] op_sel_hi:[1,1,1]
    v_pk_fma_f32 v[202:203], v[138:139], v[120:121], v[202:203] op_sel:[0,1,0] op_sel_hi:[1,1,1]
    v_lshlrev_b32 v64, 16, v16
    v_and_b32 v65, 0xffff0000, v16
    v_lshlrev_b32 v66, 16, v17
    v_and_b32 v67, 0xffff0000, v17
    v_lshlrev_b32 v68, 16, v18
    v_and_b32 v69, 0xffff0000, v18
    v_lshlrev_b32 v70, 16, v19
    v_and_b32 v71, 0xffff0000, v19
    v_pk_fma_f32 v[192:193], v[64:65], v[56:57], v[192:193] op_sel:[0,1,0] op_sel_hi:[1,1,1]
    v_pk_fma_f32 v[194:195], v[66:67], v[56:57], v[194:195] op_sel:[0,1,0] op_sel_hi:[1,1,1]
    v_pk_fma_f32 v[200:201], v[68:69], v[56:57], v[200:201] op_sel:[0,1,0] op_sel_hi:[1,1,1]
    v_pk_fma_f32 v[202:203], v[70:71], v[56:57], v[202:203] op_sel:[0,1,0] op_sel_hi:[1,1,1]
    v_accvgpr_read_b32 v84, a160
    v_accvgpr_read_b32 v85, a161
    v_accvgpr_read_b32 v86, a162
    v_accvgpr_read_b32 v87, a163
    v_lshlrev_b32 v76, 16, v84
    v_and_b32 v77, 0xffff0000, v84
    v_lshlrev_b32 v78, 16, v85
    v_and_b32 v79, 0xffff0000, v85
    v_lshlrev_b32 v80, 16, v86
    v_and_b32 v81, 0xffff0000, v86
    v_lshlrev_b32 v82, 16, v87
    v_and_b32 v83, 0xffff0000, v87
    v_pk_fma_f32 v[192:193], v[76:77], v[60:61], v[192:193] op_sel:[0,1,0] op_sel_hi:[1,1,1]
    v_pk_fma_f32 v[194:195], v[78:79], v[60:61], v[194:195] op_sel:[0,1,0] op_sel_hi:[1,1,1]
    v_pk_fma_f32 v[200:201], v[80:81], v[60:61], v[200:201] op_sel:[0,1,0] op_sel_hi:[1,1,1]
    v_pk_fma_f32 v[202:203], v[82:83], v[60:61], v[202:203] op_sel:[0,1,0] op_sel_hi:[1,1,1]
    v_accvgpr_read_b32 v96, a192
    v_accvgpr_read_b32 v97, a193
    v_accvgpr_read_b32 v98, a194
    v_accvgpr_read_b32 v99, a195
    v_lshlrev_b32 v88, 16, v96
    v_and_b32 v89, 0xffff0000, v96
    v_lshlrev_b32 v90, 16, v97
    v_and_b32 v91, 0xffff0000, v97
    v_lshlrev_b32 v92, 16, v98
    v_and_b32 v93, 0xffff0000, v98
    v_lshlrev_b32 v94, 16, v99
    v_and_b32 v95, 0xffff0000, v99
    v_pk_fma_f32 v[192:193], v[88:89], v[124:125], v[192:193] op_sel:[0,1,0] op_sel_hi:[1,1,1]
    v_pk_fma_f32 v[194:195], v[90:91], v[124:125], v[194:195] op_sel:[0,1,0] op_sel_hi:[1,1,1]
    v_pk_fma_f32 v[200:201], v[92:93], v[124:125], v[200:201] op_sel:[0,1,0] op_sel_hi:[1,1,1]
    v_pk_fma_f32 v[202:203], v[94:95], v[124:125], v[202:203] op_sel:[0,1,0] op_sel_hi:[1,1,1]
    v_cvt_pk_bf16_f32 v100, v192, v193
    v_cvt_pk_bf16_f32 v101, v194, v195
    v_cvt_pk_bf16_f32 v102, v200, v201
    v_cvt_pk_bf16_f32 v103, v202, v203
    ds_write_b128 v52, v[100:103] offset:0
    v_pk_fma_f32 v[208:209], v[144:145], v[120:121], v[208:209] op_sel:[0,1,0] op_sel_hi:[1,1,1]
    v_pk_fma_f32 v[210:211], v[146:147], v[120:121], v[210:211] op_sel:[0,1,0] op_sel_hi:[1,1,1]
    v_pk_fma_f32 v[216:217], v[152:153], v[120:121], v[216:217] op_sel:[0,1,0] op_sel_hi:[1,1,1]
    v_pk_fma_f32 v[218:219], v[154:155], v[120:121], v[218:219] op_sel:[0,1,0] op_sel_hi:[1,1,1]
    v_lshlrev_b32 v64, 16, v24
    v_and_b32 v65, 0xffff0000, v24
    v_lshlrev_b32 v66, 16, v25
    v_and_b32 v67, 0xffff0000, v25
    v_lshlrev_b32 v68, 16, v26
    v_and_b32 v69, 0xffff0000, v26
    v_lshlrev_b32 v70, 16, v27
    v_and_b32 v71, 0xffff0000, v27
    v_pk_fma_f32 v[208:209], v[64:65], v[56:57], v[208:209] op_sel:[0,1,0] op_sel_hi:[1,1,1]
    v_pk_fma_f32 v[210:211], v[66:67], v[56:57], v[210:211] op_sel:[0,1,0] op_sel_hi:[1,1,1]
    v_pk_fma_f32 v[216:217], v[68:69], v[56:57], v[216:217] op_sel:[0,1,0] op_sel_hi:[1,1,1]
    v_pk_fma_f32 v[218:219], v[70:71], v[56:57], v[218:219] op_sel:[0,1,0] op_sel_hi:[1,1,1]
    v_accvgpr_read_b32 v84, a168
    v_accvgpr_read_b32 v85, a169
    v_accvgpr_read_b32 v86, a170
    v_accvgpr_read_b32 v87, a171
    v_lshlrev_b32 v76, 16, v84
    v_and_b32 v77, 0xffff0000, v84
    v_lshlrev_b32 v78, 16, v85
    v_and_b32 v79, 0xffff0000, v85
    v_lshlrev_b32 v80, 16, v86
    v_and_b32 v81, 0xffff0000, v86
    v_lshlrev_b32 v82, 16, v87
    v_and_b32 v83, 0xffff0000, v87
    v_pk_fma_f32 v[208:209], v[76:77], v[60:61], v[208:209] op_sel:[0,1,0] op_sel_hi:[1,1,1]
    v_pk_fma_f32 v[210:211], v[78:79], v[60:61], v[210:211] op_sel:[0,1,0] op_sel_hi:[1,1,1]
    v_pk_fma_f32 v[216:217], v[80:81], v[60:61], v[216:217] op_sel:[0,1,0] op_sel_hi:[1,1,1]
    v_pk_fma_f32 v[218:219], v[82:83], v[60:61], v[218:219] op_sel:[0,1,0] op_sel_hi:[1,1,1]
    v_accvgpr_read_b32 v96, a200
    v_accvgpr_read_b32 v97, a201
    v_accvgpr_read_b32 v98, a202
    v_accvgpr_read_b32 v99, a203
    v_lshlrev_b32 v88, 16, v96
    v_and_b32 v89, 0xffff0000, v96
    v_lshlrev_b32 v90, 16, v97
    v_and_b32 v91, 0xffff0000, v97
    v_lshlrev_b32 v92, 16, v98
    v_and_b32 v93, 0xffff0000, v98
    v_lshlrev_b32 v94, 16, v99
    v_and_b32 v95, 0xffff0000, v99
    v_pk_fma_f32 v[208:209], v[88:89], v[124:125], v[208:209] op_sel:[0,1,0] op_sel_hi:[1,1,1]
    v_pk_fma_f32 v[210:211], v[90:91], v[124:125], v[210:211] op_sel:[0,1,0] op_sel_hi:[1,1,1]
    v_pk_fma_f32 v[216:217], v[92:93], v[124:125], v[216:217] op_sel:[0,1,0] op_sel_hi:[1,1,1]
    v_pk_fma_f32 v[218:219], v[94:95], v[124:125], v[218:219] op_sel:[0,1,0] op_sel_hi:[1,1,1]
    v_cvt_pk_bf16_f32 v104, v208, v209
    v_cvt_pk_bf16_f32 v105, v210, v211
    v_cvt_pk_bf16_f32 v106, v216, v217
    v_cvt_pk_bf16_f32 v107, v218, v219
    ds_write_b128 v53, v[104:107] offset:0
    v_pk_fma_f32 v[224:225], v[160:161], v[120:121], v[224:225] op_sel:[0,1,0] op_sel_hi:[1,1,1]
    v_pk_fma_f32 v[226:227], v[162:163], v[120:121], v[226:227] op_sel:[0,1,0] op_sel_hi:[1,1,1]
    v_pk_fma_f32 v[232:233], v[168:169], v[120:121], v[232:233] op_sel:[0,1,0] op_sel_hi:[1,1,1]
    v_pk_fma_f32 v[234:235], v[170:171], v[120:121], v[234:235] op_sel:[0,1,0] op_sel_hi:[1,1,1]
    v_lshlrev_b32 v64, 16, v32
    v_and_b32 v65, 0xffff0000, v32
    v_lshlrev_b32 v66, 16, v33
    v_and_b32 v67, 0xffff0000, v33
    v_lshlrev_b32 v68, 16, v34
    v_and_b32 v69, 0xffff0000, v34
    v_lshlrev_b32 v70, 16, v35
    v_and_b32 v71, 0xffff0000, v35
    v_pk_fma_f32 v[224:225], v[64:65], v[56:57], v[224:225] op_sel:[0,1,0] op_sel_hi:[1,1,1]
    v_pk_fma_f32 v[226:227], v[66:67], v[56:57], v[226:227] op_sel:[0,1,0] op_sel_hi:[1,1,1]
    v_pk_fma_f32 v[232:233], v[68:69], v[56:57], v[232:233] op_sel:[0,1,0] op_sel_hi:[1,1,1]
    v_pk_fma_f32 v[234:235], v[70:71], v[56:57], v[234:235] op_sel:[0,1,0] op_sel_hi:[1,1,1]
    v_accvgpr_read_b32 v84, a176
    v_accvgpr_read_b32 v85, a177
    v_accvgpr_read_b32 v86, a178
    v_accvgpr_read_b32 v87, a179
    v_lshlrev_b32 v76, 16, v84
    v_and_b32 v77, 0xffff0000, v84
    v_lshlrev_b32 v78, 16, v85
    v_and_b32 v79, 0xffff0000, v85
    v_lshlrev_b32 v80, 16, v86
    v_and_b32 v81, 0xffff0000, v86
    v_lshlrev_b32 v82, 16, v87
    v_and_b32 v83, 0xffff0000, v87
    v_pk_fma_f32 v[224:225], v[76:77], v[60:61], v[224:225] op_sel:[0,1,0] op_sel_hi:[1,1,1]
    v_pk_fma_f32 v[226:227], v[78:79], v[60:61], v[226:227] op_sel:[0,1,0] op_sel_hi:[1,1,1]
    v_pk_fma_f32 v[232:233], v[80:81], v[60:61], v[232:233] op_sel:[0,1,0] op_sel_hi:[1,1,1]
    v_pk_fma_f32 v[234:235], v[82:83], v[60:61], v[234:235] op_sel:[0,1,0] op_sel_hi:[1,1,1]
    v_accvgpr_read_b32 v96, a208
    v_accvgpr_read_b32 v97, a209
    v_accvgpr_read_b32 v98, a210
    v_accvgpr_read_b32 v99, a211
    v_lshlrev_b32 v88, 16, v96
    v_and_b32 v89, 0xffff0000, v96
    v_lshlrev_b32 v90, 16, v97
    v_and_b32 v91, 0xffff0000, v97
    v_lshlrev_b32 v92, 16, v98
    v_and_b32 v93, 0xffff0000, v98
    v_lshlrev_b32 v94, 16, v99
    v_and_b32 v95, 0xffff0000, v99
    v_pk_fma_f32 v[224:225], v[88:89], v[124:125], v[224:225] op_sel:[0,1,0] op_sel_hi:[1,1,1]
    v_pk_fma_f32 v[226:227], v[90:91], v[124:125], v[226:227] op_sel:[0,1,0] op_sel_hi:[1,1,1]
    v_pk_fma_f32 v[232:233], v[92:93], v[124:125], v[232:233] op_sel:[0,1,0] op_sel_hi:[1,1,1]
    v_pk_fma_f32 v[234:235], v[94:95], v[124:125], v[234:235] op_sel:[0,1,0] op_sel_hi:[1,1,1]
    v_cvt_pk_bf16_f32 v100, v224, v225
    v_cvt_pk_bf16_f32 v101, v226, v227
    v_cvt_pk_bf16_f32 v102, v232, v233
    v_cvt_pk_bf16_f32 v103, v234, v235
    ds_write_b128 v54, v[100:103] offset:0
    v_pk_fma_f32 v[240:241], v[176:177], v[120:121], v[240:241] op_sel:[0,1,0] op_sel_hi:[1,1,1]
    v_pk_fma_f32 v[242:243], v[178:179], v[120:121], v[242:243] op_sel:[0,1,0] op_sel_hi:[1,1,1]
    v_pk_fma_f32 v[248:249], v[184:185], v[120:121], v[248:249] op_sel:[0,1,0] op_sel_hi:[1,1,1]
    v_pk_fma_f32 v[250:251], v[186:187], v[120:121], v[250:251] op_sel:[0,1,0] op_sel_hi:[1,1,1]
    v_lshlrev_b32 v64, 16, v40
    v_and_b32 v65, 0xffff0000, v40
    v_lshlrev_b32 v66, 16, v41
    v_and_b32 v67, 0xffff0000, v41
    v_lshlrev_b32 v68, 16, v42
    v_and_b32 v69, 0xffff0000, v42
    v_lshlrev_b32 v70, 16, v43
    v_and_b32 v71, 0xffff0000, v43
    v_pk_fma_f32 v[240:241], v[64:65], v[56:57], v[240:241] op_sel:[0,1,0] op_sel_hi:[1,1,1]
    v_pk_fma_f32 v[242:243], v[66:67], v[56:57], v[242:243] op_sel:[0,1,0] op_sel_hi:[1,1,1]
    v_pk_fma_f32 v[248:249], v[68:69], v[56:57], v[248:249] op_sel:[0,1,0] op_sel_hi:[1,1,1]
    v_pk_fma_f32 v[250:251], v[70:71], v[56:57], v[250:251] op_sel:[0,1,0] op_sel_hi:[1,1,1]
    v_accvgpr_read_b32 v84, a184
    v_accvgpr_read_b32 v85, a185
    v_accvgpr_read_b32 v86, a186
    v_accvgpr_read_b32 v87, a187
    v_lshlrev_b32 v76, 16, v84
    v_and_b32 v77, 0xffff0000, v84
    v_lshlrev_b32 v78, 16, v85
    v_and_b32 v79, 0xffff0000, v85
    v_lshlrev_b32 v80, 16, v86
    v_and_b32 v81, 0xffff0000, v86
    v_lshlrev_b32 v82, 16, v87
    v_and_b32 v83, 0xffff0000, v87
    v_pk_fma_f32 v[240:241], v[76:77], v[60:61], v[240:241] op_sel:[0,1,0] op_sel_hi:[1,1,1]
    v_pk_fma_f32 v[242:243], v[78:79], v[60:61], v[242:243] op_sel:[0,1,0] op_sel_hi:[1,1,1]
    v_pk_fma_f32 v[248:249], v[80:81], v[60:61], v[248:249] op_sel:[0,1,0] op_sel_hi:[1,1,1]
    v_pk_fma_f32 v[250:251], v[82:83], v[60:61], v[250:251] op_sel:[0,1,0] op_sel_hi:[1,1,1]
    v_accvgpr_read_b32 v96, a216
    v_accvgpr_read_b32 v97, a217
    v_accvgpr_read_b32 v98, a218
    v_accvgpr_read_b32 v99, a219
    v_lshlrev_b32 v88, 16, v96
    v_and_b32 v89, 0xffff0000, v96
    v_lshlrev_b32 v90, 16, v97
    v_and_b32 v91, 0xffff0000, v97
    v_lshlrev_b32 v92, 16, v98
    v_and_b32 v93, 0xffff0000, v98
    v_lshlrev_b32 v94, 16, v99
    v_and_b32 v95, 0xffff0000, v99
    v_pk_fma_f32 v[240:241], v[88:89], v[124:125], v[240:241] op_sel:[0,1,0] op_sel_hi:[1,1,1]
    v_pk_fma_f32 v[242:243], v[90:91], v[124:125], v[242:243] op_sel:[0,1,0] op_sel_hi:[1,1,1]
    v_pk_fma_f32 v[248:249], v[92:93], v[124:125], v[248:249] op_sel:[0,1,0] op_sel_hi:[1,1,1]
    v_pk_fma_f32 v[250:251], v[94:95], v[124:125], v[250:251] op_sel:[0,1,0] op_sel_hi:[1,1,1]
    v_cvt_pk_bf16_f32 v104, v240, v241
    v_cvt_pk_bf16_f32 v105, v242, v243
    v_cvt_pk_bf16_f32 v106, v248, v249
    v_cvt_pk_bf16_f32 v107, v250, v251
    ds_write_b128 v55, v[104:107] offset:0
    ds_read_b128 v[128:131], v118 offset:0
    ds_read_b128 v[136:139], v118 offset:1024
    ds_read_b128 v[144:147], v118 offset:2048
    ds_read_b128 v[152:155], v118 offset:3072
    v_pk_fma_f32 v[196:197], v[132:133], v[122:123], v[196:197] op_sel:[0,1,0] op_sel_hi:[1,1,1]
    v_pk_fma_f32 v[198:199], v[134:135], v[122:123], v[198:199] op_sel:[0,1,0] op_sel_hi:[1,1,1]
    v_pk_fma_f32 v[204:205], v[140:141], v[122:123], v[204:205] op_sel:[0,1,0] op_sel_hi:[1,1,1]
    v_pk_fma_f32 v[206:207], v[142:143], v[122:123], v[206:207] op_sel:[0,1,0] op_sel_hi:[1,1,1]
    v_lshlrev_b32 v64, 16, v20
    v_and_b32 v65, 0xffff0000, v20
    v_lshlrev_b32 v66, 16, v21
    v_and_b32 v67, 0xffff0000, v21
    v_lshlrev_b32 v68, 16, v22
    v_and_b32 v69, 0xffff0000, v22
    v_lshlrev_b32 v70, 16, v23
    v_and_b32 v71, 0xffff0000, v23
    v_pk_fma_f32 v[196:197], v[64:65], v[58:59], v[196:197] op_sel:[0,1,0] op_sel_hi:[1,1,1]
    v_pk_fma_f32 v[198:199], v[66:67], v[58:59], v[198:199] op_sel:[0,1,0] op_sel_hi:[1,1,1]
    v_pk_fma_f32 v[204:205], v[68:69], v[58:59], v[204:205] op_sel:[0,1,0] op_sel_hi:[1,1,1]
    v_pk_fma_f32 v[206:207], v[70:71], v[58:59], v[206:207] op_sel:[0,1,0] op_sel_hi:[1,1,1]
    v_accvgpr_read_b32 v84, a164
    v_accvgpr_read_b32 v85, a165
    v_accvgpr_read_b32 v86, a166
    v_accvgpr_read_b32 v87, a167
    v_lshlrev_b32 v76, 16, v84
    v_and_b32 v77, 0xffff0000, v84
    v_lshlrev_b32 v78, 16, v85
    v_and_b32 v79, 0xffff0000, v85
    v_lshlrev_b32 v80, 16, v86
    v_and_b32 v81, 0xffff0000, v86
    v_lshlrev_b32 v82, 16, v87
    v_and_b32 v83, 0xffff0000, v87
    v_pk_fma_f32 v[196:197], v[76:77], v[62:63], v[196:197] op_sel:[0,1,0] op_sel_hi:[1,1,1]
    v_pk_fma_f32 v[198:199], v[78:79], v[62:63], v[198:199] op_sel:[0,1,0] op_sel_hi:[1,1,1]
    v_pk_fma_f32 v[204:205], v[80:81], v[62:63], v[204:205] op_sel:[0,1,0] op_sel_hi:[1,1,1]
    v_pk_fma_f32 v[206:207], v[82:83], v[62:63], v[206:207] op_sel:[0,1,0] op_sel_hi:[1,1,1]
    v_accvgpr_read_b32 v96, a196
    v_accvgpr_read_b32 v97, a197
    v_accvgpr_read_b32 v98, a198
    v_accvgpr_read_b32 v99, a199
    v_lshlrev_b32 v88, 16, v96
    v_and_b32 v89, 0xffff0000, v96
    v_lshlrev_b32 v90, 16, v97
    v_and_b32 v91, 0xffff0000, v97
    v_lshlrev_b32 v92, 16, v98
    v_and_b32 v93, 0xffff0000, v98
    v_lshlrev_b32 v94, 16, v99
    v_and_b32 v95, 0xffff0000, v99
    v_pk_fma_f32 v[196:197], v[88:89], v[126:127], v[196:197] op_sel:[0,1,0] op_sel_hi:[1,1,1]
    v_pk_fma_f32 v[198:199], v[90:91], v[126:127], v[198:199] op_sel:[0,1,0] op_sel_hi:[1,1,1]
    v_pk_fma_f32 v[204:205], v[92:93], v[126:127], v[204:205] op_sel:[0,1,0] op_sel_hi:[1,1,1]
    v_pk_fma_f32 v[206:207], v[94:95], v[126:127], v[206:207] op_sel:[0,1,0] op_sel_hi:[1,1,1]
    v_cvt_pk_bf16_f32 v100, v196, v197
    v_cvt_pk_bf16_f32 v101, v198, v199
    v_cvt_pk_bf16_f32 v102, v204, v205
    v_cvt_pk_bf16_f32 v103, v206, v207
    ds_write_b128 v52, v[100:103] offset:4096
    s_waitcnt lgkmcnt(1)
    s_add_u32 s30, s39, 0
    buffer_store_dwordx4 v[128:131], v48, s[16:19], s30 offen sc1
    s_add_u32 s30, s39, 4096
    buffer_store_dwordx4 v[136:139], v49, s[16:19], s30 offen sc1
    s_add_u32 s30, s39, 8192
    buffer_store_dwordx4 v[144:147], v50, s[16:19], s30 offen sc1
    s_add_u32 s30, s39, 12288
    buffer_store_dwordx4 v[152:155], v51, s[16:19], s30 offen sc1
    v_pk_fma_f32 v[212:213], v[148:149], v[122:123], v[212:213] op_sel:[0,1,0] op_sel_hi:[1,1,1]
    v_pk_fma_f32 v[214:215], v[150:151], v[122:123], v[214:215] op_sel:[0,1,0] op_sel_hi:[1,1,1]
    v_pk_fma_f32 v[220:221], v[156:157], v[122:123], v[220:221] op_sel:[0,1,0] op_sel_hi:[1,1,1]
    v_pk_fma_f32 v[222:223], v[158:159], v[122:123], v[222:223] op_sel:[0,1,0] op_sel_hi:[1,1,1]
    v_lshlrev_b32 v64, 16, v28
    v_and_b32 v65, 0xffff0000, v28
    v_lshlrev_b32 v66, 16, v29
    v_and_b32 v67, 0xffff0000, v29
    v_lshlrev_b32 v68, 16, v30
    v_and_b32 v69, 0xffff0000, v30
    v_lshlrev_b32 v70, 16, v31
    v_and_b32 v71, 0xffff0000, v31
    v_pk_fma_f32 v[212:213], v[64:65], v[58:59], v[212:213] op_sel:[0,1,0] op_sel_hi:[1,1,1]
    v_pk_fma_f32 v[214:215], v[66:67], v[58:59], v[214:215] op_sel:[0,1,0] op_sel_hi:[1,1,1]
    v_pk_fma_f32 v[220:221], v[68:69], v[58:59], v[220:221] op_sel:[0,1,0] op_sel_hi:[1,1,1]
    v_pk_fma_f32 v[222:223], v[70:71], v[58:59], v[222:223] op_sel:[0,1,0] op_sel_hi:[1,1,1]
    v_accvgpr_read_b32 v84, a172
    v_accvgpr_read_b32 v85, a173
    v_accvgpr_read_b32 v86, a174
    v_accvgpr_read_b32 v87, a175
    v_lshlrev_b32 v76, 16, v84
    v_and_b32 v77, 0xffff0000, v84
    v_lshlrev_b32 v78, 16, v85
    v_and_b32 v79, 0xffff0000, v85
    v_lshlrev_b32 v80, 16, v86
    v_and_b32 v81, 0xffff0000, v86
    v_lshlrev_b32 v82, 16, v87
    v_and_b32 v83, 0xffff0000, v87
    v_pk_fma_f32 v[212:213], v[76:77], v[62:63], v[212:213] op_sel:[0,1,0] op_sel_hi:[1,1,1]
    v_pk_fma_f32 v[214:215], v[78:79], v[62:63], v[214:215] op_sel:[0,1,0] op_sel_hi:[1,1,1]
    v_pk_fma_f32 v[220:221], v[80:81], v[62:63], v[220:221] op_sel:[0,1,0] op_sel_hi:[1,1,1]
    v_pk_fma_f32 v[222:223], v[82:83], v[62:63], v[222:223] op_sel:[0,1,0] op_sel_hi:[1,1,1]
    v_accvgpr_read_b32 v96, a204
    v_accvgpr_read_b32 v97, a205
    v_accvgpr_read_b32 v98, a206
    v_accvgpr_read_b32 v99, a207
    v_lshlrev_b32 v88, 16, v96
    v_and_b32 v89, 0xffff0000, v96
    v_lshlrev_b32 v90, 16, v97
    v_and_b32 v91, 0xffff0000, v97
    v_lshlrev_b32 v92, 16, v98
    v_and_b32 v93, 0xffff0000, v98
    v_lshlrev_b32 v94, 16, v99
    v_and_b32 v95, 0xffff0000, v99
    v_pk_fma_f32 v[212:213], v[88:89], v[126:127], v[212:213] op_sel:[0,1,0] op_sel_hi:[1,1,1]
    v_pk_fma_f32 v[214:215], v[90:91], v[126:127], v[214:215] op_sel:[0,1,0] op_sel_hi:[1,1,1]
    v_pk_fma_f32 v[220:221], v[92:93], v[126:127], v[220:221] op_sel:[0,1,0] op_sel_hi:[1,1,1]
    v_pk_fma_f32 v[222:223], v[94:95], v[126:127], v[222:223] op_sel:[0,1,0] op_sel_hi:[1,1,1]
    v_cvt_pk_bf16_f32 v104, v212, v213
    v_cvt_pk_bf16_f32 v105, v214, v215
    v_cvt_pk_bf16_f32 v106, v220, v221
    v_cvt_pk_bf16_f32 v107, v222, v223
    ds_write_b128 v53, v[104:107] offset:4096
    v_pk_fma_f32 v[228:229], v[164:165], v[122:123], v[228:229] op_sel:[0,1,0] op_sel_hi:[1,1,1]
    v_pk_fma_f32 v[230:231], v[166:167], v[122:123], v[230:231] op_sel:[0,1,0] op_sel_hi:[1,1,1]
    v_pk_fma_f32 v[236:237], v[172:173], v[122:123], v[236:237] op_sel:[0,1,0] op_sel_hi:[1,1,1]
    v_pk_fma_f32 v[238:239], v[174:175], v[122:123], v[238:239] op_sel:[0,1,0] op_sel_hi:[1,1,1]
    v_lshlrev_b32 v64, 16, v36
    v_and_b32 v65, 0xffff0000, v36
    v_lshlrev_b32 v66, 16, v37
    v_and_b32 v67, 0xffff0000, v37
    v_lshlrev_b32 v68, 16, v38
    v_and_b32 v69, 0xffff0000, v38
    v_lshlrev_b32 v70, 16, v39
    v_and_b32 v71, 0xffff0000, v39
    v_pk_fma_f32 v[228:229], v[64:65], v[58:59], v[228:229] op_sel:[0,1,0] op_sel_hi:[1,1,1]
    v_pk_fma_f32 v[230:231], v[66:67], v[58:59], v[230:231] op_sel:[0,1,0] op_sel_hi:[1,1,1]
    v_pk_fma_f32 v[236:237], v[68:69], v[58:59], v[236:237] op_sel:[0,1,0] op_sel_hi:[1,1,1]
    v_pk_fma_f32 v[238:239], v[70:71], v[58:59], v[238:239] op_sel:[0,1,0] op_sel_hi:[1,1,1]
    v_accvgpr_read_b32 v84, a180
    v_accvgpr_read_b32 v85, a181
    v_accvgpr_read_b32 v86, a182
    v_accvgpr_read_b32 v87, a183
    v_lshlrev_b32 v76, 16, v84
    v_and_b32 v77, 0xffff0000, v84
    v_lshlrev_b32 v78, 16, v85
    v_and_b32 v79, 0xffff0000, v85
    v_lshlrev_b32 v80, 16, v86
    v_and_b32 v81, 0xffff0000, v86
    v_lshlrev_b32 v82, 16, v87
    v_and_b32 v83, 0xffff0000, v87
    v_pk_fma_f32 v[228:229], v[76:77], v[62:63], v[228:229] op_sel:[0,1,0] op_sel_hi:[1,1,1]
    v_pk_fma_f32 v[230:231], v[78:79], v[62:63], v[230:231] op_sel:[0,1,0] op_sel_hi:[1,1,1]
    v_pk_fma_f32 v[236:237], v[80:81], v[62:63], v[236:237] op_sel:[0,1,0] op_sel_hi:[1,1,1]
    v_pk_fma_f32 v[238:239], v[82:83], v[62:63], v[238:239] op_sel:[0,1,0] op_sel_hi:[1,1,1]
    v_accvgpr_read_b32 v96, a212
    v_accvgpr_read_b32 v97, a213
    v_accvgpr_read_b32 v98, a214
    v_accvgpr_read_b32 v99, a215
    v_lshlrev_b32 v88, 16, v96
    v_and_b32 v89, 0xffff0000, v96
    v_lshlrev_b32 v90, 16, v97
    v_and_b32 v91, 0xffff0000, v97
    v_lshlrev_b32 v92, 16, v98
    v_and_b32 v93, 0xffff0000, v98
    v_lshlrev_b32 v94, 16, v99
    v_and_b32 v95, 0xffff0000, v99
    v_pk_fma_f32 v[228:229], v[88:89], v[126:127], v[228:229] op_sel:[0,1,0] op_sel_hi:[1,1,1]
    v_pk_fma_f32 v[230:231], v[90:91], v[126:127], v[230:231] op_sel:[0,1,0] op_sel_hi:[1,1,1]
    v_pk_fma_f32 v[236:237], v[92:93], v[126:127], v[236:237] op_sel:[0,1,0] op_sel_hi:[1,1,1]
    v_pk_fma_f32 v[238:239], v[94:95], v[126:127], v[238:239] op_sel:[0,1,0] op_sel_hi:[1,1,1]
    v_cvt_pk_bf16_f32 v100, v228, v229
    v_cvt_pk_bf16_f32 v101, v230, v231
    v_cvt_pk_bf16_f32 v102, v236, v237
    v_cvt_pk_bf16_f32 v103, v238, v239
    ds_write_b128 v54, v[100:103] offset:4096
    v_pk_fma_f32 v[244:245], v[180:181], v[122:123], v[244:245] op_sel:[0,1,0] op_sel_hi:[1,1,1]
    v_pk_fma_f32 v[246:247], v[182:183], v[122:123], v[246:247] op_sel:[0,1,0] op_sel_hi:[1,1,1]
    v_pk_fma_f32 v[252:253], v[188:189], v[122:123], v[252:253] op_sel:[0,1,0] op_sel_hi:[1,1,1]
    v_pk_fma_f32 v[254:255], v[190:191], v[122:123], v[254:255] op_sel:[0,1,0] op_sel_hi:[1,1,1]
    v_lshlrev_b32 v64, 16, v44
    v_and_b32 v65, 0xffff0000, v44
    v_lshlrev_b32 v66, 16, v45
    v_and_b32 v67, 0xffff0000, v45
    v_lshlrev_b32 v68, 16, v46
    v_and_b32 v69, 0xffff0000, v46
    v_lshlrev_b32 v70, 16, v47
    v_and_b32 v71, 0xffff0000, v47
    v_pk_fma_f32 v[244:245], v[64:65], v[58:59], v[244:245] op_sel:[0,1,0] op_sel_hi:[1,1,1]
    v_pk_fma_f32 v[246:247], v[66:67], v[58:59], v[246:247] op_sel:[0,1,0] op_sel_hi:[1,1,1]
    v_pk_fma_f32 v[252:253], v[68:69], v[58:59], v[252:253] op_sel:[0,1,0] op_sel_hi:[1,1,1]
    v_pk_fma_f32 v[254:255], v[70:71], v[58:59], v[254:255] op_sel:[0,1,0] op_sel_hi:[1,1,1]
    v_accvgpr_read_b32 v84, a188
    v_accvgpr_read_b32 v85, a189
    v_accvgpr_read_b32 v86, a190
    v_accvgpr_read_b32 v87, a191
    v_lshlrev_b32 v76, 16, v84
    v_and_b32 v77, 0xffff0000, v84
    v_lshlrev_b32 v78, 16, v85
    v_and_b32 v79, 0xffff0000, v85
    v_lshlrev_b32 v80, 16, v86
    v_and_b32 v81, 0xffff0000, v86
    v_lshlrev_b32 v82, 16, v87
    v_and_b32 v83, 0xffff0000, v87
    v_pk_fma_f32 v[244:245], v[76:77], v[62:63], v[244:245] op_sel:[0,1,0] op_sel_hi:[1,1,1]
    v_pk_fma_f32 v[246:247], v[78:79], v[62:63], v[246:247] op_sel:[0,1,0] op_sel_hi:[1,1,1]
    v_pk_fma_f32 v[252:253], v[80:81], v[62:63], v[252:253] op_sel:[0,1,0] op_sel_hi:[1,1,1]
    v_pk_fma_f32 v[254:255], v[82:83], v[62:63], v[254:255] op_sel:[0,1,0] op_sel_hi:[1,1,1]
    v_accvgpr_read_b32 v96, a220
    v_accvgpr_read_b32 v97, a221
    v_accvgpr_read_b32 v98, a222
    v_accvgpr_read_b32 v99, a223
    v_lshlrev_b32 v88, 16, v96
    v_and_b32 v89, 0xffff0000, v96
    v_lshlrev_b32 v90, 16, v97
    v_and_b32 v91, 0xffff0000, v97
    v_lshlrev_b32 v92, 16, v98
    v_and_b32 v93, 0xffff0000, v98
    v_lshlrev_b32 v94, 16, v99
    v_and_b32 v95, 0xffff0000, v99
    v_pk_fma_f32 v[244:245], v[88:89], v[126:127], v[244:245] op_sel:[0,1,0] op_sel_hi:[1,1,1]
    v_pk_fma_f32 v[246:247], v[90:91], v[126:127], v[246:247] op_sel:[0,1,0] op_sel_hi:[1,1,1]
    v_pk_fma_f32 v[252:253], v[92:93], v[126:127], v[252:253] op_sel:[0,1,0] op_sel_hi:[1,1,1]
    v_pk_fma_f32 v[254:255], v[94:95], v[126:127], v[254:255] op_sel:[0,1,0] op_sel_hi:[1,1,1]
    v_cvt_pk_bf16_f32 v104, v244, v245
    v_cvt_pk_bf16_f32 v105, v246, v247
    v_cvt_pk_bf16_f32 v106, v252, v253
    v_cvt_pk_bf16_f32 v107, v254, v255
    ds_write_b128 v55, v[104:107] offset:4096
    ds_read_b128 v[132:135], v118 offset:4096
    ds_read_b128 v[140:143], v118 offset:5120
    ds_read_b128 v[148:151], v118 offset:6144
    ds_read_b128 v[156:159], v118 offset:7168
    s_add_u32 s30, s39, 16384
    s_waitcnt lgkmcnt(3)
    buffer_store_dwordx4 v[132:135], v48, s[16:19], s30 offen sc1
    s_add_u32 s30, s39, 20480
    s_waitcnt lgkmcnt(2)
    buffer_store_dwordx4 v[140:143], v49, s[16:19], s30 offen sc1
    s_add_u32 s30, s39, 24576
    s_waitcnt lgkmcnt(1)
    buffer_store_dwordx4 v[148:151], v50, s[16:19], s30 offen sc1
    s_add_u32 s30, s39, 28672
    s_waitcnt lgkmcnt(0)
    buffer_store_dwordx4 v[156:159], v51, s[16:19], s30 offen sc1
L_end:
    s_endpgm
L_tag_1s:
    s_sleep 4
    buffer_load_dword v24, v25, s[96:99], 0 offen sc1
    s_waitcnt vmcnt(0)
    s_branch L_tag_1w
L_tag_2s:
    s_sleep 4
    buffer_load_dword v24, v25, s[96:99], 0 offen sc1
    s_waitcnt vmcnt(0)
    s_branch L_tag_2w
L_tag_3s:
    s_sleep 4
    buffer_load_dword v24, v25, s[96:99], 0 offen sc1
    s_waitcnt vmcnt(0)
    s_branch L_tag_3w
L_p3slow:
    s_sleep 2
    buffer_load_dword v27, v11, s[8:11], s70 offen sc1
    s_waitcnt vmcnt(0)
    v_cmp_ne_u32 vcc, s75, v27
    s_cbranch_vccnz L_p3slow
    s_branch L_p3ok
L_fas:
    s_sleep 2
    buffer_load_dword v27, v11, s[8:11], s68 offen sc1
    s_waitcnt vmcnt(0)
    v_cmp_ne_u32 vcc, s75, v27
    s_cbranch_vccnz L_fas
    s_branch L_fak
L_frs:
    s_sleep 2
    buffer_load_dword v27, v11, s[8:11], s46 offen sc1
    s_waitcnt vmcnt(0)
    v_cmp_ne_u32 vcc, s75, v27
    s_cbranch_vccnz L_frs
    s_branch L_frk
L_f1s:
    s_sleep 2
    buffer_load_dword v26, v11, s[8:11], s38 offen sc1
    s_waitcnt vmcnt(0)
    v_cmp_ne_u32 vcc, s75, v26
    s_cbranch_vccnz L_f1s
    s_branch L_f1k
L_fqs:
    s_sleep 2
    buffer_load_dword v27, v11, s[8:11], s48 offen sc1
    s_waitcnt vmcnt(0)
    v_cmp_ne_u32 vcc, s75, v27
    s_cbranch_vccnz L_fqs
    s_branch L_fqk
L_fvs:
    s_sleep 2
    buffer_load_dword v117, v118, s[8:11], s38 offen sc1
    s_waitcnt vmcnt(0)
    v_cmp_ne_u32 vcc, s75, v117
    s_cbranch_vccnz L_fvs
    s_branch L_fvk
L_cfslow:
    s_sleep 2
    buffer_load_dword v117, v118, s[8:11], s48 offen sc1
    s_waitcnt vmcnt(0)
    v_cmp_ne_u32 s[38:39], s75, v117
    s_nop 3
    s_cmp_eq_u64 s[38:39], 0
    s_cbranch_scc0 L_cfslow
    s_branch L_cfok
L_r1F:
    v_max3_f32 v14, v16, v17, v18
    v_max3_f32 v14, v14, v19, v24
    v_max3_f32 v14, v14, v25, v26
    v_max_f32 v14, v14, v27
    v_max3_f32 v15, v20, v21, v22
    v_max3_f32 v15, v15, v23, v28
    v_max3_f32 v15, v15, v29, v30
    v_max_f32 v15, v15, v31
    v_mov_b32 v120, v14
    v_mov_b32 v121, v15
    s_nop 1
    v_permlane16_swap_b32 v120, v14
    v_permlane16_swap_b32 v121, v15
    s_nop 1
    v_max_f32 v14, v14, v120
    v_max_f32 v15, v15, v121
    v_mov_b32 v120, v14
    v_mov_b32 v121, v15
    s_nop 1
    v_permlane32_swap_b32 v120, v14
    v_permlane32_swap_b32 v121, v15
    s_nop 1
    v_max_f32 v14, v14, v120
    v_max_f32 v15, v15, v121
    v_max_f32 v14, 0, v14
    v_sub_f32 v11, 0, v14
    v_exp_f32 v11, v11
    v_sub_f32 v16, v16, v14
    v_sub_f32 v17, v17, v14
    v_sub_f32 v18, v18, v14
    v_sub_f32 v19, v19, v14
    v_sub_f32 v24, v24, v14
    v_sub_f32 v25, v25, v14
    v_sub_f32 v26, v26, v14
    v_sub_f32 v27, v27, v14
    v_sub_f32 v56, v56, v14
    v_sub_f32 v57, v57, v14
    v_sub_f32 v58, v58, v14
    v_sub_f32 v59, v59, v14
    v_mul_f32 v8, v8, v11
    v_max_f32 v15, 0, v15
    v_sub_f32 v12, 0, v15
    v_exp_f32 v12, v12
    v_sub_f32 v20, v20, v15
    v_sub_f32 v21, v21, v15
    v_sub_f32 v22, v22, v15
    v_sub_f32 v23, v23, v15
    v_sub_f32 v28, v28, v15
    v_sub_f32 v29, v29, v15
    v_sub_f32 v30, v30, v15
    v_sub_f32 v31, v31, v15
    v_sub_f32 v60, v60, v15
    v_sub_f32 v61, v61, v15
    v_sub_f32 v62, v62, v15
    v_sub_f32 v63, v63, v15
    v_mul_f32 v9, v9, v12
    s_branch L_r1bF
L_r2F:
    s_nop 7
    v_mul_f32 v128, v128, v11
    v_mul_f32 v129, v129, v11
    v_mul_f32 v130, v130, v11
    v_mul_f32 v131, v131, v11
    v_mul_f32 v132, v132, v12
    v_mul_f32 v133, v133, v12
    v_mul_f32 v134, v134, v12
    v_mul_f32 v135, v135, v12
    v_mul_f32 v136, v136, v11
    v_mul_f32 v137, v137, v11
    v_mul_f32 v138, v138, v11
    v_mul_f32 v139, v139, v11
    v_mul_f32 v140, v140, v12
    v_mul_f32 v141, v141, v12
    v_mul_f32 v142, v142, v12
    v_mul_f32 v143, v143, v12
    v_mul_f32 v144, v144, v11
    v_mul_f32 v145, v145, v11
    v_mul_f32 v146, v146, v11
    v_mul_f32 v147, v147, v11
    v_mul_f32 v148, v148, v12
    v_mul_f32 v149, v149, v12
    v_mul_f32 v150, v150, v12
    v_mul_f32 v151, v151, v12
    v_mul_f32 v152, v152, v11
    v_mul_f32 v153, v153, v11
    v_mul_f32 v154, v154, v11
    v_mul_f32 v155, v155, v11
    v_mul_f32 v156, v156, v12
    v_mul_f32 v157, v157, v12
    v_mul_f32 v158, v158, v12
    v_mul_f32 v159, v159, v12
    v_mul_f32 v160, v160, v11
    v_mul_f32 v161, v161, v11
    v_mul_f32 v162, v162, v11
    v_mul_f32 v163, v163, v11
    v_mul_f32 v164, v164, v12
    v_mul_f32 v165, v165, v12
    v_mul_f32 v166, v166, v12
    v_mul_f32 v167, v167, v12
    v_mul_f32 v168, v168, v11
    v_mul_f32 v169, v169, v11
    v_mul_f32 v170, v170, v11
    v_mul_f32 v171, v171, v11
    v_mul_f32 v172, v172, v12
    v_mul_f32 v173, v173, v12
    v_mul_f32 v174, v174, v12
    v_mul_f32 v175, v175, v12
    v_mul_f32 v176, v176, v11
    v_mul_f32 v177, v177, v11
    v_mul_f32 v178, v178, v11
    v_mul_f32 v179, v179, v11
    v_mul_f32 v180, v180, v12
    v_mul_f32 v181, v181, v12
    v_mul_f32 v182, v182, v12
    v_mul_f32 v183, v183, v12
    v_mul_f32 v184, v184, v11
    v_mul_f32 v185, v185, v11
    v_mul_f32 v186, v186, v11
    v_mul_f32 v187, v187, v11
    v_mul_f32 v188, v188, v12
    v_mul_f32 v189, v189, v12
    v_mul_f32 v190, v190, v12
    v_mul_f32 v191, v191, v12
    v_mul_f32 v192, v192, v11
    v_mul_f32 v193, v193, v11
    v_mul_f32 v194, v194, v11
    v_mul_f32 v195, v195, v11
    v_mul_f32 v196, v196, v12
    v_mul_f32 v197, v197, v12
    v_mul_f32 v198, v198, v12
    v_mul_f32 v199, v199, v12
    v_mul_f32 v200, v200, v11
    v_mul_f32 v201, v201, v11
    v_mul_f32 v202, v202, v11
    v_mul_f32 v203, v203, v11
    v_mul_f32 v204, v204, v12
    v_mul_f32 v205, v205, v12
    v_mul_f32 v206, v206, v12
    v_mul_f32 v207, v207, v12
    v_mul_f32 v208, v208, v11
    v_mul_f32 v209, v209, v11
    v_mul_f32 v210, v210, v11
    v_mul_f32 v211, v211, v11
    v_mul_f32 v212, v212, v12
    v_mul_f32 v213, v213, v12
    v_mul_f32 v214, v214, v12
    v_mul_f32 v215, v215, v12
    v_mul_f32 v216, v216, v11
    v_mul_f32 v217, v217, v11
    v_mul_f32 v218, v218, v11
    v_mul_f32 v219, v219, v11
    v_mul_f32 v220, v220, v12
    v_mul_f32 v221, v221, v12
    v_mul_f32 v222, v222, v12
    v_mul_f32 v223, v223, v12
    v_mul_f32 v224, v224, v11
    v_mul_f32 v225, v225, v11
    v_mul_f32 v226, v226, v11
    v_mul_f32 v227, v227, v11
    v_mul_f32 v228, v228, v12
    v_mul_f32 v229, v229, v12
    v_mul_f32 v230, v230, v12
    v_mul_f32 v231, v231, v12
    v_mul_f32 v232, v232, v11
    v_mul_f32 v233, v233, v11
    v_mul_f32 v234, v234, v11
    v_mul_f32 v235, v235, v11
    v_mul_f32 v236, v236, v12
    v_mul_f32 v237, v237, v12
    v_mul_f32 v238, v238, v12
    v_mul_f32 v239, v239, v12
    v_mul_f32 v240, v240, v11
    v_mul_f32 v241, v241, v11
    v_mul_f32 v242, v242, v11
    v_mul_f32 v243, v243, v11
    v_mul_f32 v244, v244, v12
    v_mul_f32 v245, v245, v12
    v_mul_f32 v246, v246, v12
    v_mul_f32 v247, v247, v12
    v_mul_f32 v248, v248, v11
    v_mul_f32 v249, v249, v11
    v_mul_f32 v250, v250, v11
    v_mul_f32 v251, v251, v11
    v_mul_f32 v252, v252, v12
    v_mul_f32 v253, v253, v12
    v_mul_f32 v254, v254, v12
    v_mul_f32 v255, v255, v12
    v_accvgpr_read_b32 v120, a128
    v_accvgpr_read_b32 v121, a129
    v_accvgpr_read_b32 v122, a130
    v_accvgpr_read_b32 v123, a131
    v_mul_f32 v120, v120, v11
    v_mul_f32 v121, v121, v11
    v_mul_f32 v122, v122, v11
    v_mul_f32 v123, v123, v11
    v_accvgpr_write_b32 a128, v120
    v_accvgpr_write_b32 a129, v121
    v_accvgpr_write_b32 a130, v122
    v_accvgpr_write_b32 a131, v123
    v_accvgpr_read_b32 v120, a132
    v_accvgpr_read_b32 v121, a133
    v_accvgpr_read_b32 v122, a134
    v_accvgpr_read_b32 v123, a135
    v_mul_f32 v120, v120, v12
    v_mul_f32 v121, v121, v12
    v_mul_f32 v122, v122, v12
    v_mul_f32 v123, v123, v12
    v_accvgpr_write_b32 a132, v120
    v_accvgpr_write_b32 a133, v121
    v_accvgpr_write_b32 a134, v122
    v_accvgpr_write_b32 a135, v123
    v_accvgpr_read_b32 v120, a136
    v_accvgpr_read_b32 v121, a137
    v_accvgpr_read_b32 v122, a138
    v_accvgpr_read_b32 v123, a139
    v_mul_f32 v120, v120, v11
    v_mul_f32 v121, v121, v11
    v_mul_f32 v122, v122, v11
    v_mul_f32 v123, v123, v11
    v_accvgpr_write_b32 a136, v120
    v_accvgpr_write_b32 a137, v121
    v_accvgpr_write_b32 a138, v122
    v_accvgpr_write_b32 a139, v123
    v_accvgpr_read_b32 v120, a140
    v_accvgpr_read_b32 v121, a141
    v_accvgpr_read_b32 v122, a142
    v_accvgpr_read_b32 v123, a143
    v_mul_f32 v120, v120, v12
    v_mul_f32 v121, v121, v12
    v_mul_f32 v122, v122, v12
    v_mul_f32 v123, v123, v12
    v_accvgpr_write_b32 a140, v120
    v_accvgpr_write_b32 a141, v121
    v_accvgpr_write_b32 a142, v122
    v_accvgpr_write_b32 a143, v123
    v_accvgpr_read_b32 v120, a144
    v_accvgpr_read_b32 v121, a145
    v_accvgpr_read_b32 v122, a146
    v_accvgpr_read_b32 v123, a147
    v_mul_f32 v120, v120, v11
    v_mul_f32 v121, v121, v11
    v_mul_f32 v122, v122, v11
    v_mul_f32 v123, v123, v11
    v_accvgpr_write_b32 a144, v120
    v_accvgpr_write_b32 a145, v121
    v_accvgpr_write_b32 a146, v122
    v_accvgpr_write_b32 a147, v123
    v_accvgpr_read_b32 v120, a148
    v_accvgpr_read_b32 v121, a149
    v_accvgpr_read_b32 v122, a150
    v_accvgpr_read_b32 v123, a151
    v_mul_f32 v120, v120, v12
    v_mul_f32 v121, v121, v12
    v_mul_f32 v122, v122, v12
    v_mul_f32 v123, v123, v12
    v_accvgpr_write_b32 a148, v120
    v_accvgpr_write_b32 a149, v121
    v_accvgpr_write_b32 a150, v122
    v_accvgpr_write_b32 a151, v123
    v_accvgpr_read_b32 v120, a152
    v_accvgpr_read_b32 v121, a153
    v_accvgpr_read_b32 v122, a154
    v_accvgpr_read_b32 v123, a155
    v_mul_f32 v120, v120, v11
    v_mul_f32 v121, v121, v11
    v_mul_f32 v122, v122, v11
    v_mul_f32 v123, v123, v11
    v_accvgpr_write_b32 a152, v120
    v_accvgpr_write_b32 a153, v121
    v_accvgpr_write_b32 a154, v122
    v_accvgpr_write_b32 a155, v123
    v_accvgpr_read_b32 v120, a156
    v_accvgpr_read_b32 v121, a157
    v_accvgpr_read_b32 v122, a158
    v_accvgpr_read_b32 v123, a159
    v_mul_f32 v120, v120, v12
    v_mul_f32 v121, v121, v12
    v_mul_f32 v122, v122, v12
    v_mul_f32 v123, v123, v12
    v_accvgpr_write_b32 a156, v120
    v_accvgpr_write_b32 a157, v121
    v_accvgpr_write_b32 a158, v122
    v_accvgpr_write_b32 a159, v123
    v_accvgpr_read_b32 v120, a160
    v_accvgpr_read_b32 v121, a161
    v_accvgpr_read_b32 v122, a162
    v_accvgpr_read_b32 v123, a163
    v_mul_f32 v120, v120, v11
    v_mul_f32 v121, v121, v11
    v_mul_f32 v122, v122, v11
    v_mul_f32 v123, v123, v11
    v_accvgpr_write_b32 a160, v120
    v_accvgpr_write_b32 a161, v121
    v_accvgpr_write_b32 a162, v122
    v_accvgpr_write_b32 a163, v123
    v_accvgpr_read_b32 v120, a164
    v_accvgpr_read_b32 v121, a165
    v_accvgpr_read_b32 v122, a166
    v_accvgpr_read_b32 v123, a167
    v_mul_f32 v120, v120, v12
    v_mul_f32 v121, v121, v12
    v_mul_f32 v122, v122, v12
    v_mul_f32 v123, v123, v12
    v_accvgpr_write_b32 a164, v120
    v_accvgpr_write_b32 a165, v121
    v_accvgpr_write_b32 a166, v122
    v_accvgpr_write_b32 a167, v123
    v_accvgpr_read_b32 v120, a168
    v_accvgpr_read_b32 v121, a169
    v_accvgpr_read_b32 v122, a170
    v_accvgpr_read_b32 v123, a171
    v_mul_f32 v120, v120, v11
    v_mul_f32 v121, v121, v11
    v_mul_f32 v122, v122, v11
    v_mul_f32 v123, v123, v11
    v_accvgpr_write_b32 a168, v120
    v_accvgpr_write_b32 a169, v121
    v_accvgpr_write_b32 a170, v122
    v_accvgpr_write_b32 a171, v123
    v_accvgpr_read_b32 v120, a172
    v_accvgpr_read_b32 v121, a173
    v_accvgpr_read_b32 v122, a174
    v_accvgpr_read_b32 v123, a175
    v_mul_f32 v120, v120, v12
    v_mul_f32 v121, v121, v12
    v_mul_f32 v122, v122, v12
    v_mul_f32 v123, v123, v12
    v_accvgpr_write_b32 a172, v120
    v_accvgpr_write_b32 a173, v121
    v_accvgpr_write_b32 a174, v122
    v_accvgpr_write_b32 a175, v123
    v_accvgpr_read_b32 v120, a176
    v_accvgpr_read_b32 v121, a177
    v_accvgpr_read_b32 v122, a178
    v_accvgpr_read_b32 v123, a179
    v_mul_f32 v120, v120, v11
    v_mul_f32 v121, v121, v11
    v_mul_f32 v122, v122, v11
    v_mul_f32 v123, v123, v11
    v_accvgpr_write_b32 a176, v120
    v_accvgpr_write_b32 a177, v121
    v_accvgpr_write_b32 a178, v122
    v_accvgpr_write_b32 a179, v123
    v_accvgpr_read_b32 v120, a180
    v_accvgpr_read_b32 v121, a181
    v_accvgpr_read_b32 v122, a182
    v_accvgpr_read_b32 v123, a183
    v_mul_f32 v120, v120, v12
    v_mul_f32 v121, v121, v12
    v_mul_f32 v122, v122, v12
    v_mul_f32 v123, v123, v12
    v_accvgpr_write_b32 a180, v120
    v_accvgpr_write_b32 a181, v121
    v_accvgpr_write_b32 a182, v122
    v_accvgpr_write_b32 a183, v123
    v_accvgpr_read_b32 v120, a184
    v_accvgpr_read_b32 v121, a185
    v_accvgpr_read_b32 v122, a186
    v_accvgpr_read_b32 v123, a187
    v_mul_f32 v120, v120, v11
    v_mul_f32 v121, v121, v11
    v_mul_f32 v122, v122, v11
    v_mul_f32 v123, v123, v11
    v_accvgpr_write_b32 a184, v120
    v_accvgpr_write_b32 a185, v121
    v_accvgpr_write_b32 a186, v122
    v_accvgpr_write_b32 a187, v123
    v_accvgpr_read_b32 v120, a188
    v_accvgpr_read_b32 v121, a189
    v_accvgpr_read_b32 v122, a190
    v_accvgpr_read_b32 v123, a191
    v_mul_f32 v120, v120, v12
    v_mul_f32 v121, v121, v12
    v_mul_f32 v122, v122, v12
    v_mul_f32 v123, v123, v12
    v_accvgpr_write_b32 a188, v120
    v_accvgpr_write_b32 a189, v121
    v_accvgpr_write_b32 a190, v122
    v_accvgpr_write_b32 a191, v123
    v_accvgpr_read_b32 v120, a192
    v_accvgpr_read_b32 v121, a193
    v_accvgpr_read_b32 v122, a194
    v_accvgpr_read_b32 v123, a195
    v_mul_f32 v120, v120, v11
    v_mul_f32 v121, v121, v11
    v_mul_f32 v122, v122, v11
    v_mul_f32 v123, v123, v11
    v_accvgpr_write_b32 a192, v120
    v_accvgpr_write_b32 a193, v121
    v_accvgpr_write_b32 a194, v122
    v_accvgpr_write_b32 a195, v123
    v_accvgpr_read_b32 v120, a196
    v_accvgpr_read_b32 v121, a197
    v_accvgpr_read_b32 v122, a198
    v_accvgpr_read_b32 v123, a199
    v_mul_f32 v120, v120, v12
    v_mul_f32 v121, v121, v12
    v_mul_f32 v122, v122, v12
    v_mul_f32 v123, v123, v12
    v_accvgpr_write_b32 a196, v120
    v_accvgpr_write_b32 a197, v121
    v_accvgpr_write_b32 a198, v122
    v_accvgpr_write_b32 a199, v123
    v_accvgpr_read_b32 v120, a200
    v_accvgpr_read_b32 v121, a201
    v_accvgpr_read_b32 v122, a202
    v_accvgpr_read_b32 v123, a203
    v_mul_f32 v120, v120, v11
    v_mul_f32 v121, v121, v11
    v_mul_f32 v122, v122, v11
    v_mul_f32 v123, v123, v11
    v_accvgpr_write_b32 a200, v120
    v_accvgpr_write_b32 a201, v121
    v_accvgpr_write_b32 a202, v122
    v_accvgpr_write_b32 a203, v123
    v_accvgpr_read_b32 v120, a204
    v_accvgpr_read_b32 v121, a205
    v_accvgpr_read_b32 v122, a206
    v_accvgpr_read_b32 v123, a207
    v_mul_f32 v120, v120, v12
    v_mul_f32 v121, v121, v12
    v_mul_f32 v122, v122, v12
    v_mul_f32 v123, v123, v12
    v_accvgpr_write_b32 a204, v120
    v_accvgpr_write_b32 a205, v121
    v_accvgpr_write_b32 a206, v122
    v_accvgpr_write_b32 a207, v123
    v_accvgpr_read_b32 v120, a208
    v_accvgpr_read_b32 v121, a209
    v_accvgpr_read_b32 v122, a210
    v_accvgpr_read_b32 v123, a211
    v_mul_f32 v120, v120, v11
    v_mul_f32 v121, v121, v11
    v_mul_f32 v122, v122, v11
    v_mul_f32 v123, v123, v11
    v_accvgpr_write_b32 a208, v120
    v_accvgpr_write_b32 a209, v121
    v_accvgpr_write_b32 a210, v122
    v_accvgpr_write_b32 a211, v123
    v_accvgpr_read_b32 v120, a212
    v_accvgpr_read_b32 v121, a213
    v_accvgpr_read_b32 v122, a214
    v_accvgpr_read_b32 v123, a215
    v_mul_f32 v120, v120, v12
    v_mul_f32 v121, v121, v12
    v_mul_f32 v122, v122, v12
    v_mul_f32 v123, v123, v12
    v_accvgpr_write_b32 a212, v120
    v_accvgpr_write_b32 a213, v121
    v_accvgpr_write_b32 a214, v122
    v_accvgpr_write_b32 a215, v123
    v_accvgpr_read_b32 v120, a216
    v_accvgpr_read_b32 v121, a217
    v_accvgpr_read_b32 v122, a218
    v_accvgpr_read_b32 v123, a219
    v_mul_f32 v120, v120, v11
    v_mul_f32 v121, v121, v11
    v_mul_f32 v122, v122, v11
    v_mul_f32 v123, v123, v11
    v_accvgpr_write_b32 a216, v120
    v_accvgpr_write_b32 a217, v121
    v_accvgpr_write_b32 a218, v122
    v_accvgpr_write_b32 a219, v123
    v_accvgpr_read_b32 v120, a220
    v_accvgpr_read_b32 v121, a221
    v_accvgpr_read_b32 v122, a222
    v_accvgpr_read_b32 v123, a223
    v_mul_f32 v120, v120, v12
    v_mul_f32 v121, v121, v12
    v_mul_f32 v122, v122, v12
    v_mul_f32 v123, v123, v12
    v_accvgpr_write_b32 a220, v120
    v_accvgpr_write_b32 a221, v121
    v_accvgpr_write_b32 a222, v122
    v_accvgpr_write_b32 a223, v123
    v_accvgpr_read_b32 v120, a224
    v_accvgpr_read_b32 v121, a225
    v_accvgpr_read_b32 v122, a226
    v_accvgpr_read_b32 v123, a227
    v_mul_f32 v120, v120, v11
    v_mul_f32 v121, v121, v11
    v_mul_f32 v122, v122, v11
    v_mul_f32 v123, v123, v11
    v_accvgpr_write_b32 a224, v120
    v_accvgpr_write_b32 a225, v121
    v_accvgpr_write_b32 a226, v122
    v_accvgpr_write_b32 a227, v123
    v_accvgpr_read_b32 v120, a228
    v_accvgpr_read_b32 v121, a229
    v_accvgpr_read_b32 v122, a230
    v_accvgpr_read_b32 v123, a231
    v_mul_f32 v120, v120, v12
    v_mul_f32 v121, v121, v12
    v_mul_f32 v122, v122, v12
    v_mul_f32 v123, v123, v12
    v_accvgpr_write_b32 a228, v120
    v_accvgpr_write_b32 a229, v121
    v_accvgpr_write_b32 a230, v122
    v_accvgpr_write_b32 a231, v123
    v_accvgpr_read_b32 v120, a232
    v_accvgpr_read_b32 v121, a233
    v_accvgpr_read_b32 v122, a234
    v_accvgpr_read_b32 v123, a235
    v_mul_f32 v120, v120, v11
    v_mul_f32 v121, v121, v11
    v_mul_f32 v122, v122, v11
    v_mul_f32 v123, v123, v11
    v_accvgpr_write_b32 a232, v120
    v_accvgpr_write_b32 a233, v121
    v_accvgpr_write_b32 a234, v122
    v_accvgpr_write_b32 a235, v123
    v_accvgpr_read_b32 v120, a236
    v_accvgpr_read_b32 v121, a237
    v_accvgpr_read_b32 v122, a238
    v_accvgpr_read_b32 v123, a239
    v_mul_f32 v120, v120, v12
    v_mul_f32 v121, v121, v12
    v_mul_f32 v122, v122, v12
    v_mul_f32 v123, v123, v12
    v_accvgpr_write_b32 a236, v120
    v_accvgpr_write_b32 a237, v121
    v_accvgpr_write_b32 a238, v122
    v_accvgpr_write_b32 a239, v123
    v_accvgpr_read_b32 v120, a240
    v_accvgpr_read_b32 v121, a241
    v_accvgpr_read_b32 v122, a242
    v_accvgpr_read_b32 v123, a243
    v_mul_f32 v120, v120, v11
    v_mul_f32 v121, v121, v11
    v_mul_f32 v122, v122, v11
    v_mul_f32 v123, v123, v11
    v_accvgpr_write_b32 a240, v120
    v_accvgpr_write_b32 a241, v121
    v_accvgpr_write_b32 a242, v122
    v_accvgpr_write_b32 a243, v123
    v_accvgpr_read_b32 v120, a244
    v_accvgpr_read_b32 v121, a245
    v_accvgpr_read_b32 v122, a246
    v_accvgpr_read_b32 v123, a247
    v_mul_f32 v120, v120, v12
    v_mul_f32 v121, v121, v12
    v_mul_f32 v122, v122, v12
    v_mul_f32 v123, v123, v12
    v_accvgpr_write_b32 a244, v120
    v_accvgpr_write_b32 a245, v121
    v_accvgpr_write_b32 a246, v122
    v_accvgpr_write_b32 a247, v123
    v_accvgpr_read_b32 v120, a248
    v_accvgpr_read_b32 v121, a249
    v_accvgpr_read_b32 v122, a250
    v_accvgpr_read_b32 v123, a251
    v_mul_f32 v120, v120, v11
    v_mul_f32 v121, v121, v11
    v_mul_f32 v122, v122, v11
    v_mul_f32 v123, v123, v11
    v_accvgpr_write_b32 a248, v120
    v_accvgpr_write_b32 a249, v121
    v_accvgpr_write_b32 a250, v122
    v_accvgpr_write_b32 a251, v123
    v_accvgpr_read_b32 v120, a252
    v_accvgpr_read_b32 v121, a253
    v_accvgpr_read_b32 v122, a254
    v_accvgpr_read_b32 v123, a255
    v_mul_f32 v120, v120, v12
    v_mul_f32 v121, v121, v12
    v_mul_f32 v122, v122, v12
    v_mul_f32 v123, v123, v12
    v_accvgpr_write_b32 a252, v120
    v_accvgpr_write_b32 a253, v121
    v_accvgpr_write_b32 a254, v122
    v_accvgpr_write_b32 a255, v123
    s_branch L_r2bF
L_r1M:
    v_max3_f32 v14, v16, v17, v18
    v_max3_f32 v14, v14, v19, v24
    v_max3_f32 v14, v14, v25, v26
    v_max_f32 v14, v14, v27
    v_max3_f32 v15, v20, v21, v22
    v_max3_f32 v15, v15, v23, v28
    v_max3_f32 v15, v15, v29, v30
    v_max_f32 v15, v15, v31
    v_mov_b32 v120, v14
    v_mov_b32 v121, v15
    s_nop 1
    v_permlane16_swap_b32 v120, v14
    v_permlane16_swap_b32 v121, v15
    s_nop 1
    v_max_f32 v14, v14, v120
    v_max_f32 v15, v15, v121
    v_mov_b32 v120, v14
    v_mov_b32 v121, v15
    s_nop 1
    v_permlane32_swap_b32 v120, v14
    v_permlane32_swap_b32 v121, v15
    s_nop 1
    v_max_f32 v14, v14, v120
    v_max_f32 v15, v15, v121
    v_max_f32 v14, 0, v14
    v_sub_f32 v11, 0, v14
    v_exp_f32 v11, v11
    v_sub_f32 v16, v16, v14
    v_sub_f32 v17, v17, v14
    v_sub_f32 v18, v18, v14
    v_sub_f32 v19, v19, v14
    v_sub_f32 v24, v24, v14
    v_sub_f32 v25, v25, v14
    v_sub_f32 v26, v26, v14
    v_sub_f32 v27, v27, v14
    v_sub_f32 v56, v56, v14
    v_sub_f32 v57, v57, v14
    v_sub_f32 v58, v58, v14
    v_sub_f32 v59, v59, v14
    v_mul_f32 v8, v8, v11
    v_max_f32 v15, 0, v15
    v_sub_f32 v12, 0, v15
    v_exp_f32 v12, v12
    v_sub_f32 v20, v20, v15
    v_sub_f32 v21, v21, v15
    v_sub_f32 v22, v22, v15
    v_sub_f32 v23, v23, v15
    v_sub_f32 v28, v28, v15
    v_sub_f32 v29, v29, v15
    v_sub_f32 v30, v30, v15
    v_sub_f32 v31, v31, v15
    v_sub_f32 v60, v60, v15
    v_sub_f32 v61, v61, v15
    v_sub_f32 v62, v62, v15
    v_sub_f32 v63, v63, v15
    v_mul_f32 v9, v9, v12
    s_mov_b32 s55, 1000
    s_branch L_r1bM
L_r2M:
    s_nop 7
    v_mul_f32 v128, v128, v11
    v_mul_f32 v129, v129, v11
    v_mul_f32 v130, v130, v11
    v_mul_f32 v131, v131, v11
    v_mul_f32 v132, v132, v12
    v_mul_f32 v133, v133, v12
    v_mul_f32 v134, v134, v12
    v_mul_f32 v135, v135, v12
    v_mul_f32 v136, v136, v11
    v_mul_f32 v137, v137, v11
    v_mul_f32 v138, v138, v11
    v_mul_f32 v139, v139, v11
    v_mul_f32 v140, v140, v12
    v_mul_f32 v141, v141, v12
    v_mul_f32 v142, v142, v12
    v_mul_f32 v143, v143, v12
    v_mul_f32 v144, v144, v11
    v_mul_f32 v145, v145, v11
    v_mul_f32 v146, v146, v11
    v_mul_f32 v147, v147, v11
    v_mul_f32 v148, v148, v12
    v_mul_f32 v149, v149, v12
    v_mul_f32 v150, v150, v12
    v_mul_f32 v151, v151, v12
    v_mul_f32 v152, v152, v11
    v_mul_f32 v153, v153, v11
    v_mul_f32 v154, v154, v11
    v_mul_f32 v155, v155, v11
    v_mul_f32 v156, v156, v12
    v_mul_f32 v157, v157, v12
    v_mul_f32 v158, v158, v12
    v_mul_f32 v159, v159, v12
    v_mul_f32 v160, v160, v11
    v_mul_f32 v161, v161, v11
    v_mul_f32 v162, v162, v11
    v_mul_f32 v163, v163, v11
    v_mul_f32 v164, v164, v12
    v_mul_f32 v165, v165, v12
    v_mul_f32 v166, v166, v12
    v_mul_f32 v167, v167, v12
    v_mul_f32 v168, v168, v11
    v_mul_f32 v169, v169, v11
    v_mul_f32 v170, v170, v11
    v_mul_f32 v171, v171, v11
    v_mul_f32 v172, v172, v12
    v_mul_f32 v173, v173, v12
    v_mul_f32 v174, v174, v12
    v_mul_f32 v175, v175, v12
    v_mul_f32 v176, v176, v11
    v_mul_f32 v177, v177, v11
    v_mul_f32 v178, v178, v11
    v_mul_f32 v179, v179, v11
    v_mul_f32 v180, v180, v12
    v_mul_f32 v181, v181, v12
    v_mul_f32 v182, v182, v12
    v_mul_f32 v183, v183, v12
    v_mul_f32 v184, v184, v11
    v_mul_f32 v185, v185, v11
    v_mul_f32 v186, v186, v11
    v_mul_f32 v187, v187, v11
    v_mul_f32 v188, v188, v12
    v_mul_f32 v189, v189, v12
    v_mul_f32 v190, v190, v12
    v_mul_f32 v191, v191, v12
    v_mul_f32 v192, v192, v11
    v_mul_f32 v193, v193, v11
    v_mul_f32 v194, v194, v11
    v_mul_f32 v195, v195, v11
    v_mul_f32 v196, v196, v12
    v_mul_f32 v197, v197, v12
    v_mul_f32 v198, v198, v12
    v_mul_f32 v199, v199, v12
    v_mul_f32 v200, v200, v11
    v_mul_f32 v201, v201, v11
    v_mul_f32 v202, v202, v11
    v_mul_f32 v203, v203, v11
    v_mul_f32 v204, v204, v12
    v_mul_f32 v205, v205, v12
    v_mul_f32 v206, v206, v12
    v_mul_f32 v207, v207, v12
    v_mul_f32 v208, v208, v11
    v_mul_f32 v209, v209, v11
    v_mul_f32 v210, v210, v11
    v_mul_f32 v211, v211, v11
    v_mul_f32 v212, v212, v12
    v_mul_f32 v213, v213, v12
    v_mul_f32 v214, v214, v12
    v_mul_f32 v215, v215, v12
    v_mul_f32 v216, v216, v11
    v_mul_f32 v217, v217, v11
    v_mul_f32 v218, v218, v11
    v_mul_f32 v219, v219, v11
    v_mul_f32 v220, v220, v12
    v_mul_f32 v221, v221, v12
    v_mul_f32 v222, v222, v12
    v_mul_f32 v223, v223, v12
    v_mul_f32 v224, v224, v11
    v_mul_f32 v225, v225, v11
    v_mul_f32 v226, v226, v11
    v_mul_f32 v227, v227, v11
    v_mul_f32 v228, v228, v12
    v_mul_f32 v229, v229, v12
    v_mul_f32 v230, v230, v12
    v_mul_f32 v231, v231, v12
    v_mul_f32 v232, v232, v11
    v_mul_f32 v233, v233, v11
    v_mul_f32 v234, v234, v11
    v_mul_f32 v235, v235, v11
    v_mul_f32 v236, v236, v12
    v_mul_f32 v237, v237, v12
    v_mul_f32 v238, v238, v12
    v_mul_f32 v239, v239, v12
    v_mul_f32 v240, v240, v11
    v_mul_f32 v241, v241, v11
    v_mul_f32 v242, v242, v11
    v_mul_f32 v243, v243, v11
    v_mul_f32 v244, v244, v12
    v_mul_f32 v245, v245, v12
    v_mul_f32 v246, v246, v12
    v_mul_f32 v247, v247, v12
    v_mul_f32 v248, v248, v11
    v_mul_f32 v249, v249, v11
    v_mul_f32 v250, v250, v11
    v_mul_f32 v251, v251, v11
    v_mul_f32 v252, v252, v12
    v_mul_f32 v253, v253, v12
    v_mul_f32 v254, v254, v12
    v_mul_f32 v255, v255, v12
    v_accvgpr_read_b32 v120, a128
    v_accvgpr_read_b32 v121, a129
    v_accvgpr_read_b32 v122, a130
    v_accvgpr_read_b32 v123, a131
    v_mul_f32 v120, v120, v11
    v_mul_f32 v121, v121, v11
    v_mul_f32 v122, v122, v11
    v_mul_f32 v123, v123, v11
    v_accvgpr_write_b32 a128, v120
    v_accvgpr_write_b32 a129, v121
    v_accvgpr_write_b32 a130, v122
    v_accvgpr_write_b32 a131, v123
    v_accvgpr_read_b32 v120, a132
    v_accvgpr_read_b32 v121, a133
    v_accvgpr_read_b32 v122, a134
    v_accvgpr_read_b32 v123, a135
    v_mul_f32 v120, v120, v12
    v_mul_f32 v121, v121, v12
    v_mul_f32 v122, v122, v12
    v_mul_f32 v123, v123, v12
    v_accvgpr_write_b32 a132, v120
    v_accvgpr_write_b32 a133, v121
    v_accvgpr_write_b32 a134, v122
    v_accvgpr_write_b32 a135, v123
    v_accvgpr_read_b32 v120, a136
    v_accvgpr_read_b32 v121, a137
    v_accvgpr_read_b32 v122, a138
    v_accvgpr_read_b32 v123, a139
    v_mul_f32 v120, v120, v11
    v_mul_f32 v121, v121, v11
    v_mul_f32 v122, v122, v11
    v_mul_f32 v123, v123, v11
    v_accvgpr_write_b32 a136, v120
    v_accvgpr_write_b32 a137, v121
    v_accvgpr_write_b32 a138, v122
    v_accvgpr_write_b32 a139, v123
    v_accvgpr_read_b32 v120, a140
    v_accvgpr_read_b32 v121, a141
    v_accvgpr_read_b32 v122, a142
    v_accvgpr_read_b32 v123, a143
    v_mul_f32 v120, v120, v12
    v_mul_f32 v121, v121, v12
    v_mul_f32 v122, v122, v12
    v_mul_f32 v123, v123, v12
    v_accvgpr_write_b32 a140, v120
    v_accvgpr_write_b32 a141, v121
    v_accvgpr_write_b32 a142, v122
    v_accvgpr_write_b32 a143, v123
    v_accvgpr_read_b32 v120, a144
    v_accvgpr_read_b32 v121, a145
    v_accvgpr_read_b32 v122, a146
    v_accvgpr_read_b32 v123, a147
    v_mul_f32 v120, v120, v11
    v_mul_f32 v121, v121, v11
    v_mul_f32 v122, v122, v11
    v_mul_f32 v123, v123, v11
    v_accvgpr_write_b32 a144, v120
    v_accvgpr_write_b32 a145, v121
    v_accvgpr_write_b32 a146, v122
    v_accvgpr_write_b32 a147, v123
    v_accvgpr_read_b32 v120, a148
    v_accvgpr_read_b32 v121, a149
    v_accvgpr_read_b32 v122, a150
    v_accvgpr_read_b32 v123, a151
    v_mul_f32 v120, v120, v12
    v_mul_f32 v121, v121, v12
    v_mul_f32 v122, v122, v12
    v_mul_f32 v123, v123, v12
    v_accvgpr_write_b32 a148, v120
    v_accvgpr_write_b32 a149, v121
    v_accvgpr_write_b32 a150, v122
    v_accvgpr_write_b32 a151, v123
    v_accvgpr_read_b32 v120, a152
    v_accvgpr_read_b32 v121, a153
    v_accvgpr_read_b32 v122, a154
    v_accvgpr_read_b32 v123, a155
    v_mul_f32 v120, v120, v11
    v_mul_f32 v121, v121, v11
    v_mul_f32 v122, v122, v11
    v_mul_f32 v123, v123, v11
    v_accvgpr_write_b32 a152, v120
    v_accvgpr_write_b32 a153, v121
    v_accvgpr_write_b32 a154, v122
    v_accvgpr_write_b32 a155, v123
    v_accvgpr_read_b32 v120, a156
    v_accvgpr_read_b32 v121, a157
    v_accvgpr_read_b32 v122, a158
    v_accvgpr_read_b32 v123, a159
    v_mul_f32 v120, v120, v12
    v_mul_f32 v121, v121, v12
    v_mul_f32 v122, v122, v12
    v_mul_f32 v123, v123, v12
    v_accvgpr_write_b32 a156, v120
    v_accvgpr_write_b32 a157, v121
    v_accvgpr_write_b32 a158, v122
    v_accvgpr_write_b32 a159, v123
    v_accvgpr_read_b32 v120, a160
    v_accvgpr_read_b32 v121, a161
    v_accvgpr_read_b32 v122, a162
    v_accvgpr_read_b32 v123, a163
    v_mul_f32 v120, v120, v11
    v_mul_f32 v121, v121, v11
    v_mul_f32 v122, v122, v11
    v_mul_f32 v123, v123, v11
    v_accvgpr_write_b32 a160, v120
    v_accvgpr_write_b32 a161, v121
    v_accvgpr_write_b32 a162, v122
    v_accvgpr_write_b32 a163, v123
    v_accvgpr_read_b32 v120, a164
    v_accvgpr_read_b32 v121, a165
    v_accvgpr_read_b32 v122, a166
    v_accvgpr_read_b32 v123, a167
    v_mul_f32 v120, v120, v12
    v_mul_f32 v121, v121, v12
    v_mul_f32 v122, v122, v12
    v_mul_f32 v123, v123, v12
    v_accvgpr_write_b32 a164, v120
    v_accvgpr_write_b32 a165, v121
    v_accvgpr_write_b32 a166, v122
    v_accvgpr_write_b32 a167, v123
    v_accvgpr_read_b32 v120, a168
    v_accvgpr_read_b32 v121, a169
    v_accvgpr_read_b32 v122, a170
    v_accvgpr_read_b32 v123, a171
    v_mul_f32 v120, v120, v11
    v_mul_f32 v121, v121, v11
    v_mul_f32 v122, v122, v11
    v_mul_f32 v123, v123, v11
    v_accvgpr_write_b32 a168, v120
    v_accvgpr_write_b32 a169, v121
    v_accvgpr_write_b32 a170, v122
    v_accvgpr_write_b32 a171, v123
    v_accvgpr_read_b32 v120, a172
    v_accvgpr_read_b32 v121, a173
    v_accvgpr_read_b32 v122, a174
    v_accvgpr_read_b32 v123, a175
    v_mul_f32 v120, v120, v12
    v_mul_f32 v121, v121, v12
    v_mul_f32 v122, v122, v12
    v_mul_f32 v123, v123, v12
    v_accvgpr_write_b32 a172, v120
    v_accvgpr_write_b32 a173, v121
    v_accvgpr_write_b32 a174, v122
    v_accvgpr_write_b32 a175, v123
    v_accvgpr_read_b32 v120, a176
    v_accvgpr_read_b32 v121, a177
    v_accvgpr_read_b32 v122, a178
    v_accvgpr_read_b32 v123, a179
    v_mul_f32 v120, v120, v11
    v_mul_f32 v121, v121, v11
    v_mul_f32 v122, v122, v11
    v_mul_f32 v123, v123, v11
    v_accvgpr_write_b32 a176, v120
    v_accvgpr_write_b32 a177, v121
    v_accvgpr_write_b32 a178, v122
    v_accvgpr_write_b32 a179, v123
    v_accvgpr_read_b32 v120, a180
    v_accvgpr_read_b32 v121, a181
    v_accvgpr_read_b32 v122, a182
    v_accvgpr_read_b32 v123, a183
    v_mul_f32 v120, v120, v12
    v_mul_f32 v121, v121, v12
    v_mul_f32 v122, v122, v12
    v_mul_f32 v123, v123, v12
    v_accvgpr_write_b32 a180, v120
    v_accvgpr_write_b32 a181, v121
    v_accvgpr_write_b32 a182, v122
    v_accvgpr_write_b32 a183, v123
    v_accvgpr_read_b32 v120, a184
    v_accvgpr_read_b32 v121, a185
    v_accvgpr_read_b32 v122, a186
    v_accvgpr_read_b32 v123, a187
    v_mul_f32 v120, v120, v11
    v_mul_f32 v121, v121, v11
    v_mul_f32 v122, v122, v11
    v_mul_f32 v123, v123, v11
    v_accvgpr_write_b32 a184, v120
    v_accvgpr_write_b32 a185, v121
    v_accvgpr_write_b32 a186, v122
    v_accvgpr_write_b32 a187, v123
    v_accvgpr_read_b32 v120, a188
    v_accvgpr_read_b32 v121, a189
    v_accvgpr_read_b32 v122, a190
    v_accvgpr_read_b32 v123, a191
    v_mul_f32 v120, v120, v12
    v_mul_f32 v121, v121, v12
    v_mul_f32 v122, v122, v12
    v_mul_f32 v123, v123, v12
    v_accvgpr_write_b32 a188, v120
    v_accvgpr_write_b32 a189, v121
    v_accvgpr_write_b32 a190, v122
    v_accvgpr_write_b32 a191, v123
    v_accvgpr_read_b32 v120, a192
    v_accvgpr_read_b32 v121, a193
    v_accvgpr_read_b32 v122, a194
    v_accvgpr_read_b32 v123, a195
    v_mul_f32 v120, v120, v11
    v_mul_f32 v121, v121, v11
    v_mul_f32 v122, v122, v11
    v_mul_f32 v123, v123, v11
    v_accvgpr_write_b32 a192, v120
    v_accvgpr_write_b32 a193, v121
    v_accvgpr_write_b32 a194, v122
    v_accvgpr_write_b32 a195, v123
    v_accvgpr_read_b32 v120, a196
    v_accvgpr_read_b32 v121, a197
    v_accvgpr_read_b32 v122, a198
    v_accvgpr_read_b32 v123, a199
    v_mul_f32 v120, v120, v12
    v_mul_f32 v121, v121, v12
    v_mul_f32 v122, v122, v12
    v_mul_f32 v123, v123, v12
    v_accvgpr_write_b32 a196, v120
    v_accvgpr_write_b32 a197, v121
    v_accvgpr_write_b32 a198, v122
    v_accvgpr_write_b32 a199, v123
    v_accvgpr_read_b32 v120, a200
    v_accvgpr_read_b32 v121, a201
    v_accvgpr_read_b32 v122, a202
    v_accvgpr_read_b32 v123, a203
    v_mul_f32 v120, v120, v11
    v_mul_f32 v121, v121, v11
    v_mul_f32 v122, v122, v11
    v_mul_f32 v123, v123, v11
    v_accvgpr_write_b32 a200, v120
    v_accvgpr_write_b32 a201, v121
    v_accvgpr_write_b32 a202, v122
    v_accvgpr_write_b32 a203, v123
    v_accvgpr_read_b32 v120, a204
    v_accvgpr_read_b32 v121, a205
    v_accvgpr_read_b32 v122, a206
    v_accvgpr_read_b32 v123, a207
    v_mul_f32 v120, v120, v12
    v_mul_f32 v121, v121, v12
    v_mul_f32 v122, v122, v12
    v_mul_f32 v123, v123, v12
    v_accvgpr_write_b32 a204, v120
    v_accvgpr_write_b32 a205, v121
    v_accvgpr_write_b32 a206, v122
    v_accvgpr_write_b32 a207, v123
    v_accvgpr_read_b32 v120, a208
    v_accvgpr_read_b32 v121, a209
    v_accvgpr_read_b32 v122, a210
    v_accvgpr_read_b32 v123, a211
    v_mul_f32 v120, v120, v11
    v_mul_f32 v121, v121, v11
    v_mul_f32 v122, v122, v11
    v_mul_f32 v123, v123, v11
    v_accvgpr_write_b32 a208, v120
    v_accvgpr_write_b32 a209, v121
    v_accvgpr_write_b32 a210, v122
    v_accvgpr_write_b32 a211, v123
    v_accvgpr_read_b32 v120, a212
    v_accvgpr_read_b32 v121, a213
    v_accvgpr_read_b32 v122, a214
    v_accvgpr_read_b32 v123, a215
    v_mul_f32 v120, v120, v12
    v_mul_f32 v121, v121, v12
    v_mul_f32 v122, v122, v12
    v_mul_f32 v123, v123, v12
    v_accvgpr_write_b32 a212, v120
    v_accvgpr_write_b32 a213, v121
    v_accvgpr_write_b32 a214, v122
    v_accvgpr_write_b32 a215, v123
    v_accvgpr_read_b32 v120, a216
    v_accvgpr_read_b32 v121, a217
    v_accvgpr_read_b32 v122, a218
    v_accvgpr_read_b32 v123, a219
    v_mul_f32 v120, v120, v11
    v_mul_f32 v121, v121, v11
    v_mul_f32 v122, v122, v11
    v_mul_f32 v123, v123, v11
    v_accvgpr_write_b32 a216, v120
    v_accvgpr_write_b32 a217, v121
    v_accvgpr_write_b32 a218, v122
    v_accvgpr_write_b32 a219, v123
    v_accvgpr_read_b32 v120, a220
    v_accvgpr_read_b32 v121, a221
    v_accvgpr_read_b32 v122, a222
    v_accvgpr_read_b32 v123, a223
    v_mul_f32 v120, v120, v12
    v_mul_f32 v121, v121, v12
    v_mul_f32 v122, v122, v12
    v_mul_f32 v123, v123, v12
    v_accvgpr_write_b32 a220, v120
    v_accvgpr_write_b32 a221, v121
    v_accvgpr_write_b32 a222, v122
    v_accvgpr_write_b32 a223, v123
    v_accvgpr_read_b32 v120, a224
    v_accvgpr_read_b32 v121, a225
    v_accvgpr_read_b32 v122, a226
    v_accvgpr_read_b32 v123, a227
    v_mul_f32 v120, v120, v11
    v_mul_f32 v121, v121, v11
    v_mul_f32 v122, v122, v11
    v_mul_f32 v123, v123, v11
    v_accvgpr_write_b32 a224, v120
    v_accvgpr_write_b32 a225, v121
    v_accvgpr_write_b32 a226, v122
    v_accvgpr_write_b32 a227, v123
    v_accvgpr_read_b32 v120, a228
    v_accvgpr_read_b32 v121, a229
    v_accvgpr_read_b32 v122, a230
    v_accvgpr_read_b32 v123, a231
    v_mul_f32 v120, v120, v12
    v_mul_f32 v121, v121, v12
    v_mul_f32 v122, v122, v12
    v_mul_f32 v123, v123, v12
    v_accvgpr_write_b32 a228, v120
    v_accvgpr_write_b32 a229, v121
    v_accvgpr_write_b32 a230, v122
    v_accvgpr_write_b32 a231, v123
    v_accvgpr_read_b32 v120, a232
    v_accvgpr_read_b32 v121, a233
    v_accvgpr_read_b32 v122, a234
    v_accvgpr_read_b32 v123, a235
    v_mul_f32 v120, v120, v11
    v_mul_f32 v121, v121, v11
    v_mul_f32 v122, v122, v11
    v_mul_f32 v123, v123, v11
    v_accvgpr_write_b32 a232, v120
    v_accvgpr_write_b32 a233, v121
    v_accvgpr_write_b32 a234, v122
    v_accvgpr_write_b32 a235, v123
    v_accvgpr_read_b32 v120, a236
    v_accvgpr_read_b32 v121, a237
    v_accvgpr_read_b32 v122, a238
    v_accvgpr_read_b32 v123, a239
    v_mul_f32 v120, v120, v12
    v_mul_f32 v121, v121, v12
    v_mul_f32 v122, v122, v12
    v_mul_f32 v123, v123, v12
    v_accvgpr_write_b32 a236, v120
    v_accvgpr_write_b32 a237, v121
    v_accvgpr_write_b32 a238, v122
    v_accvgpr_write_b32 a239, v123
    v_accvgpr_read_b32 v120, a240
    v_accvgpr_read_b32 v121, a241
    v_accvgpr_read_b32 v122, a242
    v_accvgpr_read_b32 v123, a243
    v_mul_f32 v120, v120, v11
    v_mul_f32 v121, v121, v11
    v_mul_f32 v122, v122, v11
    v_mul_f32 v123, v123, v11
    v_accvgpr_write_b32 a240, v120
    v_accvgpr_write_b32 a241, v121
    v_accvgpr_write_b32 a242, v122
    v_accvgpr_write_b32 a243, v123
    v_accvgpr_read_b32 v120, a244
    v_accvgpr_read_b32 v121, a245
    v_accvgpr_read_b32 v122, a246
    v_accvgpr_read_b32 v123, a247
    v_mul_f32 v120, v120, v12
    v_mul_f32 v121, v121, v12
    v_mul_f32 v122, v122, v12
    v_mul_f32 v123, v123, v12
    v_accvgpr_write_b32 a244, v120
    v_accvgpr_write_b32 a245, v121
    v_accvgpr_write_b32 a246, v122
    v_accvgpr_write_b32 a247, v123
    v_accvgpr_read_b32 v120, a248
    v_accvgpr_read_b32 v121, a249
    v_accvgpr_read_b32 v122, a250
    v_accvgpr_read_b32 v123, a251
    v_mul_f32 v120, v120, v11
    v_mul_f32 v121, v121, v11
    v_mul_f32 v122, v122, v11
    v_mul_f32 v123, v123, v11
    v_accvgpr_write_b32 a248, v120
    v_accvgpr_write_b32 a249, v121
    v_accvgpr_write_b32 a250, v122
    v_accvgpr_write_b32 a251, v123
    v_accvgpr_read_b32 v120, a252
    v_accvgpr_read_b32 v121, a253
    v_accvgpr_read_b32 v122, a254
    v_accvgpr_read_b32 v123, a255
    v_mul_f32 v120, v120, v12
    v_mul_f32 v121, v121, v12
    v_mul_f32 v122, v122, v12
    v_mul_f32 v123, v123, v12
    v_accvgpr_write_b32 a252, v120
    v_accvgpr_write_b32 a253, v121
    v_accvgpr_write_b32 a254, v122
    v_accvgpr_write_b32 a255, v123
    s_branch L_r2bM
L_r1L:
    v_max3_f32 v14, v16, v17, v18
    v_max3_f32 v14, v14, v19, v24
    v_max3_f32 v14, v14, v25, v26
    v_max_f32 v14, v14, v27
    v_max3_f32 v15, v20, v21, v22
    v_max3_f32 v15, v15, v23, v28
    v_max3_f32 v15, v15, v29, v30
    v_max_f32 v15, v15, v31
    v_mov_b32 v120, v14
    v_mov_b32 v121, v15
    s_nop 1
    v_permlane16_swap_b32 v120, v14
    v_permlane16_swap_b32 v121, v15
    s_nop 1
    v_max_f32 v14, v14, v120
    v_max_f32 v15, v15, v121
    v_mov_b32 v120, v14
    v_mov_b32 v121, v15
    s_nop 1
    v_permlane32_swap_b32 v120, v14
    v_permlane32_swap_b32 v121, v15
    s_nop 1
    v_max_f32 v14, v14, v120
    v_max_f32 v15, v15, v121
    v_max_f32 v14, 0, v14
    v_sub_f32 v11, 0, v14
    v_exp_f32 v11, v11
    v_sub_f32 v16, v16, v14
    v_sub_f32 v17, v17, v14
    v_sub_f32 v18, v18, v14
    v_sub_f32 v19, v19, v14
    v_sub_f32 v24, v24, v14
    v_sub_f32 v25, v25, v14
    v_sub_f32 v26, v26, v14
    v_sub_f32 v27, v27, v14
    v_sub_f32 v56, v56, v14
    v_sub_f32 v57, v57, v14
    v_sub_f32 v58, v58, v14
    v_sub_f32 v59, v59, v14
    v_mul_f32 v8, v8, v11
    v_max_f32 v15, 0, v15
    v_sub_f32 v12, 0, v15
    v_exp_f32 v12, v12
    v_sub_f32 v20, v20, v15
    v_sub_f32 v21, v21, v15
    v_sub_f32 v22, v22, v15
    v_sub_f32 v23, v23, v15
    v_sub_f32 v28, v28, v15
    v_sub_f32 v29, v29, v15
    v_sub_f32 v30, v30, v15
    v_sub_f32 v31, v31, v15
    v_sub_f32 v60, v60, v15
    v_sub_f32 v61, v61, v15
    v_sub_f32 v62, v62, v15
    v_sub_f32 v63, v63, v15
    v_mul_f32 v9, v9, v12
    s_branch L_r1bL
L_r2L:
    s_nop 7
    v_mul_f32 v128, v128, v11
    v_mul_f32 v129, v129, v11
    v_mul_f32 v130, v130, v11
    v_mul_f32 v131, v131, v11
    v_mul_f32 v132, v132, v12
    v_mul_f32 v133, v133, v12
    v_mul_f32 v134, v134, v12
    v_mul_f32 v135, v135, v12
    v_mul_f32 v136, v136, v11
    v_mul_f32 v137, v137, v11
    v_mul_f32 v138, v138, v11
    v_mul_f32 v139, v139, v11
    v_mul_f32 v140, v140, v12
    v_mul_f32 v141, v141, v12
    v_mul_f32 v142, v142, v12
    v_mul_f32 v143, v143, v12
    v_mul_f32 v144, v144, v11
    v_mul_f32 v145, v145, v11
    v_mul_f32 v146, v146, v11
    v_mul_f32 v147, v147, v11
    v_mul_f32 v148, v148, v12
    v_mul_f32 v149, v149, v12
    v_mul_f32 v150, v150, v12
    v_mul_f32 v151, v151, v12
    v_mul_f32 v152, v152, v11
    v_mul_f32 v153, v153, v11
    v_mul_f32 v154, v154, v11
    v_mul_f32 v155, v155, v11
    v_mul_f32 v156, v156, v12
    v_mul_f32 v157, v157, v12
    v_mul_f32 v158, v158, v12
    v_mul_f32 v159, v159, v12
    v_mul_f32 v160, v160, v11
    v_mul_f32 v161, v161, v11
    v_mul_f32 v162, v162, v11
    v_mul_f32 v163, v163, v11
    v_mul_f32 v164, v164, v12
    v_mul_f32 v165, v165, v12
    v_mul_f32 v166, v166, v12
    v_mul_f32 v167, v167, v12
    v_mul_f32 v168, v168, v11
    v_mul_f32 v169, v169, v11
    v_mul_f32 v170, v170, v11
    v_mul_f32 v171, v171, v11
    v_mul_f32 v172, v172, v12
    v_mul_f32 v173, v173, v12
    v_mul_f32 v174, v174, v12
    v_mul_f32 v175, v175, v12
    v_mul_f32 v176, v176, v11
    v_mul_f32 v177, v177, v11
    v_mul_f32 v178, v178, v11
    v_mul_f32 v179, v179, v11
    v_mul_f32 v180, v180, v12
    v_mul_f32 v181, v181, v12
    v_mul_f32 v182, v182, v12
    v_mul_f32 v183, v183, v12
    v_mul_f32 v184, v184, v11
    v_mul_f32 v185, v185, v11
    v_mul_f32 v186, v186, v11
    v_mul_f32 v187, v187, v11
    v_mul_f32 v188, v188, v12
    v_mul_f32 v189, v189, v12
    v_mul_f32 v190, v190, v12
    v_mul_f32 v191, v191, v12
    v_mul_f32 v192, v192, v11
    v_mul_f32 v193, v193, v11
    v_mul_f32 v194, v194, v11
    v_mul_f32 v195, v195, v11
    v_mul_f32 v196, v196, v12
    v_mul_f32 v197, v197, v12
    v_mul_f32 v198, v198, v12
    v_mul_f32 v199, v199, v12
    v_mul_f32 v200, v200, v11
    v_mul_f32 v201, v201, v11
    v_mul_f32 v202, v202, v11
    v_mul_f32 v203, v203, v11
    v_mul_f32 v204, v204, v12
    v_mul_f32 v205, v205, v12
    v_mul_f32 v206, v206, v12
    v_mul_f32 v207, v207, v12
    v_mul_f32 v208, v208, v11
    v_mul_f32 v209, v209, v11
    v_mul_f32 v210, v210, v11
    v_mul_f32 v211, v211, v11
    v_mul_f32 v212, v212, v12
    v_mul_f32 v213, v213, v12
    v_mul_f32 v214, v214, v12
    v_mul_f32 v215, v215, v12
    v_mul_f32 v216, v216, v11
    v_mul_f32 v217, v217, v11
    v_mul_f32 v218, v218, v11
    v_mul_f32 v219, v219, v11
    v_mul_f32 v220, v220, v12
    v_mul_f32 v221, v221, v12
    v_mul_f32 v222, v222, v12
    v_mul_f32 v223, v223, v12
    v_mul_f32 v224, v224, v11
    v_mul_f32 v225, v225, v11
    v_mul_f32 v226, v226, v11
    v_mul_f32 v227, v227, v11
    v_mul_f32 v228, v228, v12
    v_mul_f32 v229, v229, v12
    v_mul_f32 v230, v230, v12
    v_mul_f32 v231, v231, v12
    v_mul_f32 v232, v232, v11
    v_mul_f32 v233, v233, v11
    v_mul_f32 v234, v234, v11
    v_mul_f32 v235, v235, v11
    v_mul_f32 v236, v236, v12
    v_mul_f32 v237, v237, v12
    v_mul_f32 v238, v238, v12
    v_mul_f32 v239, v239, v12
    v_mul_f32 v240, v240, v11
    v_mul_f32 v241, v241, v11
    v_mul_f32 v242, v242, v11
    v_mul_f32 v243, v243, v11
    v_mul_f32 v244, v244, v12
    v_mul_f32 v245, v245, v12
    v_mul_f32 v246, v246, v12
    v_mul_f32 v247, v247, v12
    v_mul_f32 v248, v248, v11
    v_mul_f32 v249, v249, v11
    v_mul_f32 v250, v250, v11
    v_mul_f32 v251, v251, v11
    v_mul_f32 v252, v252, v12
    v_mul_f32 v253, v253, v12
    v_mul_f32 v254, v254, v12
    v_mul_f32 v255, v255, v12
    v_accvgpr_read_b32 v120, a128
    v_accvgpr_read_b32 v121, a129
    v_accvgpr_read_b32 v122, a130
    v_accvgpr_read_b32 v123, a131
    v_mul_f32 v120, v120, v11
    v_mul_f32 v121, v121, v11
    v_mul_f32 v122, v122, v11
    v_mul_f32 v123, v123, v11
    v_accvgpr_write_b32 a128, v120
    v_accvgpr_write_b32 a129, v121
    v_accvgpr_write_b32 a130, v122
    v_accvgpr_write_b32 a131, v123
    v_accvgpr_read_b32 v120, a132
    v_accvgpr_read_b32 v121, a133
    v_accvgpr_read_b32 v122, a134
    v_accvgpr_read_b32 v123, a135
    v_mul_f32 v120, v120, v12
    v_mul_f32 v121, v121, v12
    v_mul_f32 v122, v122, v12
    v_mul_f32 v123, v123, v12
    v_accvgpr_write_b32 a132, v120
    v_accvgpr_write_b32 a133, v121
    v_accvgpr_write_b32 a134, v122
    v_accvgpr_write_b32 a135, v123
    v_accvgpr_read_b32 v120, a136
    v_accvgpr_read_b32 v121, a137
    v_accvgpr_read_b32 v122, a138
    v_accvgpr_read_b32 v123, a139
    v_mul_f32 v120, v120, v11
    v_mul_f32 v121, v121, v11
    v_mul_f32 v122, v122, v11
    v_mul_f32 v123, v123, v11
    v_accvgpr_write_b32 a136, v120
    v_accvgpr_write_b32 a137, v121
    v_accvgpr_write_b32 a138, v122
    v_accvgpr_write_b32 a139, v123
    v_accvgpr_read_b32 v120, a140
    v_accvgpr_read_b32 v121, a141
    v_accvgpr_read_b32 v122, a142
    v_accvgpr_read_b32 v123, a143
    v_mul_f32 v120, v120, v12
    v_mul_f32 v121, v121, v12
    v_mul_f32 v122, v122, v12
    v_mul_f32 v123, v123, v12
    v_accvgpr_write_b32 a140, v120
    v_accvgpr_write_b32 a141, v121
    v_accvgpr_write_b32 a142, v122
    v_accvgpr_write_b32 a143, v123
    v_accvgpr_read_b32 v120, a144
    v_accvgpr_read_b32 v121, a145
    v_accvgpr_read_b32 v122, a146
    v_accvgpr_read_b32 v123, a147
    v_mul_f32 v120, v120, v11
    v_mul_f32 v121, v121, v11
    v_mul_f32 v122, v122, v11
    v_mul_f32 v123, v123, v11
    v_accvgpr_write_b32 a144, v120
    v_accvgpr_write_b32 a145, v121
    v_accvgpr_write_b32 a146, v122
    v_accvgpr_write_b32 a147, v123
    v_accvgpr_read_b32 v120, a148
    v_accvgpr_read_b32 v121, a149
    v_accvgpr_read_b32 v122, a150
    v_accvgpr_read_b32 v123, a151
    v_mul_f32 v120, v120, v12
    v_mul_f32 v121, v121, v12
    v_mul_f32 v122, v122, v12
    v_mul_f32 v123, v123, v12
    v_accvgpr_write_b32 a148, v120
    v_accvgpr_write_b32 a149, v121
    v_accvgpr_write_b32 a150, v122
    v_accvgpr_write_b32 a151, v123
    v_accvgpr_read_b32 v120, a152
    v_accvgpr_read_b32 v121, a153
    v_accvgpr_read_b32 v122, a154
    v_accvgpr_read_b32 v123, a155
    v_mul_f32 v120, v120, v11
    v_mul_f32 v121, v121, v11
    v_mul_f32 v122, v122, v11
    v_mul_f32 v123, v123, v11
    v_accvgpr_write_b32 a152, v120
    v_accvgpr_write_b32 a153, v121
    v_accvgpr_write_b32 a154, v122
    v_accvgpr_write_b32 a155, v123
    v_accvgpr_read_b32 v120, a156
    v_accvgpr_read_b32 v121, a157
    v_accvgpr_read_b32 v122, a158
    v_accvgpr_read_b32 v123, a159
    v_mul_f32 v120, v120, v12
    v_mul_f32 v121, v121, v12
    v_mul_f32 v122, v122, v12
    v_mul_f32 v123, v123, v12
    v_accvgpr_write_b32 a156, v120
    v_accvgpr_write_b32 a157, v121
    v_accvgpr_write_b32 a158, v122
    v_accvgpr_write_b32 a159, v123
    v_accvgpr_read_b32 v120, a160
    v_accvgpr_read_b32 v121, a161
    v_accvgpr_read_b32 v122, a162
    v_accvgpr_read_b32 v123, a163
    v_mul_f32 v120, v120, v11
    v_mul_f32 v121, v121, v11
    v_mul_f32 v122, v122, v11
    v_mul_f32 v123, v123, v11
    v_accvgpr_write_b32 a160, v120
    v_accvgpr_write_b32 a161, v121
    v_accvgpr_write_b32 a162, v122
    v_accvgpr_write_b32 a163, v123
    v_accvgpr_read_b32 v120, a164
    v_accvgpr_read_b32 v121, a165
    v_accvgpr_read_b32 v122, a166
    v_accvgpr_read_b32 v123, a167
    v_mul_f32 v120, v120, v12
    v_mul_f32 v121, v121, v12
    v_mul_f32 v122, v122, v12
    v_mul_f32 v123, v123, v12
    v_accvgpr_write_b32 a164, v120
    v_accvgpr_write_b32 a165, v121
    v_accvgpr_write_b32 a166, v122
    v_accvgpr_write_b32 a167, v123
    v_accvgpr_read_b32 v120, a168
    v_accvgpr_read_b32 v121, a169
    v_accvgpr_read_b32 v122, a170
    v_accvgpr_read_b32 v123, a171
    v_mul_f32 v120, v120, v11
    v_mul_f32 v121, v121, v11
    v_mul_f32 v122, v122, v11
    v_mul_f32 v123, v123, v11
    v_accvgpr_write_b32 a168, v120
    v_accvgpr_write_b32 a169, v121
    v_accvgpr_write_b32 a170, v122
    v_accvgpr_write_b32 a171, v123
    v_accvgpr_read_b32 v120, a172
    v_accvgpr_read_b32 v121, a173
    v_accvgpr_read_b32 v122, a174
    v_accvgpr_read_b32 v123, a175
    v_mul_f32 v120, v120, v12
    v_mul_f32 v121, v121, v12
    v_mul_f32 v122, v122, v12
    v_mul_f32 v123, v123, v12
    v_accvgpr_write_b32 a172, v120
    v_accvgpr_write_b32 a173, v121
    v_accvgpr_write_b32 a174, v122
    v_accvgpr_write_b32 a175, v123
    v_accvgpr_read_b32 v120, a176
    v_accvgpr_read_b32 v121, a177
    v_accvgpr_read_b32 v122, a178
    v_accvgpr_read_b32 v123, a179
    v_mul_f32 v120, v120, v11
    v_mul_f32 v121, v121, v11
    v_mul_f32 v122, v122, v11
    v_mul_f32 v123, v123, v11
    v_accvgpr_write_b32 a176, v120
    v_accvgpr_write_b32 a177, v121
    v_accvgpr_write_b32 a178, v122
    v_accvgpr_write_b32 a179, v123
    v_accvgpr_read_b32 v120, a180
    v_accvgpr_read_b32 v121, a181
    v_accvgpr_read_b32 v122, a182
    v_accvgpr_read_b32 v123, a183
    v_mul_f32 v120, v120, v12
    v_mul_f32 v121, v121, v12
    v_mul_f32 v122, v122, v12
    v_mul_f32 v123, v123, v12
    v_accvgpr_write_b32 a180, v120
    v_accvgpr_write_b32 a181, v121
    v_accvgpr_write_b32 a182, v122
    v_accvgpr_write_b32 a183, v123
    v_accvgpr_read_b32 v120, a184
    v_accvgpr_read_b32 v121, a185
    v_accvgpr_read_b32 v122, a186
    v_accvgpr_read_b32 v123, a187
    v_mul_f32 v120, v120, v11
    v_mul_f32 v121, v121, v11
    v_mul_f32 v122, v122, v11
    v_mul_f32 v123, v123, v11
    v_accvgpr_write_b32 a184, v120
    v_accvgpr_write_b32 a185, v121
    v_accvgpr_write_b32 a186, v122
    v_accvgpr_write_b32 a187, v123
    v_accvgpr_read_b32 v120, a188
    v_accvgpr_read_b32 v121, a189
    v_accvgpr_read_b32 v122, a190
    v_accvgpr_read_b32 v123, a191
    v_mul_f32 v120, v120, v12
    v_mul_f32 v121, v121, v12
    v_mul_f32 v122, v122, v12
    v_mul_f32 v123, v123, v12
    v_accvgpr_write_b32 a188, v120
    v_accvgpr_write_b32 a189, v121
    v_accvgpr_write_b32 a190, v122
    v_accvgpr_write_b32 a191, v123
    v_accvgpr_read_b32 v120, a192
    v_accvgpr_read_b32 v121, a193
    v_accvgpr_read_b32 v122, a194
    v_accvgpr_read_b32 v123, a195
    v_mul_f32 v120, v120, v11
    v_mul_f32 v121, v121, v11
    v_mul_f32 v122, v122, v11
    v_mul_f32 v123, v123, v11
    v_accvgpr_write_b32 a192, v120
    v_accvgpr_write_b32 a193, v121
    v_accvgpr_write_b32 a194, v122
    v_accvgpr_write_b32 a195, v123
    v_accvgpr_read_b32 v120, a196
    v_accvgpr_read_b32 v121, a197
    v_accvgpr_read_b32 v122, a198
    v_accvgpr_read_b32 v123, a199
    v_mul_f32 v120, v120, v12
    v_mul_f32 v121, v121, v12
    v_mul_f32 v122, v122, v12
    v_mul_f32 v123, v123, v12
    v_accvgpr_write_b32 a196, v120
    v_accvgpr_write_b32 a197, v121
    v_accvgpr_write_b32 a198, v122
    v_accvgpr_write_b32 a199, v123
    v_accvgpr_read_b32 v120, a200
    v_accvgpr_read_b32 v121, a201
    v_accvgpr_read_b32 v122, a202
    v_accvgpr_read_b32 v123, a203
    v_mul_f32 v120, v120, v11
    v_mul_f32 v121, v121, v11
    v_mul_f32 v122, v122, v11
    v_mul_f32 v123, v123, v11
    v_accvgpr_write_b32 a200, v120
    v_accvgpr_write_b32 a201, v121
    v_accvgpr_write_b32 a202, v122
    v_accvgpr_write_b32 a203, v123
    v_accvgpr_read_b32 v120, a204
    v_accvgpr_read_b32 v121, a205
    v_accvgpr_read_b32 v122, a206
    v_accvgpr_read_b32 v123, a207
    v_mul_f32 v120, v120, v12
    v_mul_f32 v121, v121, v12
    v_mul_f32 v122, v122, v12
    v_mul_f32 v123, v123, v12
    v_accvgpr_write_b32 a204, v120
    v_accvgpr_write_b32 a205, v121
    v_accvgpr_write_b32 a206, v122
    v_accvgpr_write_b32 a207, v123
    v_accvgpr_read_b32 v120, a208
    v_accvgpr_read_b32 v121, a209
    v_accvgpr_read_b32 v122, a210
    v_accvgpr_read_b32 v123, a211
    v_mul_f32 v120, v120, v11
    v_mul_f32 v121, v121, v11
    v_mul_f32 v122, v122, v11
    v_mul_f32 v123, v123, v11
    v_accvgpr_write_b32 a208, v120
    v_accvgpr_write_b32 a209, v121
    v_accvgpr_write_b32 a210, v122
    v_accvgpr_write_b32 a211, v123
    v_accvgpr_read_b32 v120, a212
    v_accvgpr_read_b32 v121, a213
    v_accvgpr_read_b32 v122, a214
    v_accvgpr_read_b32 v123, a215
    v_mul_f32 v120, v120, v12
    v_mul_f32 v121, v121, v12
    v_mul_f32 v122, v122, v12
    v_mul_f32 v123, v123, v12
    v_accvgpr_write_b32 a212, v120
    v_accvgpr_write_b32 a213, v121
    v_accvgpr_write_b32 a214, v122
    v_accvgpr_write_b32 a215, v123
    v_accvgpr_read_b32 v120, a216
    v_accvgpr_read_b32 v121, a217
    v_accvgpr_read_b32 v122, a218
    v_accvgpr_read_b32 v123, a219
    v_mul_f32 v120, v120, v11
    v_mul_f32 v121, v121, v11
    v_mul_f32 v122, v122, v11
    v_mul_f32 v123, v123, v11
    v_accvgpr_write_b32 a216, v120
    v_accvgpr_write_b32 a217, v121
    v_accvgpr_write_b32 a218, v122
    v_accvgpr_write_b32 a219, v123
    v_accvgpr_read_b32 v120, a220
    v_accvgpr_read_b32 v121, a221
    v_accvgpr_read_b32 v122, a222
    v_accvgpr_read_b32 v123, a223
    v_mul_f32 v120, v120, v12
    v_mul_f32 v121, v121, v12
    v_mul_f32 v122, v122, v12
    v_mul_f32 v123, v123, v12
    v_accvgpr_write_b32 a220, v120
    v_accvgpr_write_b32 a221, v121
    v_accvgpr_write_b32 a222, v122
    v_accvgpr_write_b32 a223, v123
    v_accvgpr_read_b32 v120, a224
    v_accvgpr_read_b32 v121, a225
    v_accvgpr_read_b32 v122, a226
    v_accvgpr_read_b32 v123, a227
    v_mul_f32 v120, v120, v11
    v_mul_f32 v121, v121, v11
    v_mul_f32 v122, v122, v11
    v_mul_f32 v123, v123, v11
    v_accvgpr_write_b32 a224, v120
    v_accvgpr_write_b32 a225, v121
    v_accvgpr_write_b32 a226, v122
    v_accvgpr_write_b32 a227, v123
    v_accvgpr_read_b32 v120, a228
    v_accvgpr_read_b32 v121, a229
    v_accvgpr_read_b32 v122, a230
    v_accvgpr_read_b32 v123, a231
    v_mul_f32 v120, v120, v12
    v_mul_f32 v121, v121, v12
    v_mul_f32 v122, v122, v12
    v_mul_f32 v123, v123, v12
    v_accvgpr_write_b32 a228, v120
    v_accvgpr_write_b32 a229, v121
    v_accvgpr_write_b32 a230, v122
    v_accvgpr_write_b32 a231, v123
    v_accvgpr_read_b32 v120, a232
    v_accvgpr_read_b32 v121, a233
    v_accvgpr_read_b32 v122, a234
    v_accvgpr_read_b32 v123, a235
    v_mul_f32 v120, v120, v11
    v_mul_f32 v121, v121, v11
    v_mul_f32 v122, v122, v11
    v_mul_f32 v123, v123, v11
    v_accvgpr_write_b32 a232, v120
    v_accvgpr_write_b32 a233, v121
    v_accvgpr_write_b32 a234, v122
    v_accvgpr_write_b32 a235, v123
    v_accvgpr_read_b32 v120, a236
    v_accvgpr_read_b32 v121, a237
    v_accvgpr_read_b32 v122, a238
    v_accvgpr_read_b32 v123, a239
    v_mul_f32 v120, v120, v12
    v_mul_f32 v121, v121, v12
    v_mul_f32 v122, v122, v12
    v_mul_f32 v123, v123, v12
    v_accvgpr_write_b32 a236, v120
    v_accvgpr_write_b32 a237, v121
    v_accvgpr_write_b32 a238, v122
    v_accvgpr_write_b32 a239, v123
    v_accvgpr_read_b32 v120, a240
    v_accvgpr_read_b32 v121, a241
    v_accvgpr_read_b32 v122, a242
    v_accvgpr_read_b32 v123, a243
    v_mul_f32 v120, v120, v11
    v_mul_f32 v121, v121, v11
    v_mul_f32 v122, v122, v11
    v_mul_f32 v123, v123, v11
    v_accvgpr_write_b32 a240, v120
    v_accvgpr_write_b32 a241, v121
    v_accvgpr_write_b32 a242, v122
    v_accvgpr_write_b32 a243, v123
    v_accvgpr_read_b32 v120, a244
    v_accvgpr_read_b32 v121, a245
    v_accvgpr_read_b32 v122, a246
    v_accvgpr_read_b32 v123, a247
    v_mul_f32 v120, v120, v12
    v_mul_f32 v121, v121, v12
    v_mul_f32 v122, v122, v12
    v_mul_f32 v123, v123, v12
    v_accvgpr_write_b32 a244, v120
    v_accvgpr_write_b32 a245, v121
    v_accvgpr_write_b32 a246, v122
    v_accvgpr_write_b32 a247, v123
    v_accvgpr_read_b32 v120, a248
    v_accvgpr_read_b32 v121, a249
    v_accvgpr_read_b32 v122, a250
    v_accvgpr_read_b32 v123, a251
    v_mul_f32 v120, v120, v11
    v_mul_f32 v121, v121, v11
    v_mul_f32 v122, v122, v11
    v_mul_f32 v123, v123, v11
    v_accvgpr_write_b32 a248, v120
    v_accvgpr_write_b32 a249, v121
    v_accvgpr_write_b32 a250, v122
    v_accvgpr_write_b32 a251, v123
    v_accvgpr_read_b32 v120, a252
    v_accvgpr_read_b32 v121, a253
    v_accvgpr_read_b32 v122, a254
    v_accvgpr_read_b32 v123, a255
    v_mul_f32 v120, v120, v12
    v_mul_f32 v121, v121, v12
    v_mul_f32 v122, v122, v12
    v_mul_f32 v123, v123, v12
    v_accvgpr_write_b32 a252, v120
    v_accvgpr_write_b32 a253, v121
    v_accvgpr_write_b32 a254, v122
    v_accvgpr_write_b32 a255, v123
    s_branch L_r2bL
code_end:
    s_endpgm
.section .rodata,"a"
.p2align 6
.amdhsa_kernel standalone__conformer_family_branchformer__speech_kernel
  .amdhsa_next_free_vgpr 512
  .amdhsa_next_free_sgpr 102
  .amdhsa_accum_offset 256
  .amdhsa_group_segment_fixed_size 0
  .amdhsa_kernarg_size 96
  .amdhsa_user_sgpr_count 2
  .amdhsa_user_sgpr_kernarg_segment_ptr 1
  .amdhsa_system_sgpr_workgroup_id_x 1
.end_amdhsa_kernel
```
